```python
import torch

def _softmax(x, axis=-1):
    return torch.softmax(x, dim=axis)
def _gelu(x):
    return torch.nn.functional.gelu(x, approximate="tanh")
def _silu(x):
    return torch.nn.functional.silu(x)
def _sigmoid(x):
    return torch.sigmoid(x)
def _layernorm(x, axis=-1, eps=1e-5):
    m = x.mean(dim=axis, keepdim=True)
    v = x.var(dim=axis, keepdim=True, unbiased=False)
    return (x - m) / torch.sqrt(v + eps)
def _scatter_add(tgt, idx, src, axis=0):
    return tgt.clone().index_add_(axis, idx, src)
def _segment_sum(src, seg, n):
    out = torch.zeros((n,) + src.shape[1:], dtype=src.dtype)
    return out.index_add_(0, seg, src)
def _pad(x, pw):
    flat = tuple(v for pair in reversed(pw) for v in pair)
    return torch.nn.functional.pad(x, flat)

kernel_name = 'recurrent_scan__ssm_conv_s5__geglu_ffn__prompt'

def setup_inputs():

    _w = (lambda a: (lambda t: t.to(torch.bfloat16) if t.is_floating_point() else t)(torch.as_tensor(a)))
    def _A_setup():
        B, S, D = 1, 2048, 1024
        P = D
        Lambda_re = -0.5 * (lambda _x: torch.exp(torch.as_tensor(_x)))((lambda *s: torch.randn(*s, dtype=torch.bfloat16) * 0.2)(P))
        Lambda_im = (lambda *s: torch.randn(*s, dtype=torch.bfloat16) * 0.4)(P) * 1.0
        B_re = (lambda *s: torch.randn(*s, dtype=torch.bfloat16) * 0.2)(P, D) * (D ** -0.5)
        B_im = (lambda *s: torch.randn(*s, dtype=torch.bfloat16) * 0.2)(P, D) * (D ** -0.5)
        C_re = (lambda *s: torch.randn(*s, dtype=torch.bfloat16) * 0.2)(D, P) * (P ** -0.5)
        C_im = (lambda *s: torch.randn(*s, dtype=torch.bfloat16) * 0.2)(D, P) * (P ** -0.5)
        log_dt = (lambda *s: torch.randn(*s, dtype=torch.bfloat16) * 0.2)(P) * 0.3 - 2.0
        Dskip = (lambda *s: torch.randn(*s, dtype=torch.bfloat16) * 0.05)(D)
        return {
            "x": _w((lambda *s: torch.randn(*s, dtype=torch.bfloat16) * 0.05)(B, S, D)),
            "Lambda_re": _w(Lambda_re),
            "Lambda_im": _w(Lambda_im),
            "B_re": _w(B_re),
            "B_im": _w(B_im),
            "C_re": _w(C_re),
            "C_im": _w(C_im),
            "log_dt": _w(log_dt),
            "Dskip": _w(Dskip),
        }
    _A_in = _A_setup()

    def _B_setup():
        B, S, D, F = 1, 2048, 1024, 3584
        return {
            "x": _w((lambda *s: torch.randn(*s, dtype=torch.bfloat16) * 0.05)(B, S, D)),
            "w_gate": _w((lambda *s: torch.randn(*s, dtype=torch.bfloat16) * 0.05)(D, F)),
            "w_up": _w((lambda *s: torch.randn(*s, dtype=torch.bfloat16) * 0.05)(D, F)),
            "w_down": _w((lambda *s: torch.randn(*s, dtype=torch.bfloat16) * 0.05)(F, D)),
        }
    _B_in = _B_setup()

    return {
        "A_x": _A_in["x"],
        "A_Lambda_re": _A_in["Lambda_re"],
        "A_Lambda_im": _A_in["Lambda_im"],
        "A_B_re": _A_in["B_re"],
        "A_B_im": _A_in["B_im"],
        "A_C_re": _A_in["C_re"],
        "A_C_im": _A_in["C_im"],
        "A_log_dt": _A_in["log_dt"],
        "A_Dskip": _A_in["Dskip"],
        "B_x": _B_in["x"],
        "B_w_gate": _B_in["w_gate"],
        "B_w_up": _B_in["w_up"],
        "B_w_down": _B_in["w_down"],
    }

def reference(A_x, A_Lambda_re, A_Lambda_im, A_B_re, A_B_im, A_C_re, A_C_im, A_log_dt, A_Dskip, B_x, B_w_gate, B_w_up, B_w_down):
    def _A_ref(x, Lambda_re, Lambda_im, B_re, B_im, C_re, C_im, log_dt, Dskip):
        Bsz, L, H = x.shape
        Lam = Lambda_re + 1j * Lambda_im
        Bmat = B_re + 1j * B_im
        Cmat = C_re + 1j * C_im
        dt = torch.exp(log_dt)
        Lam_bar = torch.exp(dt * Lam)
        B_bar = ((Lam_bar - 1.0) / Lam)[:, None] * Bmat
        Bu = torch.einsum("bld,pd->blp", x + 0j, B_bar)
        h = torch.zeros_like(Bu[:, 0, :])
        hs = []
        for t in range(L):
            h = Lam_bar[None, :] * h + Bu[:, t, :]
            hs.append(h)
        hseq = torch.stack(hs, 1)
        y = 2.0 * torch.einsum("blp,dp->bld", hseq, Cmat).real + x * Dskip[None, None, :]
        return y

    def _B_ref(x, w_gate, w_up, w_down):
        return (_gelu(x @ w_gate) * (x @ w_up)) @ w_down

    x = A_x
    xn = _layernorm(x, axis=-1)
    s = _A_ref(xn, A_Lambda_re, A_Lambda_im, A_B_re, A_B_im, A_C_re, A_C_im, A_log_dt, A_Dskip)
    g = _silu(_B_ref(xn, B_w_gate, B_w_up, B_w_down))
    return x + s * g
```

```asm
; @launch kernel=ln_kernel grid=(512,1,1) block=(256,1,1) lds=0
; @launch kernel=gemm1_kernel grid=(256,1,1) block=(512,1,1) lds=139264
; @launch kernel=scan_kernel grid=(64,1,1) block=(512,1,1) lds=4096
; @launch kernel=gemm2_kernel grid=(256,1,1) block=(512,1,1) lds=98304
.amdgcn_target "amdgcn-amd-amdhsa--gfx950"

.text
.globl ln_kernel
.p2align 8
.type ln_kernel,@function
ln_kernel:
    s_cmp_ge_u32 s2, 512
    s_cbranch_scc1 ln_kernel_end
    s_load_dwordx2 s[4:5], s[0:1], 0
    s_load_dwordx2 s[6:7], s[0:1], 120
    v_lshrrev_b32 v1, 6, v0
    v_and_b32 v2, 63, v0
    s_nop 0
    v_readfirstlane_b32 s3, v1
    s_lshl_b32 s2, s2, 2
    s_nop 2
    s_add_u32 s3, s3, s2
    s_lshl_b32 s3, s3, 11
    v_lshlrev_b32 v3, 4, v2
    v_add_u32 v3, s3, v3
    s_waitcnt lgkmcnt(0)
    s_mov_b32 s8, s4
    s_mov_b32 s9, s5
    s_mov_b32 s10, 0x400000
    s_mov_b32 s11, 0x20000
    s_add_u32 s12, s6, 0
    s_addc_u32 s13, s7, 0
    s_mov_b32 s14, 0x400000
    s_mov_b32 s15, 0x20000
    buffer_load_dwordx4 v[4:7], v3, s[8:11], 0 offen
    buffer_load_dwordx4 v[8:11], v3, s[8:11], 0 offen offset:1024
    s_waitcnt vmcnt(0)
    v_lshlrev_b32 v16, 16, v4
    v_and_b32 v17, 0xffff0000, v4
    v_lshlrev_b32 v18, 16, v5
    v_and_b32 v19, 0xffff0000, v5
    v_lshlrev_b32 v20, 16, v6
    v_and_b32 v21, 0xffff0000, v6
    v_lshlrev_b32 v22, 16, v7
    v_and_b32 v23, 0xffff0000, v7
    v_lshlrev_b32 v24, 16, v8
    v_and_b32 v25, 0xffff0000, v8
    v_lshlrev_b32 v26, 16, v9
    v_and_b32 v27, 0xffff0000, v9
    v_lshlrev_b32 v28, 16, v10
    v_and_b32 v29, 0xffff0000, v10
    v_lshlrev_b32 v30, 16, v11
    v_and_b32 v31, 0xffff0000, v11
    v_add_f32 v12, v16, v17
    v_add_f32 v12, v12, v18
    v_add_f32 v12, v12, v19
    v_add_f32 v12, v12, v20
    v_add_f32 v12, v12, v21
    v_add_f32 v12, v12, v22
    v_add_f32 v12, v12, v23
    v_add_f32 v12, v12, v24
    v_add_f32 v12, v12, v25
    v_add_f32 v12, v12, v26
    v_add_f32 v12, v12, v27
    v_add_f32 v12, v12, v28
    v_add_f32 v12, v12, v29
    v_add_f32 v12, v12, v30
    v_add_f32 v12, v12, v31
    s_nop 1
    v_add_f32_dpp v13, v12, v12 row_shr:1 row_mask:0xf bank_mask:0xf bound_ctrl:0
    s_nop 1
    v_add_f32_dpp v13, v13, v13 row_shr:2 row_mask:0xf bank_mask:0xf bound_ctrl:0
    s_nop 1
    v_add_f32_dpp v13, v13, v13 row_shr:4 row_mask:0xf bank_mask:0xf bound_ctrl:0
    s_nop 1
    v_add_f32_dpp v13, v13, v13 row_shr:8 row_mask:0xf bank_mask:0xf bound_ctrl:0
    s_nop 1
    v_readlane_b32 s20, v13, 15
    v_readlane_b32 s21, v13, 31
    v_readlane_b32 s22, v13, 47
    v_readlane_b32 s23, v13, 63
    s_nop 3
    v_mov_b32 v13, s20
    v_add_f32 v13, s21, v13
    v_add_f32 v13, s22, v13
    v_add_f32 v13, s23, v13
    v_mul_f32 v13, 0x3a800000, v13
    v_sub_f32 v14, v16, v13
    v_mul_f32 v12, v14, v14
    v_sub_f32 v14, v17, v13
    v_fmac_f32 v12, v14, v14
    v_sub_f32 v14, v18, v13
    v_fmac_f32 v12, v14, v14
    v_sub_f32 v14, v19, v13
    v_fmac_f32 v12, v14, v14
    v_sub_f32 v14, v20, v13
    v_fmac_f32 v12, v14, v14
    v_sub_f32 v14, v21, v13
    v_fmac_f32 v12, v14, v14
    v_sub_f32 v14, v22, v13
    v_fmac_f32 v12, v14, v14
    v_sub_f32 v14, v23, v13
    v_fmac_f32 v12, v14, v14
    v_sub_f32 v14, v24, v13
    v_fmac_f32 v12, v14, v14
    v_sub_f32 v14, v25, v13
    v_fmac_f32 v12, v14, v14
    v_sub_f32 v14, v26, v13
    v_fmac_f32 v12, v14, v14
    v_sub_f32 v14, v27, v13
    v_fmac_f32 v12, v14, v14
    v_sub_f32 v14, v28, v13
    v_fmac_f32 v12, v14, v14
    v_sub_f32 v14, v29, v13
    v_fmac_f32 v12, v14, v14
    v_sub_f32 v14, v30, v13
    v_fmac_f32 v12, v14, v14
    v_sub_f32 v14, v31, v13
    v_fmac_f32 v12, v14, v14
    s_nop 1
    v_add_f32_dpp v15, v12, v12 row_shr:1 row_mask:0xf bank_mask:0xf bound_ctrl:0
    s_nop 1
    v_add_f32_dpp v15, v15, v15 row_shr:2 row_mask:0xf bank_mask:0xf bound_ctrl:0
    s_nop 1
    v_add_f32_dpp v15, v15, v15 row_shr:4 row_mask:0xf bank_mask:0xf bound_ctrl:0
    s_nop 1
    v_add_f32_dpp v15, v15, v15 row_shr:8 row_mask:0xf bank_mask:0xf bound_ctrl:0
    s_nop 1
    v_readlane_b32 s20, v15, 15
    v_readlane_b32 s21, v15, 31
    v_readlane_b32 s22, v15, 47
    v_readlane_b32 s23, v15, 63
    s_nop 3
    v_mov_b32 v15, s20
    v_add_f32 v15, s21, v15
    v_add_f32 v15, s22, v15
    v_add_f32 v15, s23, v15
    v_mul_f32 v15, 0x3a800000, v15
    v_cvt_pk_bf16_f32 v40, v13, v15
    v_lshlrev_b32 v13, 16, v40
    v_and_b32 v15, 0xffff0000, v40
    v_add_f32 v15, 0x3727c5ac, v15
    v_cvt_pk_bf16_f32 v40, v15, v15
    v_lshlrev_b32 v15, 16, v40
    v_sqrt_f32 v15, v15
    s_nop 0
    v_cvt_pk_bf16_f32 v40, v15, v15
    v_lshlrev_b32 v15, 16, v40
    v_rcp_f32 v41, v15
    s_nop 0
    v_sub_f32 v16, v16, v13
    v_cvt_pk_bf16_f32 v40, v16, v16
    v_lshlrev_b32 v16, 16, v40
    v_mul_f32 v42, v16, v41
    v_fma_f32 v43, -v42, v15, v16
    v_fma_f32 v16, v43, v41, v42
    v_sub_f32 v17, v17, v13
    v_cvt_pk_bf16_f32 v40, v17, v17
    v_lshlrev_b32 v17, 16, v40
    v_mul_f32 v42, v17, v41
    v_fma_f32 v43, -v42, v15, v17
    v_fma_f32 v17, v43, v41, v42
    v_sub_f32 v18, v18, v13
    v_cvt_pk_bf16_f32 v40, v18, v18
    v_lshlrev_b32 v18, 16, v40
    v_mul_f32 v42, v18, v41
    v_fma_f32 v43, -v42, v15, v18
    v_fma_f32 v18, v43, v41, v42
    v_sub_f32 v19, v19, v13
    v_cvt_pk_bf16_f32 v40, v19, v19
    v_lshlrev_b32 v19, 16, v40
    v_mul_f32 v42, v19, v41
    v_fma_f32 v43, -v42, v15, v19
    v_fma_f32 v19, v43, v41, v42
    v_sub_f32 v20, v20, v13
    v_cvt_pk_bf16_f32 v40, v20, v20
    v_lshlrev_b32 v20, 16, v40
    v_mul_f32 v42, v20, v41
    v_fma_f32 v43, -v42, v15, v20
    v_fma_f32 v20, v43, v41, v42
    v_sub_f32 v21, v21, v13
    v_cvt_pk_bf16_f32 v40, v21, v21
    v_lshlrev_b32 v21, 16, v40
    v_mul_f32 v42, v21, v41
    v_fma_f32 v43, -v42, v15, v21
    v_fma_f32 v21, v43, v41, v42
    v_sub_f32 v22, v22, v13
    v_cvt_pk_bf16_f32 v40, v22, v22
    v_lshlrev_b32 v22, 16, v40
    v_mul_f32 v42, v22, v41
    v_fma_f32 v43, -v42, v15, v22
    v_fma_f32 v22, v43, v41, v42
    v_sub_f32 v23, v23, v13
    v_cvt_pk_bf16_f32 v40, v23, v23
    v_lshlrev_b32 v23, 16, v40
    v_mul_f32 v42, v23, v41
    v_fma_f32 v43, -v42, v15, v23
    v_fma_f32 v23, v43, v41, v42
    v_sub_f32 v24, v24, v13
    v_cvt_pk_bf16_f32 v40, v24, v24
    v_lshlrev_b32 v24, 16, v40
    v_mul_f32 v42, v24, v41
    v_fma_f32 v43, -v42, v15, v24
    v_fma_f32 v24, v43, v41, v42
    v_sub_f32 v25, v25, v13
    v_cvt_pk_bf16_f32 v40, v25, v25
    v_lshlrev_b32 v25, 16, v40
    v_mul_f32 v42, v25, v41
    v_fma_f32 v43, -v42, v15, v25
    v_fma_f32 v25, v43, v41, v42
    v_sub_f32 v26, v26, v13
    v_cvt_pk_bf16_f32 v40, v26, v26
    v_lshlrev_b32 v26, 16, v40
    v_mul_f32 v42, v26, v41
    v_fma_f32 v43, -v42, v15, v26
    v_fma_f32 v26, v43, v41, v42
    v_sub_f32 v27, v27, v13
    v_cvt_pk_bf16_f32 v40, v27, v27
    v_lshlrev_b32 v27, 16, v40
    v_mul_f32 v42, v27, v41
    v_fma_f32 v43, -v42, v15, v27
    v_fma_f32 v27, v43, v41, v42
    v_sub_f32 v28, v28, v13
    v_cvt_pk_bf16_f32 v40, v28, v28
    v_lshlrev_b32 v28, 16, v40
    v_mul_f32 v42, v28, v41
    v_fma_f32 v43, -v42, v15, v28
    v_fma_f32 v28, v43, v41, v42
    v_sub_f32 v29, v29, v13
    v_cvt_pk_bf16_f32 v40, v29, v29
    v_lshlrev_b32 v29, 16, v40
    v_mul_f32 v42, v29, v41
    v_fma_f32 v43, -v42, v15, v29
    v_fma_f32 v29, v43, v41, v42
    v_sub_f32 v30, v30, v13
    v_cvt_pk_bf16_f32 v40, v30, v30
    v_lshlrev_b32 v30, 16, v40
    v_mul_f32 v42, v30, v41
    v_fma_f32 v43, -v42, v15, v30
    v_fma_f32 v30, v43, v41, v42
    v_sub_f32 v31, v31, v13
    v_cvt_pk_bf16_f32 v40, v31, v31
    v_lshlrev_b32 v31, 16, v40
    v_mul_f32 v42, v31, v41
    v_fma_f32 v43, -v42, v15, v31
    v_fma_f32 v31, v43, v41, v42
    v_cvt_pk_bf16_f32 v4, v16, v17
    v_cvt_pk_bf16_f32 v5, v18, v19
    v_cvt_pk_bf16_f32 v6, v20, v21
    v_cvt_pk_bf16_f32 v7, v22, v23
    v_cvt_pk_bf16_f32 v8, v24, v25
    v_cvt_pk_bf16_f32 v9, v26, v27
    v_cvt_pk_bf16_f32 v10, v28, v29
    v_cvt_pk_bf16_f32 v11, v30, v31
    buffer_store_dwordx4 v[4:7], v3, s[12:15], 0 offen
    buffer_store_dwordx4 v[8:11], v3, s[12:15], 0 offen offset:1024
ln_kernel_end:
    s_endpgm
.section .rodata,"a"
.p2align 6
.amdhsa_kernel ln_kernel
  .amdhsa_next_free_vgpr 48
  .amdhsa_next_free_sgpr 32
  .amdhsa_accum_offset 48
  .amdhsa_group_segment_fixed_size 0
  .amdhsa_kernarg_size 128
  .amdhsa_user_sgpr_count 2
  .amdhsa_user_sgpr_kernarg_segment_ptr 1
  .amdhsa_system_sgpr_workgroup_id_x 1
.end_amdhsa_kernel

.text
.globl gemm1_kernel
.p2align 8
.type gemm1_kernel,@function
gemm1_kernel:
    s_cmp_ge_u32 s2, 256
    s_cbranch_scc1 gemm1_kernel_end
    s_load_dwordx2 s[60:61], s[0:1], 120
    s_load_dwordx2 s[62:63], s[0:1], 80
    s_load_dwordx2 s[64:65], s[0:1], 88
    s_load_dwordx2 s[66:67], s[0:1], 24
    s_load_dwordx2 s[68:69], s[0:1], 32
    v_and_b32 v1, 63, v0
    v_lshrrev_b32 v2, 6, v0
    s_nop 0
    v_readfirstlane_b32 s40, v2
    s_nop 3
    s_and_b32 s56, s2, 7
    s_lshl_b32 s56, s56, 2
    s_lshr_b32 s57, s2, 3
    s_and_b32 s57, s57, 3
    s_add_u32 s56, s56, s57
    s_lshr_b32 s57, s2, 5
    s_lshl_b32 s44, s57, 19
    s_mul_i32 s45, s56, 224
    s_mov_b32 s46, s45
    s_lshl_b32 s47, s56, 16
    s_mov_b32 s48, s47
    s_add_u32 s74, s40, 8
    s_and_b32 s74, s74, 7
    s_lshl_b32 s75, s74, 10
    s_add_u32 s76, s40, 7
    s_and_b32 s76, s76, 7
    s_lshl_b32 s77, s76, 10
    s_add_u32 s78, s40, 1
    s_and_b32 s78, s78, 7
    s_lshl_b32 s79, s78, 10
    s_waitcnt lgkmcnt(0)
    s_mov_b32 s4, s60
    s_mov_b32 s5, s61
    s_mov_b32 s6, 4194304
    s_mov_b32 s7, 0x20000
    s_mov_b32 s8, s62
    s_mov_b32 s9, s63
    s_mov_b32 s10, 7340032
    s_mov_b32 s11, 0x20000
    s_mov_b32 s12, s64
    s_mov_b32 s13, s65
    s_mov_b32 s14, 7340032
    s_mov_b32 s15, 0x20000
    s_mov_b32 s16, s66
    s_mov_b32 s17, s67
    s_mov_b32 s18, 2097152
    s_mov_b32 s19, 0x20000
    s_mov_b32 s20, s68
    s_mov_b32 s21, s69
    s_mov_b32 s22, 2097152
    s_mov_b32 s23, 0x20000
    s_add_u32 s24, s60, 33554432
    s_addc_u32 s25, s61, 0
    s_mov_b32 s26, 14680064
    s_mov_b32 s27, 0x20000
    s_add_u32 s28, s60, 8388608
    s_addc_u32 s29, s61, 0
    s_mov_b32 s30, 8388608
    s_mov_b32 s31, 0x20000
    s_add_u32 s32, s60, 16777216
    s_addc_u32 s33, s61, 0
    s_mov_b32 s34, 8388608
    s_mov_b32 s35, 0x20000
    s_lshl_b32 s96, s74, 6
    s_add_u32 s96, s96, 0
    v_add_u32 v2, s96, v1
    v_lshrrev_b32 v3, 2, v2
    v_lshrrev_b32 v4, 1, v3
    v_xor_b32 v4, v4, v2
    v_and_b32 v4, 3, v4
    v_lshlrev_b32 v4, 4, v4
    s_mov_b32 s96, 2048
    v_mul_lo_u32 v3, v3, s96
    v_add_u32 v5, v3, v4
    s_lshl_b32 s96, s74, 6
    s_add_u32 s96, s96, 512
    v_add_u32 v2, s96, v1
    v_lshrrev_b32 v3, 2, v2
    v_lshrrev_b32 v4, 1, v3
    v_xor_b32 v4, v4, v2
    v_and_b32 v4, 3, v4
    v_lshlrev_b32 v4, 4, v4
    s_mov_b32 s96, 2048
    v_mul_lo_u32 v3, v3, s96
    v_add_u32 v6, v3, v4
    s_lshl_b32 s96, s74, 6
    s_add_u32 s96, s96, 0
    v_add_u32 v2, s96, v1
    s_mov_b32 s96, 306783379
    v_mul_hi_u32 v3, v2, s96
    v_mul_u32_u24 v4, 14, v3
    v_sub_u32 v4, v2, v4
    v_and_b32 v2, 0xfffffff3, v3
    v_lshrrev_b32 v7, 1, v3
    v_and_b32 v7, 4, v7
    v_or_b32 v2, v2, v7
    v_lshlrev_b32 v7, 1, v3
    v_and_b32 v7, 8, v7
    v_or_b32 v3, v2, v7
    v_lshlrev_b32 v4, 4, v4
    s_mov_b32 s96, 7168
    v_mul_lo_u32 v3, v3, s96
    v_add_u32 v7, v3, v4
    s_lshl_b32 s96, s76, 6
    s_add_u32 s96, s96, 0
    v_add_u32 v2, s96, v1
    s_mov_b32 s96, 306783379
    v_mul_hi_u32 v3, v2, s96
    v_mul_u32_u24 v4, 14, v3
    v_sub_u32 v4, v2, v4
    v_and_b32 v2, 0xfffffff3, v3
    v_lshrrev_b32 v8, 1, v3
    v_and_b32 v8, 4, v8
    v_or_b32 v2, v2, v8
    v_lshlrev_b32 v8, 1, v3
    v_and_b32 v8, 8, v8
    v_or_b32 v3, v2, v8
    v_lshlrev_b32 v4, 4, v4
    s_mov_b32 s96, 7168
    v_mul_lo_u32 v3, v3, s96
    v_add_u32 v8, v3, v4
    s_lshl_b32 s96, s78, 6
    s_add_u32 s96, s96, 0
    v_add_u32 v2, s96, v1
    v_lshrrev_b32 v3, 2, v2
    v_lshrrev_b32 v4, 1, v3
    v_xor_b32 v4, v4, v2
    v_and_b32 v4, 3, v4
    v_lshlrev_b32 v4, 4, v4
    s_mov_b32 s96, 2048
    v_mul_lo_u32 v3, v3, s96
    v_add_u32 v9, v3, v4
    s_lshl_b32 s96, s76, 6
    s_add_u32 s96, s96, 0
    v_add_u32 v2, s96, v1
    v_lshrrev_b32 v3, 2, v2
    v_lshrrev_b32 v4, 1, v3
    v_xor_b32 v4, v4, v2
    v_and_b32 v4, 3, v4
    v_lshlrev_b32 v4, 4, v4
    s_mov_b32 s96, 2048
    v_mul_lo_u32 v3, v3, s96
    v_add_u32 v10, v3, v4
    v_lshrrev_b32 v2, 4, v1
    v_lshrrev_b32 v3, 1, v1
    v_xor_b32 v2, v2, v3
    v_and_b32 v2, 3, v2
    v_lshlrev_b32 v2, 4, v2
    v_and_b32 v3, 15, v1
    v_lshlrev_b32 v3, 6, v3
    v_add_u32 v11, v2, v3
    v_add_u32 v11, 0, v11
    s_lshl_b32 s58, s40, 11
    v_add_u32 v11, s58, v11
    v_lshrrev_b32 v2, 4, v1
    v_and_b32 v3, 1, v2
    v_lshlrev_b32 v3, 2, v3
    v_lshrrev_b32 v2, 1, v2
    v_lshlrev_b32 v2, 4, v2
    v_add_u32 v2, v2, v3
    v_bfe_u32 v3, v1, 2, 2
    v_add3_u32 v2, v2, v3, 0
    v_mul_u32_u24 v2, 224, v2
    v_and_b32 v3, 3, v1
    v_lshlrev_b32 v3, 3, v3
    v_add_u32 v12, v2, v3
    v_add_u32 v12, 16384, v12
    v_lshrrev_b32 v2, 4, v1
    v_and_b32 v3, 1, v2
    v_lshlrev_b32 v3, 2, v3
    v_lshrrev_b32 v2, 1, v2
    v_lshlrev_b32 v2, 4, v2
    v_add_u32 v2, v2, v3
    v_bfe_u32 v3, v1, 2, 2
    v_add3_u32 v2, v2, v3, 8
    v_mul_u32_u24 v2, 224, v2
    v_and_b32 v3, 3, v1
    v_lshlrev_b32 v3, 3, v3
    v_add_u32 v13, v2, v3
    v_add_u32 v13, 16384, v13
    v_lshrrev_b32 v2, 4, v1
    v_and_b32 v3, 1, v2
    v_lshlrev_b32 v3, 2, v3
    v_lshrrev_b32 v2, 1, v2
    v_lshlrev_b32 v2, 4, v2
    v_add_u32 v2, v2, v3
    v_bfe_u32 v3, v1, 2, 2
    v_add3_u32 v2, v2, v3, 0
    v_mul_u32_u24 v2, 224, v2
    v_and_b32 v3, 3, v1
    v_lshlrev_b32 v3, 3, v3
    v_add_u32 v14, v2, v3
    v_add_u32 v14, 23552, v14
    v_lshrrev_b32 v2, 4, v1
    v_and_b32 v3, 1, v2
    v_lshlrev_b32 v3, 2, v3
    v_lshrrev_b32 v2, 1, v2
    v_lshlrev_b32 v2, 4, v2
    v_add_u32 v2, v2, v3
    v_bfe_u32 v3, v1, 2, 2
    v_add3_u32 v2, v2, v3, 8
    v_mul_u32_u24 v2, 224, v2
    v_and_b32 v3, 3, v1
    v_lshlrev_b32 v3, 3, v3
    v_add_u32 v15, v2, v3
    v_add_u32 v15, 23552, v15
    v_lshrrev_b32 v2, 4, v1
    v_lshrrev_b32 v3, 1, v1
    v_xor_b32 v2, v2, v3
    v_and_b32 v2, 3, v2
    v_lshlrev_b32 v2, 4, v2
    v_and_b32 v3, 15, v1
    v_lshlrev_b32 v3, 6, v3
    v_add_u32 v16, v2, v3
    v_add_u32 v16, 30720, v16
    v_lshrrev_b32 v2, 4, v1
    v_lshrrev_b32 v3, 1, v1
    v_xor_b32 v2, v2, v3
    v_and_b32 v2, 3, v2
    v_lshlrev_b32 v2, 4, v2
    v_and_b32 v3, 15, v1
    v_lshlrev_b32 v3, 6, v3
    v_add_u32 v17, v2, v3
    v_add_u32 v17, 32768, v17
    v_add_u32 v18, 69632, v11
    v_add_u32 v19, 69632, v12
    v_add_u32 v20, 69632, v13
    v_add_u32 v21, 69632, v14
    v_add_u32 v22, 69632, v15
    v_add_u32 v23, 69632, v16
    v_add_u32 v24, 69632, v17
    v_accvgpr_write_b32 a0, 0
    v_accvgpr_write_b32 a1, 0
    v_accvgpr_write_b32 a2, 0
    v_accvgpr_write_b32 a3, 0
    v_accvgpr_write_b32 a4, 0
    v_accvgpr_write_b32 a5, 0
    v_accvgpr_write_b32 a6, 0
    v_accvgpr_write_b32 a7, 0
    v_accvgpr_write_b32 a8, 0
    v_accvgpr_write_b32 a9, 0
    v_accvgpr_write_b32 a10, 0
    v_accvgpr_write_b32 a11, 0
    v_accvgpr_write_b32 a12, 0
    v_accvgpr_write_b32 a13, 0
    v_accvgpr_write_b32 a14, 0
    v_accvgpr_write_b32 a15, 0
    v_accvgpr_write_b32 a16, 0
    v_accvgpr_write_b32 a17, 0
    v_accvgpr_write_b32 a18, 0
    v_accvgpr_write_b32 a19, 0
    v_accvgpr_write_b32 a20, 0
    v_accvgpr_write_b32 a21, 0
    v_accvgpr_write_b32 a22, 0
    v_accvgpr_write_b32 a23, 0
    v_accvgpr_write_b32 a24, 0
    v_accvgpr_write_b32 a25, 0
    v_accvgpr_write_b32 a26, 0
    v_accvgpr_write_b32 a27, 0
    v_accvgpr_write_b32 a28, 0
    v_accvgpr_write_b32 a29, 0
    v_accvgpr_write_b32 a30, 0
    v_accvgpr_write_b32 a31, 0
    v_accvgpr_write_b32 a32, 0
    v_accvgpr_write_b32 a33, 0
    v_accvgpr_write_b32 a34, 0
    v_accvgpr_write_b32 a35, 0
    v_accvgpr_write_b32 a36, 0
    v_accvgpr_write_b32 a37, 0
    v_accvgpr_write_b32 a38, 0
    v_accvgpr_write_b32 a39, 0
    v_accvgpr_write_b32 a40, 0
    v_accvgpr_write_b32 a41, 0
    v_accvgpr_write_b32 a42, 0
    v_accvgpr_write_b32 a43, 0
    v_accvgpr_write_b32 a44, 0
    v_accvgpr_write_b32 a45, 0
    v_accvgpr_write_b32 a46, 0
    v_accvgpr_write_b32 a47, 0
    v_accvgpr_write_b32 a48, 0
    v_accvgpr_write_b32 a49, 0
    v_accvgpr_write_b32 a50, 0
    v_accvgpr_write_b32 a51, 0
    v_accvgpr_write_b32 a52, 0
    v_accvgpr_write_b32 a53, 0
    v_accvgpr_write_b32 a54, 0
    v_accvgpr_write_b32 a55, 0
    v_accvgpr_write_b32 a56, 0
    v_accvgpr_write_b32 a57, 0
    v_accvgpr_write_b32 a58, 0
    v_accvgpr_write_b32 a59, 0
    v_accvgpr_write_b32 a60, 0
    v_accvgpr_write_b32 a61, 0
    v_accvgpr_write_b32 a62, 0
    v_accvgpr_write_b32 a63, 0
    v_accvgpr_write_b32 a64, 0
    v_accvgpr_write_b32 a65, 0
    v_accvgpr_write_b32 a66, 0
    v_accvgpr_write_b32 a67, 0
    v_accvgpr_write_b32 a68, 0
    v_accvgpr_write_b32 a69, 0
    v_accvgpr_write_b32 a70, 0
    v_accvgpr_write_b32 a71, 0
    v_accvgpr_write_b32 a72, 0
    v_accvgpr_write_b32 a73, 0
    v_accvgpr_write_b32 a74, 0
    v_accvgpr_write_b32 a75, 0
    v_accvgpr_write_b32 a76, 0
    v_accvgpr_write_b32 a77, 0
    v_accvgpr_write_b32 a78, 0
    v_accvgpr_write_b32 a79, 0
    v_accvgpr_write_b32 a80, 0
    v_accvgpr_write_b32 a81, 0
    v_accvgpr_write_b32 a82, 0
    v_accvgpr_write_b32 a83, 0
    v_accvgpr_write_b32 a84, 0
    v_accvgpr_write_b32 a85, 0
    v_accvgpr_write_b32 a86, 0
    v_accvgpr_write_b32 a87, 0
    v_accvgpr_write_b32 a88, 0
    v_accvgpr_write_b32 a89, 0
    v_accvgpr_write_b32 a90, 0
    v_accvgpr_write_b32 a91, 0
    v_accvgpr_write_b32 a92, 0
    v_accvgpr_write_b32 a93, 0
    v_accvgpr_write_b32 a94, 0
    v_accvgpr_write_b32 a95, 0
    v_accvgpr_write_b32 a96, 0
    v_accvgpr_write_b32 a97, 0
    v_accvgpr_write_b32 a98, 0
    v_accvgpr_write_b32 a99, 0
    v_accvgpr_write_b32 a100, 0
    v_accvgpr_write_b32 a101, 0
    v_accvgpr_write_b32 a102, 0
    v_accvgpr_write_b32 a103, 0
    v_accvgpr_write_b32 a104, 0
    v_accvgpr_write_b32 a105, 0
    v_accvgpr_write_b32 a106, 0
    v_accvgpr_write_b32 a107, 0
    v_accvgpr_write_b32 a108, 0
    v_accvgpr_write_b32 a109, 0
    v_accvgpr_write_b32 a110, 0
    v_accvgpr_write_b32 a111, 0
    v_accvgpr_write_b32 a112, 0
    v_accvgpr_write_b32 a113, 0
    v_accvgpr_write_b32 a114, 0
    v_accvgpr_write_b32 a115, 0
    v_accvgpr_write_b32 a116, 0
    v_accvgpr_write_b32 a117, 0
    v_accvgpr_write_b32 a118, 0
    v_accvgpr_write_b32 a119, 0
    v_accvgpr_write_b32 a120, 0
    v_accvgpr_write_b32 a121, 0
    v_accvgpr_write_b32 a122, 0
    v_accvgpr_write_b32 a123, 0
    v_accvgpr_write_b32 a124, 0
    v_accvgpr_write_b32 a125, 0
    v_accvgpr_write_b32 a126, 0
    v_accvgpr_write_b32 a127, 0
    v_accvgpr_write_b32 a128, 0
    v_accvgpr_write_b32 a129, 0
    v_accvgpr_write_b32 a130, 0
    v_accvgpr_write_b32 a131, 0
    v_accvgpr_write_b32 a132, 0
    v_accvgpr_write_b32 a133, 0
    v_accvgpr_write_b32 a134, 0
    v_accvgpr_write_b32 a135, 0
    v_accvgpr_write_b32 a136, 0
    v_accvgpr_write_b32 a137, 0
    v_accvgpr_write_b32 a138, 0
    v_accvgpr_write_b32 a139, 0
    v_accvgpr_write_b32 a140, 0
    v_accvgpr_write_b32 a141, 0
    v_accvgpr_write_b32 a142, 0
    v_accvgpr_write_b32 a143, 0
    s_add_u32 m0, s75, 0
    s_nop 0
    buffer_load_dwordx4 v5, s[4:7], s44 offen lds
    s_add_u32 m0, s75, 8192
    s_nop 0
    buffer_load_dwordx4 v6, s[4:7], s44 offen lds
    s_add_u32 s44, s44, 64
    s_cmp_lt_u32 s75, 7168
    s_cbranch_scc0 L_gemm1_kernel_dskip_1
    s_add_u32 m0, s75, 16384
    s_nop 0
    buffer_load_dwordx4 v7, s[8:11], s45 offen lds
L_gemm1_kernel_dskip_1:
    s_add_u32 s45, s45, 229376
    s_cmp_lt_u32 s77, 7168
    s_cbranch_scc0 L_gemm1_kernel_dskip_2
    s_add_u32 m0, s77, 23552
    s_nop 0
    buffer_load_dwordx4 v8, s[12:15], s46 offen lds
L_gemm1_kernel_dskip_2:
    s_add_u32 s46, s46, 229376
    s_cmp_lt_u32 s79, 2048
    s_cbranch_scc0 L_gemm1_kernel_dskip_3
    s_add_u32 m0, s79, 30720
    s_nop 0
    buffer_load_dwordx4 v9, s[16:19], s47 offen lds
L_gemm1_kernel_dskip_3:
    s_add_u32 s47, s47, 64
    s_cmp_lt_u32 s77, 2048
    s_cbranch_scc0 L_gemm1_kernel_dskip_4
    s_add_u32 m0, s77, 32768
    s_nop 0
    buffer_load_dwordx4 v10, s[20:23], s48 offen lds
L_gemm1_kernel_dskip_4:
    s_add_u32 s48, s48, 64
    s_add_u32 m0, s75, 34816
    s_nop 0
    buffer_load_dwordx4 v5, s[4:7], s44 offen lds
    s_add_u32 m0, s75, 43008
    s_nop 0
    buffer_load_dwordx4 v6, s[4:7], s44 offen lds
    s_add_u32 s44, s44, 64
    s_cmp_lt_u32 s75, 7168
    s_cbranch_scc0 L_gemm1_kernel_dskip_5
    s_add_u32 m0, s75, 51200
    s_nop 0
    buffer_load_dwordx4 v7, s[8:11], s45 offen lds
L_gemm1_kernel_dskip_5:
    s_add_u32 s45, s45, 229376
    s_cmp_lt_u32 s77, 7168
    s_cbranch_scc0 L_gemm1_kernel_dskip_6
    s_add_u32 m0, s77, 58368
    s_nop 0
    buffer_load_dwordx4 v8, s[12:15], s46 offen lds
L_gemm1_kernel_dskip_6:
    s_add_u32 s46, s46, 229376
    s_cmp_lt_u32 s79, 2048
    s_cbranch_scc0 L_gemm1_kernel_dskip_7
    s_add_u32 m0, s79, 65536
    s_nop 0
    buffer_load_dwordx4 v9, s[16:19], s47 offen lds
L_gemm1_kernel_dskip_7:
    s_add_u32 s47, s47, 64
    s_cmp_lt_u32 s77, 2048
    s_cbranch_scc0 L_gemm1_kernel_dskip_8
    s_add_u32 m0, s77, 67584
    s_nop 0
    buffer_load_dwordx4 v10, s[20:23], s48 offen lds
L_gemm1_kernel_dskip_8:
    s_add_u32 s48, s48, 64
    s_lshl_b32 s97, 1, s40
    s_and_b32 s97, s97, 6
    s_cbranch_scc1 L_gemm1_kernel_w_9
    s_waitcnt vmcnt(4)
    s_branch L_gemm1_kernel_w_10
L_gemm1_kernel_w_9:
    s_waitcnt vmcnt(5)
L_gemm1_kernel_w_10:
    s_barrier
    s_add_u32 m0, s75, 69632
    s_nop 0
    buffer_load_dwordx4 v5, s[4:7], s44 offen lds
    s_add_u32 m0, s75, 77824
    s_nop 0
    buffer_load_dwordx4 v6, s[4:7], s44 offen lds
    s_add_u32 s44, s44, 64
    s_cmp_lt_u32 s75, 7168
    s_cbranch_scc0 L_gemm1_kernel_dskip_11
    s_add_u32 m0, s75, 86016
    s_nop 0
    buffer_load_dwordx4 v7, s[8:11], s45 offen lds
L_gemm1_kernel_dskip_11:
    s_add_u32 s45, s45, 229376
    s_cmp_lt_u32 s77, 7168
    s_cbranch_scc0 L_gemm1_kernel_dskip_12
    s_add_u32 m0, s77, 93184
    s_nop 0
    buffer_load_dwordx4 v8, s[12:15], s46 offen lds
L_gemm1_kernel_dskip_12:
    s_add_u32 s46, s46, 229376
    s_cmp_lt_u32 s79, 2048
    s_cbranch_scc0 L_gemm1_kernel_dskip_13
    s_add_u32 m0, s79, 100352
    s_nop 0
    buffer_load_dwordx4 v9, s[16:19], s47 offen lds
L_gemm1_kernel_dskip_13:
    s_add_u32 s47, s47, 64
    s_cmp_lt_u32 s77, 2048
    s_cbranch_scc0 L_gemm1_kernel_dskip_14
    s_add_u32 m0, s77, 102400
    s_nop 0
    buffer_load_dwordx4 v10, s[20:23], s48 offen lds
L_gemm1_kernel_dskip_14:
    s_add_u32 s48, s48, 64
    ds_read_b128 v[28:31], v11 offset:0
    ds_read_b128 v[32:35], v11 offset:1024
    ds_read_b64_tr_b16 v[44:45], v12 offset:0
    ds_read_b64_tr_b16 v[46:47], v13 offset:0
    ds_read_b64_tr_b16 v[48:49], v12 offset:32
    ds_read_b64_tr_b16 v[50:51], v13 offset:32
    ds_read_b64_tr_b16 v[52:53], v12 offset:64
    ds_read_b64_tr_b16 v[54:55], v13 offset:64
    ds_read_b64_tr_b16 v[56:57], v12 offset:96
    ds_read_b64_tr_b16 v[58:59], v13 offset:96
    ds_read_b64_tr_b16 v[60:61], v12 offset:128
    ds_read_b64_tr_b16 v[62:63], v13 offset:128
    ds_read_b64_tr_b16 v[64:65], v12 offset:160
    ds_read_b64_tr_b16 v[66:67], v13 offset:160
    ds_read_b64_tr_b16 v[68:69], v12 offset:192
    ds_read_b64_tr_b16 v[70:71], v13 offset:192
    s_waitcnt lgkmcnt(12)
    v_mfma_f32_16x16x32_bf16 a[0:3], v[44:47], v[28:31], a[0:3]
    v_mfma_f32_16x16x32_bf16 a[4:7], v[44:47], v[32:35], a[4:7]
    ds_read_b64_tr_b16 v[72:73], v14 offset:0
    ds_read_b64_tr_b16 v[74:75], v15 offset:0
    s_waitcnt lgkmcnt(12)
    v_mfma_f32_16x16x32_bf16 a[8:11], v[48:51], v[28:31], a[8:11]
    v_mfma_f32_16x16x32_bf16 a[12:15], v[48:51], v[32:35], a[12:15]
    ds_read_b64_tr_b16 v[76:77], v14 offset:32
    ds_read_b64_tr_b16 v[78:79], v15 offset:32
    s_waitcnt lgkmcnt(12)
    v_mfma_f32_16x16x32_bf16 a[16:19], v[52:55], v[28:31], a[16:19]
    v_mfma_f32_16x16x32_bf16 a[20:23], v[52:55], v[32:35], a[20:23]
    ds_read_b64_tr_b16 v[44:45], v14 offset:64
    ds_read_b64_tr_b16 v[46:47], v15 offset:64
    s_waitcnt lgkmcnt(12)
    v_mfma_f32_16x16x32_bf16 a[24:27], v[56:59], v[28:31], a[24:27]
    v_mfma_f32_16x16x32_bf16 a[28:31], v[56:59], v[32:35], a[28:31]
    ds_read_b64_tr_b16 v[48:49], v14 offset:96
    ds_read_b64_tr_b16 v[50:51], v15 offset:96
    s_waitcnt lgkmcnt(12)
    v_mfma_f32_16x16x32_bf16 a[32:35], v[60:63], v[28:31], a[32:35]
    v_mfma_f32_16x16x32_bf16 a[36:39], v[60:63], v[32:35], a[36:39]
    ds_read_b64_tr_b16 v[52:53], v14 offset:128
    ds_read_b64_tr_b16 v[54:55], v15 offset:128
    s_waitcnt lgkmcnt(12)
    v_mfma_f32_16x16x32_bf16 a[40:43], v[64:67], v[28:31], a[40:43]
    v_mfma_f32_16x16x32_bf16 a[44:47], v[64:67], v[32:35], a[44:47]
    ds_read_b64_tr_b16 v[56:57], v14 offset:160
    ds_read_b64_tr_b16 v[58:59], v15 offset:160
    s_waitcnt lgkmcnt(12)
    v_mfma_f32_16x16x32_bf16 a[48:51], v[68:71], v[28:31], a[48:51]
    v_mfma_f32_16x16x32_bf16 a[52:55], v[68:71], v[32:35], a[52:55]
    ds_read_b64_tr_b16 v[60:61], v14 offset:192
    ds_read_b64_tr_b16 v[62:63], v15 offset:192
    s_waitcnt lgkmcnt(12)
    v_mfma_f32_16x16x32_bf16 a[56:59], v[72:75], v[28:31], a[56:59]
    v_mfma_f32_16x16x32_bf16 a[60:63], v[72:75], v[32:35], a[60:63]
    ds_read_b128 v[64:67], v16 offset:0
    ds_read_b128 v[68:71], v17 offset:0
    s_waitcnt lgkmcnt(12)
    v_mfma_f32_16x16x32_bf16 a[64:67], v[76:79], v[28:31], a[64:67]
    v_mfma_f32_16x16x32_bf16 a[68:71], v[76:79], v[32:35], a[68:71]
    ds_read_b128 v[72:75], v16 offset:1024
    ds_read_b128 v[76:79], v17 offset:1024
    s_waitcnt lgkmcnt(12)
    v_mfma_f32_16x16x32_bf16 a[72:75], v[44:47], v[28:31], a[72:75]
    v_mfma_f32_16x16x32_bf16 a[76:79], v[44:47], v[32:35], a[76:79]
    s_lshl_b32 s97, 1, s40
    s_and_b32 s97, s97, 6
    s_cbranch_scc1 L_gemm1_kernel_w_15
    s_waitcnt vmcnt(4)
    s_branch L_gemm1_kernel_w_16
L_gemm1_kernel_w_15:
    s_waitcnt vmcnt(5)
L_gemm1_kernel_w_16:
    s_barrier
    s_add_u32 m0, s75, 104448
    s_nop 0
    buffer_load_dwordx4 v5, s[4:7], s44 offen lds
    s_add_u32 m0, s75, 112640
    s_nop 0
    buffer_load_dwordx4 v6, s[4:7], s44 offen lds
    s_add_u32 s44, s44, 64
    s_cmp_lt_u32 s75, 7168
    s_cbranch_scc0 L_gemm1_kernel_dskip_17
    s_add_u32 m0, s75, 120832
    s_nop 0
    buffer_load_dwordx4 v7, s[8:11], s45 offen lds
L_gemm1_kernel_dskip_17:
    s_add_u32 s45, s45, 229376
    s_cmp_lt_u32 s77, 7168
    s_cbranch_scc0 L_gemm1_kernel_dskip_18
    s_add_u32 m0, s77, 128000
    s_nop 0
    buffer_load_dwordx4 v8, s[12:15], s46 offen lds
L_gemm1_kernel_dskip_18:
    s_add_u32 s46, s46, 229376
    s_cmp_lt_u32 s79, 2048
    s_cbranch_scc0 L_gemm1_kernel_dskip_19
    s_add_u32 m0, s79, 135168
    s_nop 0
    buffer_load_dwordx4 v9, s[16:19], s47 offen lds
L_gemm1_kernel_dskip_19:
    s_add_u32 s47, s47, 64
    s_cmp_lt_u32 s77, 2048
    s_cbranch_scc0 L_gemm1_kernel_dskip_20
    s_add_u32 m0, s77, 137216
    s_nop 0
    buffer_load_dwordx4 v10, s[20:23], s48 offen lds
L_gemm1_kernel_dskip_20:
    s_add_u32 s48, s48, 64
    ds_read_b128 v[36:39], v11 offset:34816
    ds_read_b128 v[40:43], v11 offset:35840
    s_waitcnt lgkmcnt(12)
    v_mfma_f32_16x16x32_bf16 a[80:83], v[48:51], v[28:31], a[80:83]
    v_mfma_f32_16x16x32_bf16 a[84:87], v[48:51], v[32:35], a[84:87]
    ds_read_b64_tr_b16 v[44:45], v12 offset:34816
    ds_read_b64_tr_b16 v[46:47], v13 offset:34816
    s_waitcnt lgkmcnt(12)
    v_mfma_f32_16x16x32_bf16 a[88:91], v[52:55], v[28:31], a[88:91]
    v_mfma_f32_16x16x32_bf16 a[92:95], v[52:55], v[32:35], a[92:95]
    ds_read_b64_tr_b16 v[48:49], v12 offset:34848
    ds_read_b64_tr_b16 v[50:51], v13 offset:34848
    s_waitcnt lgkmcnt(12)
    v_mfma_f32_16x16x32_bf16 a[96:99], v[56:59], v[28:31], a[96:99]
    v_mfma_f32_16x16x32_bf16 a[100:103], v[56:59], v[32:35], a[100:103]
    ds_read_b64_tr_b16 v[52:53], v12 offset:34880
    ds_read_b64_tr_b16 v[54:55], v13 offset:34880
    s_waitcnt lgkmcnt(12)
    v_mfma_f32_16x16x32_bf16 a[104:107], v[60:63], v[28:31], a[104:107]
    v_mfma_f32_16x16x32_bf16 a[108:111], v[60:63], v[32:35], a[108:111]
    s_waitcnt lgkmcnt(11)
    v_mfma_f32_16x16x32_bf16 a[112:115], v[64:67], v[28:31], a[112:115]
    v_mfma_f32_16x16x32_bf16 a[116:119], v[64:67], v[32:35], a[116:119]
    ds_read_b64_tr_b16 v[56:57], v12 offset:34912
    ds_read_b64_tr_b16 v[58:59], v13 offset:34912
    s_waitcnt lgkmcnt(12)
    v_mfma_f32_16x16x32_bf16 a[120:123], v[68:71], v[28:31], a[120:123]
    v_mfma_f32_16x16x32_bf16 a[124:127], v[68:71], v[32:35], a[124:127]
    s_waitcnt lgkmcnt(11)
    v_mfma_f32_16x16x32_bf16 a[128:131], v[72:75], v[28:31], a[128:131]
    v_mfma_f32_16x16x32_bf16 a[132:135], v[72:75], v[32:35], a[132:135]
    ds_read_b64_tr_b16 v[60:61], v12 offset:34944
    ds_read_b64_tr_b16 v[62:63], v13 offset:34944
    s_waitcnt lgkmcnt(12)
    v_mfma_f32_16x16x32_bf16 a[136:139], v[76:79], v[28:31], a[136:139]
    v_mfma_f32_16x16x32_bf16 a[140:143], v[76:79], v[32:35], a[140:143]
    ds_read_b64_tr_b16 v[64:65], v12 offset:34976
    ds_read_b64_tr_b16 v[66:67], v13 offset:34976
    ds_read_b64_tr_b16 v[68:69], v12 offset:35008
    ds_read_b64_tr_b16 v[70:71], v13 offset:35008
    s_waitcnt lgkmcnt(12)
    v_mfma_f32_16x16x32_bf16 a[0:3], v[44:47], v[36:39], a[0:3]
    v_mfma_f32_16x16x32_bf16 a[4:7], v[44:47], v[40:43], a[4:7]
    ds_read_b64_tr_b16 v[72:73], v14 offset:34816
    ds_read_b64_tr_b16 v[74:75], v15 offset:34816
    s_waitcnt lgkmcnt(12)
    v_mfma_f32_16x16x32_bf16 a[8:11], v[48:51], v[36:39], a[8:11]
    v_mfma_f32_16x16x32_bf16 a[12:15], v[48:51], v[40:43], a[12:15]
    ds_read_b64_tr_b16 v[76:77], v14 offset:34848
    ds_read_b64_tr_b16 v[78:79], v15 offset:34848
    s_waitcnt lgkmcnt(12)
    v_mfma_f32_16x16x32_bf16 a[16:19], v[52:55], v[36:39], a[16:19]
    v_mfma_f32_16x16x32_bf16 a[20:23], v[52:55], v[40:43], a[20:23]
    ds_read_b64_tr_b16 v[44:45], v14 offset:34880
    ds_read_b64_tr_b16 v[46:47], v15 offset:34880
    s_waitcnt lgkmcnt(12)
    v_mfma_f32_16x16x32_bf16 a[24:27], v[56:59], v[36:39], a[24:27]
    v_mfma_f32_16x16x32_bf16 a[28:31], v[56:59], v[40:43], a[28:31]
    ds_read_b64_tr_b16 v[48:49], v14 offset:34912
    ds_read_b64_tr_b16 v[50:51], v15 offset:34912
    s_waitcnt lgkmcnt(12)
    v_mfma_f32_16x16x32_bf16 a[32:35], v[60:63], v[36:39], a[32:35]
    v_mfma_f32_16x16x32_bf16 a[36:39], v[60:63], v[40:43], a[36:39]
    ds_read_b64_tr_b16 v[52:53], v14 offset:34944
    ds_read_b64_tr_b16 v[54:55], v15 offset:34944
    s_waitcnt lgkmcnt(12)
    v_mfma_f32_16x16x32_bf16 a[40:43], v[64:67], v[36:39], a[40:43]
    v_mfma_f32_16x16x32_bf16 a[44:47], v[64:67], v[40:43], a[44:47]
    ds_read_b64_tr_b16 v[56:57], v14 offset:34976
    ds_read_b64_tr_b16 v[58:59], v15 offset:34976
    s_waitcnt lgkmcnt(12)
    v_mfma_f32_16x16x32_bf16 a[48:51], v[68:71], v[36:39], a[48:51]
    v_mfma_f32_16x16x32_bf16 a[52:55], v[68:71], v[40:43], a[52:55]
    ds_read_b64_tr_b16 v[60:61], v14 offset:35008
    ds_read_b64_tr_b16 v[62:63], v15 offset:35008
    s_waitcnt lgkmcnt(12)
    v_mfma_f32_16x16x32_bf16 a[56:59], v[72:75], v[36:39], a[56:59]
    v_mfma_f32_16x16x32_bf16 a[60:63], v[72:75], v[40:43], a[60:63]
    ds_read_b128 v[64:67], v16 offset:34816
    ds_read_b128 v[68:71], v17 offset:34816
    s_waitcnt lgkmcnt(12)
    v_mfma_f32_16x16x32_bf16 a[64:67], v[76:79], v[36:39], a[64:67]
    v_mfma_f32_16x16x32_bf16 a[68:71], v[76:79], v[40:43], a[68:71]
    ds_read_b128 v[72:75], v16 offset:35840
    ds_read_b128 v[76:79], v17 offset:35840
    s_waitcnt lgkmcnt(12)
    v_mfma_f32_16x16x32_bf16 a[72:75], v[44:47], v[36:39], a[72:75]
    v_mfma_f32_16x16x32_bf16 a[76:79], v[44:47], v[40:43], a[76:79]
    s_lshl_b32 s97, 1, s40
    s_and_b32 s97, s97, 6
    s_cbranch_scc1 L_gemm1_kernel_w_21
    s_waitcnt vmcnt(4)
    s_branch L_gemm1_kernel_w_22
L_gemm1_kernel_w_21:
    s_waitcnt vmcnt(5)
L_gemm1_kernel_w_22:
    s_barrier
    s_add_u32 m0, s75, 0
    s_nop 0
    buffer_load_dwordx4 v5, s[4:7], s44 offen lds
    s_add_u32 m0, s75, 8192
    s_nop 0
    buffer_load_dwordx4 v6, s[4:7], s44 offen lds
    s_add_u32 s44, s44, 64
    s_cmp_lt_u32 s75, 7168
    s_cbranch_scc0 L_gemm1_kernel_dskip_23
    s_add_u32 m0, s75, 16384
    s_nop 0
    buffer_load_dwordx4 v7, s[8:11], s45 offen lds
L_gemm1_kernel_dskip_23:
    s_add_u32 s45, s45, 229376
    s_cmp_lt_u32 s77, 7168
    s_cbranch_scc0 L_gemm1_kernel_dskip_24
    s_add_u32 m0, s77, 23552
    s_nop 0
    buffer_load_dwordx4 v8, s[12:15], s46 offen lds
L_gemm1_kernel_dskip_24:
    s_add_u32 s46, s46, 229376
    s_cmp_lt_u32 s79, 2048
    s_cbranch_scc0 L_gemm1_kernel_dskip_25
    s_add_u32 m0, s79, 30720
    s_nop 0
    buffer_load_dwordx4 v9, s[16:19], s47 offen lds
L_gemm1_kernel_dskip_25:
    s_add_u32 s47, s47, 64
    s_cmp_lt_u32 s77, 2048
    s_cbranch_scc0 L_gemm1_kernel_dskip_26
    s_add_u32 m0, s77, 32768
    s_nop 0
    buffer_load_dwordx4 v10, s[20:23], s48 offen lds
L_gemm1_kernel_dskip_26:
    s_add_u32 s48, s48, 64
    ds_read_b128 v[28:31], v18 offset:0
    ds_read_b128 v[32:35], v18 offset:1024
    s_waitcnt lgkmcnt(12)
    v_mfma_f32_16x16x32_bf16 a[80:83], v[48:51], v[36:39], a[80:83]
    v_mfma_f32_16x16x32_bf16 a[84:87], v[48:51], v[40:43], a[84:87]
    ds_read_b64_tr_b16 v[44:45], v19 offset:0
    ds_read_b64_tr_b16 v[46:47], v20 offset:0
    s_waitcnt lgkmcnt(12)
    v_mfma_f32_16x16x32_bf16 a[88:91], v[52:55], v[36:39], a[88:91]
    v_mfma_f32_16x16x32_bf16 a[92:95], v[52:55], v[40:43], a[92:95]
    ds_read_b64_tr_b16 v[48:49], v19 offset:32
    ds_read_b64_tr_b16 v[50:51], v20 offset:32
    s_waitcnt lgkmcnt(12)
    v_mfma_f32_16x16x32_bf16 a[96:99], v[56:59], v[36:39], a[96:99]
    v_mfma_f32_16x16x32_bf16 a[100:103], v[56:59], v[40:43], a[100:103]
    ds_read_b64_tr_b16 v[52:53], v19 offset:64
    ds_read_b64_tr_b16 v[54:55], v20 offset:64
    s_waitcnt lgkmcnt(12)
    v_mfma_f32_16x16x32_bf16 a[104:107], v[60:63], v[36:39], a[104:107]
    v_mfma_f32_16x16x32_bf16 a[108:111], v[60:63], v[40:43], a[108:111]
    s_waitcnt lgkmcnt(11)
    v_mfma_f32_16x16x32_bf16 a[112:115], v[64:67], v[36:39], a[112:115]
    v_mfma_f32_16x16x32_bf16 a[116:119], v[64:67], v[40:43], a[116:119]
    ds_read_b64_tr_b16 v[56:57], v19 offset:96
    ds_read_b64_tr_b16 v[58:59], v20 offset:96
    s_waitcnt lgkmcnt(12)
    v_mfma_f32_16x16x32_bf16 a[120:123], v[68:71], v[36:39], a[120:123]
    v_mfma_f32_16x16x32_bf16 a[124:127], v[68:71], v[40:43], a[124:127]
    s_waitcnt lgkmcnt(11)
    v_mfma_f32_16x16x32_bf16 a[128:131], v[72:75], v[36:39], a[128:131]
    v_mfma_f32_16x16x32_bf16 a[132:135], v[72:75], v[40:43], a[132:135]
    ds_read_b64_tr_b16 v[60:61], v19 offset:128
    ds_read_b64_tr_b16 v[62:63], v20 offset:128
    s_waitcnt lgkmcnt(12)
    v_mfma_f32_16x16x32_bf16 a[136:139], v[76:79], v[36:39], a[136:139]
    v_mfma_f32_16x16x32_bf16 a[140:143], v[76:79], v[40:43], a[140:143]
    ds_read_b64_tr_b16 v[64:65], v19 offset:160
    ds_read_b64_tr_b16 v[66:67], v20 offset:160
    ds_read_b64_tr_b16 v[68:69], v19 offset:192
    ds_read_b64_tr_b16 v[70:71], v20 offset:192
    s_waitcnt lgkmcnt(12)
    v_mfma_f32_16x16x32_bf16 a[0:3], v[44:47], v[28:31], a[0:3]
    v_mfma_f32_16x16x32_bf16 a[4:7], v[44:47], v[32:35], a[4:7]
    ds_read_b64_tr_b16 v[72:73], v21 offset:0
    ds_read_b64_tr_b16 v[74:75], v22 offset:0
    s_waitcnt lgkmcnt(12)
    v_mfma_f32_16x16x32_bf16 a[8:11], v[48:51], v[28:31], a[8:11]
    v_mfma_f32_16x16x32_bf16 a[12:15], v[48:51], v[32:35], a[12:15]
    ds_read_b64_tr_b16 v[76:77], v21 offset:32
    ds_read_b64_tr_b16 v[78:79], v22 offset:32
    s_waitcnt lgkmcnt(12)
    v_mfma_f32_16x16x32_bf16 a[16:19], v[52:55], v[28:31], a[16:19]
    v_mfma_f32_16x16x32_bf16 a[20:23], v[52:55], v[32:35], a[20:23]
    ds_read_b64_tr_b16 v[44:45], v21 offset:64
    ds_read_b64_tr_b16 v[46:47], v22 offset:64
    s_waitcnt lgkmcnt(12)
    v_mfma_f32_16x16x32_bf16 a[24:27], v[56:59], v[28:31], a[24:27]
    v_mfma_f32_16x16x32_bf16 a[28:31], v[56:59], v[32:35], a[28:31]
    ds_read_b64_tr_b16 v[48:49], v21 offset:96
    ds_read_b64_tr_b16 v[50:51], v22 offset:96
    s_waitcnt lgkmcnt(12)
    v_mfma_f32_16x16x32_bf16 a[32:35], v[60:63], v[28:31], a[32:35]
    v_mfma_f32_16x16x32_bf16 a[36:39], v[60:63], v[32:35], a[36:39]
    ds_read_b64_tr_b16 v[52:53], v21 offset:128
    ds_read_b64_tr_b16 v[54:55], v22 offset:128
    s_waitcnt lgkmcnt(12)
    v_mfma_f32_16x16x32_bf16 a[40:43], v[64:67], v[28:31], a[40:43]
    v_mfma_f32_16x16x32_bf16 a[44:47], v[64:67], v[32:35], a[44:47]
    ds_read_b64_tr_b16 v[56:57], v21 offset:160
    ds_read_b64_tr_b16 v[58:59], v22 offset:160
    s_waitcnt lgkmcnt(12)
    v_mfma_f32_16x16x32_bf16 a[48:51], v[68:71], v[28:31], a[48:51]
    v_mfma_f32_16x16x32_bf16 a[52:55], v[68:71], v[32:35], a[52:55]
    ds_read_b64_tr_b16 v[60:61], v21 offset:192
    ds_read_b64_tr_b16 v[62:63], v22 offset:192
    s_waitcnt lgkmcnt(12)
    v_mfma_f32_16x16x32_bf16 a[56:59], v[72:75], v[28:31], a[56:59]
    v_mfma_f32_16x16x32_bf16 a[60:63], v[72:75], v[32:35], a[60:63]
    ds_read_b128 v[64:67], v23 offset:0
    ds_read_b128 v[68:71], v24 offset:0
    s_waitcnt lgkmcnt(12)
    v_mfma_f32_16x16x32_bf16 a[64:67], v[76:79], v[28:31], a[64:67]
    v_mfma_f32_16x16x32_bf16 a[68:71], v[76:79], v[32:35], a[68:71]
    ds_read_b128 v[72:75], v23 offset:1024
    ds_read_b128 v[76:79], v24 offset:1024
    s_waitcnt lgkmcnt(12)
    v_mfma_f32_16x16x32_bf16 a[72:75], v[44:47], v[28:31], a[72:75]
    v_mfma_f32_16x16x32_bf16 a[76:79], v[44:47], v[32:35], a[76:79]
    s_lshl_b32 s97, 1, s40
    s_and_b32 s97, s97, 6
    s_cbranch_scc1 L_gemm1_kernel_w_27
    s_waitcnt vmcnt(4)
    s_branch L_gemm1_kernel_w_28
L_gemm1_kernel_w_27:
    s_waitcnt vmcnt(5)
L_gemm1_kernel_w_28:
    s_barrier
    s_add_u32 m0, s75, 34816
    s_nop 0
    buffer_load_dwordx4 v5, s[4:7], s44 offen lds
    s_add_u32 m0, s75, 43008
    s_nop 0
    buffer_load_dwordx4 v6, s[4:7], s44 offen lds
    s_add_u32 s44, s44, 64
    s_cmp_lt_u32 s75, 7168
    s_cbranch_scc0 L_gemm1_kernel_dskip_29
    s_add_u32 m0, s75, 51200
    s_nop 0
    buffer_load_dwordx4 v7, s[8:11], s45 offen lds
L_gemm1_kernel_dskip_29:
    s_add_u32 s45, s45, 229376
    s_cmp_lt_u32 s77, 7168
    s_cbranch_scc0 L_gemm1_kernel_dskip_30
    s_add_u32 m0, s77, 58368
    s_nop 0
    buffer_load_dwordx4 v8, s[12:15], s46 offen lds
L_gemm1_kernel_dskip_30:
    s_add_u32 s46, s46, 229376
    s_cmp_lt_u32 s79, 2048
    s_cbranch_scc0 L_gemm1_kernel_dskip_31
    s_add_u32 m0, s79, 65536
    s_nop 0
    buffer_load_dwordx4 v9, s[16:19], s47 offen lds
L_gemm1_kernel_dskip_31:
    s_add_u32 s47, s47, 64
    s_cmp_lt_u32 s77, 2048
    s_cbranch_scc0 L_gemm1_kernel_dskip_32
    s_add_u32 m0, s77, 67584
    s_nop 0
    buffer_load_dwordx4 v10, s[20:23], s48 offen lds
L_gemm1_kernel_dskip_32:
    s_add_u32 s48, s48, 64
    ds_read_b128 v[36:39], v18 offset:34816
    ds_read_b128 v[40:43], v18 offset:35840
    s_waitcnt lgkmcnt(12)
    v_mfma_f32_16x16x32_bf16 a[80:83], v[48:51], v[28:31], a[80:83]
    v_mfma_f32_16x16x32_bf16 a[84:87], v[48:51], v[32:35], a[84:87]
    ds_read_b64_tr_b16 v[44:45], v19 offset:34816
    ds_read_b64_tr_b16 v[46:47], v20 offset:34816
    s_waitcnt lgkmcnt(12)
    v_mfma_f32_16x16x32_bf16 a[88:91], v[52:55], v[28:31], a[88:91]
    v_mfma_f32_16x16x32_bf16 a[92:95], v[52:55], v[32:35], a[92:95]
    ds_read_b64_tr_b16 v[48:49], v19 offset:34848
    ds_read_b64_tr_b16 v[50:51], v20 offset:34848
    s_waitcnt lgkmcnt(12)
    v_mfma_f32_16x16x32_bf16 a[96:99], v[56:59], v[28:31], a[96:99]
    v_mfma_f32_16x16x32_bf16 a[100:103], v[56:59], v[32:35], a[100:103]
    ds_read_b64_tr_b16 v[52:53], v19 offset:34880
    ds_read_b64_tr_b16 v[54:55], v20 offset:34880
    s_waitcnt lgkmcnt(12)
    v_mfma_f32_16x16x32_bf16 a[104:107], v[60:63], v[28:31], a[104:107]
    v_mfma_f32_16x16x32_bf16 a[108:111], v[60:63], v[32:35], a[108:111]
    s_waitcnt lgkmcnt(11)
    v_mfma_f32_16x16x32_bf16 a[112:115], v[64:67], v[28:31], a[112:115]
    v_mfma_f32_16x16x32_bf16 a[116:119], v[64:67], v[32:35], a[116:119]
    ds_read_b64_tr_b16 v[56:57], v19 offset:34912
    ds_read_b64_tr_b16 v[58:59], v20 offset:34912
    s_waitcnt lgkmcnt(12)
    v_mfma_f32_16x16x32_bf16 a[120:123], v[68:71], v[28:31], a[120:123]
    v_mfma_f32_16x16x32_bf16 a[124:127], v[68:71], v[32:35], a[124:127]
    s_waitcnt lgkmcnt(11)
    v_mfma_f32_16x16x32_bf16 a[128:131], v[72:75], v[28:31], a[128:131]
    v_mfma_f32_16x16x32_bf16 a[132:135], v[72:75], v[32:35], a[132:135]
    ds_read_b64_tr_b16 v[60:61], v19 offset:34944
    ds_read_b64_tr_b16 v[62:63], v20 offset:34944
    s_waitcnt lgkmcnt(12)
    v_mfma_f32_16x16x32_bf16 a[136:139], v[76:79], v[28:31], a[136:139]
    v_mfma_f32_16x16x32_bf16 a[140:143], v[76:79], v[32:35], a[140:143]
    ds_read_b64_tr_b16 v[64:65], v19 offset:34976
    ds_read_b64_tr_b16 v[66:67], v20 offset:34976
    ds_read_b64_tr_b16 v[68:69], v19 offset:35008
    ds_read_b64_tr_b16 v[70:71], v20 offset:35008
    s_waitcnt lgkmcnt(12)
    v_mfma_f32_16x16x32_bf16 a[0:3], v[44:47], v[36:39], a[0:3]
    v_mfma_f32_16x16x32_bf16 a[4:7], v[44:47], v[40:43], a[4:7]
    ds_read_b64_tr_b16 v[72:73], v21 offset:34816
    ds_read_b64_tr_b16 v[74:75], v22 offset:34816
    s_waitcnt lgkmcnt(12)
    v_mfma_f32_16x16x32_bf16 a[8:11], v[48:51], v[36:39], a[8:11]
    v_mfma_f32_16x16x32_bf16 a[12:15], v[48:51], v[40:43], a[12:15]
    ds_read_b64_tr_b16 v[76:77], v21 offset:34848
    ds_read_b64_tr_b16 v[78:79], v22 offset:34848
    s_waitcnt lgkmcnt(12)
    v_mfma_f32_16x16x32_bf16 a[16:19], v[52:55], v[36:39], a[16:19]
    v_mfma_f32_16x16x32_bf16 a[20:23], v[52:55], v[40:43], a[20:23]
    ds_read_b64_tr_b16 v[44:45], v21 offset:34880
    ds_read_b64_tr_b16 v[46:47], v22 offset:34880
    s_waitcnt lgkmcnt(12)
    v_mfma_f32_16x16x32_bf16 a[24:27], v[56:59], v[36:39], a[24:27]
    v_mfma_f32_16x16x32_bf16 a[28:31], v[56:59], v[40:43], a[28:31]
    ds_read_b64_tr_b16 v[48:49], v21 offset:34912
    ds_read_b64_tr_b16 v[50:51], v22 offset:34912
    s_waitcnt lgkmcnt(12)
    v_mfma_f32_16x16x32_bf16 a[32:35], v[60:63], v[36:39], a[32:35]
    v_mfma_f32_16x16x32_bf16 a[36:39], v[60:63], v[40:43], a[36:39]
    ds_read_b64_tr_b16 v[52:53], v21 offset:34944
    ds_read_b64_tr_b16 v[54:55], v22 offset:34944
    s_waitcnt lgkmcnt(12)
    v_mfma_f32_16x16x32_bf16 a[40:43], v[64:67], v[36:39], a[40:43]
    v_mfma_f32_16x16x32_bf16 a[44:47], v[64:67], v[40:43], a[44:47]
    ds_read_b64_tr_b16 v[56:57], v21 offset:34976
    ds_read_b64_tr_b16 v[58:59], v22 offset:34976
    s_waitcnt lgkmcnt(12)
    v_mfma_f32_16x16x32_bf16 a[48:51], v[68:71], v[36:39], a[48:51]
    v_mfma_f32_16x16x32_bf16 a[52:55], v[68:71], v[40:43], a[52:55]
    ds_read_b64_tr_b16 v[60:61], v21 offset:35008
    ds_read_b64_tr_b16 v[62:63], v22 offset:35008
    s_waitcnt lgkmcnt(12)
    v_mfma_f32_16x16x32_bf16 a[56:59], v[72:75], v[36:39], a[56:59]
    v_mfma_f32_16x16x32_bf16 a[60:63], v[72:75], v[40:43], a[60:63]
    ds_read_b128 v[64:67], v23 offset:34816
    ds_read_b128 v[68:71], v24 offset:34816
    s_waitcnt lgkmcnt(12)
    v_mfma_f32_16x16x32_bf16 a[64:67], v[76:79], v[36:39], a[64:67]
    v_mfma_f32_16x16x32_bf16 a[68:71], v[76:79], v[40:43], a[68:71]
    ds_read_b128 v[72:75], v23 offset:35840
    ds_read_b128 v[76:79], v24 offset:35840
    s_waitcnt lgkmcnt(12)
    v_mfma_f32_16x16x32_bf16 a[72:75], v[44:47], v[36:39], a[72:75]
    v_mfma_f32_16x16x32_bf16 a[76:79], v[44:47], v[40:43], a[76:79]
    s_lshl_b32 s97, 1, s40
    s_and_b32 s97, s97, 6
    s_cbranch_scc1 L_gemm1_kernel_w_33
    s_waitcnt vmcnt(4)
    s_branch L_gemm1_kernel_w_34
L_gemm1_kernel_w_33:
    s_waitcnt vmcnt(5)
L_gemm1_kernel_w_34:
    s_barrier
    s_add_u32 m0, s75, 69632
    s_nop 0
    buffer_load_dwordx4 v5, s[4:7], s44 offen lds
    s_add_u32 m0, s75, 77824
    s_nop 0
    buffer_load_dwordx4 v6, s[4:7], s44 offen lds
    s_add_u32 s44, s44, 64
    s_cmp_lt_u32 s75, 7168
    s_cbranch_scc0 L_gemm1_kernel_dskip_35
    s_add_u32 m0, s75, 86016
    s_nop 0
    buffer_load_dwordx4 v7, s[8:11], s45 offen lds
L_gemm1_kernel_dskip_35:
    s_add_u32 s45, s45, 229376
    s_cmp_lt_u32 s77, 7168
    s_cbranch_scc0 L_gemm1_kernel_dskip_36
    s_add_u32 m0, s77, 93184
    s_nop 0
    buffer_load_dwordx4 v8, s[12:15], s46 offen lds
L_gemm1_kernel_dskip_36:
    s_add_u32 s46, s46, 229376
    s_cmp_lt_u32 s79, 2048
    s_cbranch_scc0 L_gemm1_kernel_dskip_37
    s_add_u32 m0, s79, 100352
    s_nop 0
    buffer_load_dwordx4 v9, s[16:19], s47 offen lds
L_gemm1_kernel_dskip_37:
    s_add_u32 s47, s47, 64
    s_cmp_lt_u32 s77, 2048
    s_cbranch_scc0 L_gemm1_kernel_dskip_38
    s_add_u32 m0, s77, 102400
    s_nop 0
    buffer_load_dwordx4 v10, s[20:23], s48 offen lds
L_gemm1_kernel_dskip_38:
    s_add_u32 s48, s48, 64
    ds_read_b128 v[28:31], v11 offset:0
    ds_read_b128 v[32:35], v11 offset:1024
    s_waitcnt lgkmcnt(12)
    v_mfma_f32_16x16x32_bf16 a[80:83], v[48:51], v[36:39], a[80:83]
    v_mfma_f32_16x16x32_bf16 a[84:87], v[48:51], v[40:43], a[84:87]
    ds_read_b64_tr_b16 v[44:45], v12 offset:0
    ds_read_b64_tr_b16 v[46:47], v13 offset:0
    s_waitcnt lgkmcnt(12)
    v_mfma_f32_16x16x32_bf16 a[88:91], v[52:55], v[36:39], a[88:91]
    v_mfma_f32_16x16x32_bf16 a[92:95], v[52:55], v[40:43], a[92:95]
    ds_read_b64_tr_b16 v[48:49], v12 offset:32
    ds_read_b64_tr_b16 v[50:51], v13 offset:32
    s_waitcnt lgkmcnt(12)
    v_mfma_f32_16x16x32_bf16 a[96:99], v[56:59], v[36:39], a[96:99]
    v_mfma_f32_16x16x32_bf16 a[100:103], v[56:59], v[40:43], a[100:103]
    ds_read_b64_tr_b16 v[52:53], v12 offset:64
    ds_read_b64_tr_b16 v[54:55], v13 offset:64
    s_waitcnt lgkmcnt(12)
    v_mfma_f32_16x16x32_bf16 a[104:107], v[60:63], v[36:39], a[104:107]
    v_mfma_f32_16x16x32_bf16 a[108:111], v[60:63], v[40:43], a[108:111]
    s_waitcnt lgkmcnt(11)
    v_mfma_f32_16x16x32_bf16 a[112:115], v[64:67], v[36:39], a[112:115]
    v_mfma_f32_16x16x32_bf16 a[116:119], v[64:67], v[40:43], a[116:119]
    ds_read_b64_tr_b16 v[56:57], v12 offset:96
    ds_read_b64_tr_b16 v[58:59], v13 offset:96
    s_waitcnt lgkmcnt(12)
    v_mfma_f32_16x16x32_bf16 a[120:123], v[68:71], v[36:39], a[120:123]
    v_mfma_f32_16x16x32_bf16 a[124:127], v[68:71], v[40:43], a[124:127]
    s_waitcnt lgkmcnt(11)
    v_mfma_f32_16x16x32_bf16 a[128:131], v[72:75], v[36:39], a[128:131]
    v_mfma_f32_16x16x32_bf16 a[132:135], v[72:75], v[40:43], a[132:135]
    s_waitcnt lgkmcnt(10)
    v_mfma_f32_16x16x32_bf16 a[136:139], v[76:79], v[36:39], a[136:139]
    v_mfma_f32_16x16x32_bf16 a[140:143], v[76:79], v[40:43], a[140:143]
    s_mov_b32 s59, 1
L_gemm1_kernel_loop_39:
    ds_read_b64_tr_b16 v[60:61], v12 offset:128
    ds_read_b64_tr_b16 v[62:63], v13 offset:128
    ds_read_b64_tr_b16 v[64:65], v12 offset:160
    ds_read_b64_tr_b16 v[66:67], v13 offset:160
    ds_read_b64_tr_b16 v[68:69], v12 offset:192
    ds_read_b64_tr_b16 v[70:71], v13 offset:192
    s_waitcnt lgkmcnt(12)
    v_mfma_f32_16x16x32_bf16 a[0:3], v[44:47], v[28:31], a[0:3]
    v_mfma_f32_16x16x32_bf16 a[4:7], v[44:47], v[32:35], a[4:7]
    ds_read_b64_tr_b16 v[72:73], v14 offset:0
    ds_read_b64_tr_b16 v[74:75], v15 offset:0
    s_waitcnt lgkmcnt(12)
    v_mfma_f32_16x16x32_bf16 a[8:11], v[48:51], v[28:31], a[8:11]
    v_mfma_f32_16x16x32_bf16 a[12:15], v[48:51], v[32:35], a[12:15]
    ds_read_b64_tr_b16 v[76:77], v14 offset:32
    ds_read_b64_tr_b16 v[78:79], v15 offset:32
    s_waitcnt lgkmcnt(12)
    v_mfma_f32_16x16x32_bf16 a[16:19], v[52:55], v[28:31], a[16:19]
    v_mfma_f32_16x16x32_bf16 a[20:23], v[52:55], v[32:35], a[20:23]
    ds_read_b64_tr_b16 v[44:45], v14 offset:64
    ds_read_b64_tr_b16 v[46:47], v15 offset:64
    s_waitcnt lgkmcnt(12)
    v_mfma_f32_16x16x32_bf16 a[24:27], v[56:59], v[28:31], a[24:27]
    v_mfma_f32_16x16x32_bf16 a[28:31], v[56:59], v[32:35], a[28:31]
    ds_read_b64_tr_b16 v[48:49], v14 offset:96
    ds_read_b64_tr_b16 v[50:51], v15 offset:96
    s_waitcnt lgkmcnt(12)
    v_mfma_f32_16x16x32_bf16 a[32:35], v[60:63], v[28:31], a[32:35]
    v_mfma_f32_16x16x32_bf16 a[36:39], v[60:63], v[32:35], a[36:39]
    ds_read_b64_tr_b16 v[52:53], v14 offset:128
    ds_read_b64_tr_b16 v[54:55], v15 offset:128
    s_waitcnt lgkmcnt(12)
    v_mfma_f32_16x16x32_bf16 a[40:43], v[64:67], v[28:31], a[40:43]
    v_mfma_f32_16x16x32_bf16 a[44:47], v[64:67], v[32:35], a[44:47]
    ds_read_b64_tr_b16 v[56:57], v14 offset:160
    ds_read_b64_tr_b16 v[58:59], v15 offset:160
    s_waitcnt lgkmcnt(12)
    v_mfma_f32_16x16x32_bf16 a[48:51], v[68:71], v[28:31], a[48:51]
    v_mfma_f32_16x16x32_bf16 a[52:55], v[68:71], v[32:35], a[52:55]
    ds_read_b64_tr_b16 v[60:61], v14 offset:192
    ds_read_b64_tr_b16 v[62:63], v15 offset:192
    s_waitcnt lgkmcnt(12)
    v_mfma_f32_16x16x32_bf16 a[56:59], v[72:75], v[28:31], a[56:59]
    v_mfma_f32_16x16x32_bf16 a[60:63], v[72:75], v[32:35], a[60:63]
    ds_read_b128 v[64:67], v16 offset:0
    ds_read_b128 v[68:71], v17 offset:0
    s_waitcnt lgkmcnt(12)
    v_mfma_f32_16x16x32_bf16 a[64:67], v[76:79], v[28:31], a[64:67]
    v_mfma_f32_16x16x32_bf16 a[68:71], v[76:79], v[32:35], a[68:71]
    ds_read_b128 v[72:75], v16 offset:1024
    ds_read_b128 v[76:79], v17 offset:1024
    s_waitcnt lgkmcnt(12)
    v_mfma_f32_16x16x32_bf16 a[72:75], v[44:47], v[28:31], a[72:75]
    v_mfma_f32_16x16x32_bf16 a[76:79], v[44:47], v[32:35], a[76:79]
    s_lshl_b32 s97, 1, s40
    s_and_b32 s97, s97, 6
    s_cbranch_scc1 L_gemm1_kernel_w_40
    s_waitcnt vmcnt(4)
    s_branch L_gemm1_kernel_w_41
L_gemm1_kernel_w_40:
    s_waitcnt vmcnt(5)
L_gemm1_kernel_w_41:
    s_barrier
    s_add_u32 m0, s75, 104448
    s_nop 0
    buffer_load_dwordx4 v5, s[4:7], s44 offen lds
    s_add_u32 m0, s75, 112640
    s_nop 0
    buffer_load_dwordx4 v6, s[4:7], s44 offen lds
    s_add_u32 s44, s44, 64
    s_cmp_lt_u32 s75, 7168
    s_cbranch_scc0 L_gemm1_kernel_dskip_42
    s_add_u32 m0, s75, 120832
    s_nop 0
    buffer_load_dwordx4 v7, s[8:11], s45 offen lds
L_gemm1_kernel_dskip_42:
    s_add_u32 s45, s45, 229376
    s_cmp_lt_u32 s77, 7168
    s_cbranch_scc0 L_gemm1_kernel_dskip_43
    s_add_u32 m0, s77, 128000
    s_nop 0
    buffer_load_dwordx4 v8, s[12:15], s46 offen lds
L_gemm1_kernel_dskip_43:
    s_add_u32 s46, s46, 229376
    s_cmp_lt_u32 s79, 2048
    s_cbranch_scc0 L_gemm1_kernel_dskip_44
    s_add_u32 m0, s79, 135168
    s_nop 0
    buffer_load_dwordx4 v9, s[16:19], s47 offen lds
L_gemm1_kernel_dskip_44:
    s_add_u32 s47, s47, 64
    s_cmp_lt_u32 s77, 2048
    s_cbranch_scc0 L_gemm1_kernel_dskip_45
    s_add_u32 m0, s77, 137216
    s_nop 0
    buffer_load_dwordx4 v10, s[20:23], s48 offen lds
L_gemm1_kernel_dskip_45:
    s_add_u32 s48, s48, 64
    ds_read_b128 v[36:39], v11 offset:34816
    ds_read_b128 v[40:43], v11 offset:35840
    s_waitcnt lgkmcnt(12)
    v_mfma_f32_16x16x32_bf16 a[80:83], v[48:51], v[28:31], a[80:83]
    v_mfma_f32_16x16x32_bf16 a[84:87], v[48:51], v[32:35], a[84:87]
    ds_read_b64_tr_b16 v[44:45], v12 offset:34816
    ds_read_b64_tr_b16 v[46:47], v13 offset:34816
    s_waitcnt lgkmcnt(12)
    v_mfma_f32_16x16x32_bf16 a[88:91], v[52:55], v[28:31], a[88:91]
    v_mfma_f32_16x16x32_bf16 a[92:95], v[52:55], v[32:35], a[92:95]
    ds_read_b64_tr_b16 v[48:49], v12 offset:34848
    ds_read_b64_tr_b16 v[50:51], v13 offset:34848
    s_waitcnt lgkmcnt(12)
    v_mfma_f32_16x16x32_bf16 a[96:99], v[56:59], v[28:31], a[96:99]
    v_mfma_f32_16x16x32_bf16 a[100:103], v[56:59], v[32:35], a[100:103]
    ds_read_b64_tr_b16 v[52:53], v12 offset:34880
    ds_read_b64_tr_b16 v[54:55], v13 offset:34880
    s_waitcnt lgkmcnt(12)
    v_mfma_f32_16x16x32_bf16 a[104:107], v[60:63], v[28:31], a[104:107]
    v_mfma_f32_16x16x32_bf16 a[108:111], v[60:63], v[32:35], a[108:111]
    s_waitcnt lgkmcnt(11)
    v_mfma_f32_16x16x32_bf16 a[112:115], v[64:67], v[28:31], a[112:115]
    v_mfma_f32_16x16x32_bf16 a[116:119], v[64:67], v[32:35], a[116:119]
    ds_read_b64_tr_b16 v[56:57], v12 offset:34912
    ds_read_b64_tr_b16 v[58:59], v13 offset:34912
    s_waitcnt lgkmcnt(12)
    v_mfma_f32_16x16x32_bf16 a[120:123], v[68:71], v[28:31], a[120:123]
    v_mfma_f32_16x16x32_bf16 a[124:127], v[68:71], v[32:35], a[124:127]
    s_waitcnt lgkmcnt(11)
    v_mfma_f32_16x16x32_bf16 a[128:131], v[72:75], v[28:31], a[128:131]
    v_mfma_f32_16x16x32_bf16 a[132:135], v[72:75], v[32:35], a[132:135]
    ds_read_b64_tr_b16 v[60:61], v12 offset:34944
    ds_read_b64_tr_b16 v[62:63], v13 offset:34944
    s_waitcnt lgkmcnt(12)
    v_mfma_f32_16x16x32_bf16 a[136:139], v[76:79], v[28:31], a[136:139]
    v_mfma_f32_16x16x32_bf16 a[140:143], v[76:79], v[32:35], a[140:143]
    ds_read_b64_tr_b16 v[64:65], v12 offset:34976
    ds_read_b64_tr_b16 v[66:67], v13 offset:34976
    ds_read_b64_tr_b16 v[68:69], v12 offset:35008
    ds_read_b64_tr_b16 v[70:71], v13 offset:35008
    s_waitcnt lgkmcnt(12)
    v_mfma_f32_16x16x32_bf16 a[0:3], v[44:47], v[36:39], a[0:3]
    v_mfma_f32_16x16x32_bf16 a[4:7], v[44:47], v[40:43], a[4:7]
    ds_read_b64_tr_b16 v[72:73], v14 offset:34816
    ds_read_b64_tr_b16 v[74:75], v15 offset:34816
    s_waitcnt lgkmcnt(12)
    v_mfma_f32_16x16x32_bf16 a[8:11], v[48:51], v[36:39], a[8:11]
    v_mfma_f32_16x16x32_bf16 a[12:15], v[48:51], v[40:43], a[12:15]
    ds_read_b64_tr_b16 v[76:77], v14 offset:34848
    ds_read_b64_tr_b16 v[78:79], v15 offset:34848
    s_waitcnt lgkmcnt(12)
    v_mfma_f32_16x16x32_bf16 a[16:19], v[52:55], v[36:39], a[16:19]
    v_mfma_f32_16x16x32_bf16 a[20:23], v[52:55], v[40:43], a[20:23]
    ds_read_b64_tr_b16 v[44:45], v14 offset:34880
    ds_read_b64_tr_b16 v[46:47], v15 offset:34880
    s_waitcnt lgkmcnt(12)
    v_mfma_f32_16x16x32_bf16 a[24:27], v[56:59], v[36:39], a[24:27]
    v_mfma_f32_16x16x32_bf16 a[28:31], v[56:59], v[40:43], a[28:31]
    ds_read_b64_tr_b16 v[48:49], v14 offset:34912
    ds_read_b64_tr_b16 v[50:51], v15 offset:34912
    s_waitcnt lgkmcnt(12)
    v_mfma_f32_16x16x32_bf16 a[32:35], v[60:63], v[36:39], a[32:35]
    v_mfma_f32_16x16x32_bf16 a[36:39], v[60:63], v[40:43], a[36:39]
    ds_read_b64_tr_b16 v[52:53], v14 offset:34944
    ds_read_b64_tr_b16 v[54:55], v15 offset:34944
    s_waitcnt lgkmcnt(12)
    v_mfma_f32_16x16x32_bf16 a[40:43], v[64:67], v[36:39], a[40:43]
    v_mfma_f32_16x16x32_bf16 a[44:47], v[64:67], v[40:43], a[44:47]
    ds_read_b64_tr_b16 v[56:57], v14 offset:34976
    ds_read_b64_tr_b16 v[58:59], v15 offset:34976
    s_waitcnt lgkmcnt(12)
    v_mfma_f32_16x16x32_bf16 a[48:51], v[68:71], v[36:39], a[48:51]
    v_mfma_f32_16x16x32_bf16 a[52:55], v[68:71], v[40:43], a[52:55]
    ds_read_b64_tr_b16 v[60:61], v14 offset:35008
    ds_read_b64_tr_b16 v[62:63], v15 offset:35008
    s_waitcnt lgkmcnt(12)
    v_mfma_f32_16x16x32_bf16 a[56:59], v[72:75], v[36:39], a[56:59]
    v_mfma_f32_16x16x32_bf16 a[60:63], v[72:75], v[40:43], a[60:63]
    ds_read_b128 v[64:67], v16 offset:34816
    ds_read_b128 v[68:71], v17 offset:34816
    s_waitcnt lgkmcnt(12)
    v_mfma_f32_16x16x32_bf16 a[64:67], v[76:79], v[36:39], a[64:67]
    v_mfma_f32_16x16x32_bf16 a[68:71], v[76:79], v[40:43], a[68:71]
    ds_read_b128 v[72:75], v16 offset:35840
    ds_read_b128 v[76:79], v17 offset:35840
    s_waitcnt lgkmcnt(12)
    v_mfma_f32_16x16x32_bf16 a[72:75], v[44:47], v[36:39], a[72:75]
    v_mfma_f32_16x16x32_bf16 a[76:79], v[44:47], v[40:43], a[76:79]
    s_lshl_b32 s97, 1, s40
    s_and_b32 s97, s97, 6
    s_cbranch_scc1 L_gemm1_kernel_w_46
    s_waitcnt vmcnt(4)
    s_branch L_gemm1_kernel_w_47
L_gemm1_kernel_w_46:
    s_waitcnt vmcnt(5)
L_gemm1_kernel_w_47:
    s_barrier
    s_add_u32 m0, s75, 0
    s_nop 0
    buffer_load_dwordx4 v5, s[4:7], s44 offen lds
    s_add_u32 m0, s75, 8192
    s_nop 0
    buffer_load_dwordx4 v6, s[4:7], s44 offen lds
    s_add_u32 s44, s44, 64
    s_cmp_lt_u32 s75, 7168
    s_cbranch_scc0 L_gemm1_kernel_dskip_48
    s_add_u32 m0, s75, 16384
    s_nop 0
    buffer_load_dwordx4 v7, s[8:11], s45 offen lds
L_gemm1_kernel_dskip_48:
    s_add_u32 s45, s45, 229376
    s_cmp_lt_u32 s77, 7168
    s_cbranch_scc0 L_gemm1_kernel_dskip_49
    s_add_u32 m0, s77, 23552
    s_nop 0
    buffer_load_dwordx4 v8, s[12:15], s46 offen lds
L_gemm1_kernel_dskip_49:
    s_add_u32 s46, s46, 229376
    s_cmp_lt_u32 s79, 2048
    s_cbranch_scc0 L_gemm1_kernel_dskip_50
    s_add_u32 m0, s79, 30720
    s_nop 0
    buffer_load_dwordx4 v9, s[16:19], s47 offen lds
L_gemm1_kernel_dskip_50:
    s_add_u32 s47, s47, 64
    s_cmp_lt_u32 s77, 2048
    s_cbranch_scc0 L_gemm1_kernel_dskip_51
    s_add_u32 m0, s77, 32768
    s_nop 0
    buffer_load_dwordx4 v10, s[20:23], s48 offen lds
L_gemm1_kernel_dskip_51:
    s_add_u32 s48, s48, 64
    ds_read_b128 v[28:31], v18 offset:0
    ds_read_b128 v[32:35], v18 offset:1024
    s_waitcnt lgkmcnt(12)
    v_mfma_f32_16x16x32_bf16 a[80:83], v[48:51], v[36:39], a[80:83]
    v_mfma_f32_16x16x32_bf16 a[84:87], v[48:51], v[40:43], a[84:87]
    ds_read_b64_tr_b16 v[44:45], v19 offset:0
    ds_read_b64_tr_b16 v[46:47], v20 offset:0
    s_waitcnt lgkmcnt(12)
    v_mfma_f32_16x16x32_bf16 a[88:91], v[52:55], v[36:39], a[88:91]
    v_mfma_f32_16x16x32_bf16 a[92:95], v[52:55], v[40:43], a[92:95]
    ds_read_b64_tr_b16 v[48:49], v19 offset:32
    ds_read_b64_tr_b16 v[50:51], v20 offset:32
    s_waitcnt lgkmcnt(12)
    v_mfma_f32_16x16x32_bf16 a[96:99], v[56:59], v[36:39], a[96:99]
    v_mfma_f32_16x16x32_bf16 a[100:103], v[56:59], v[40:43], a[100:103]
    ds_read_b64_tr_b16 v[52:53], v19 offset:64
    ds_read_b64_tr_b16 v[54:55], v20 offset:64
    s_waitcnt lgkmcnt(12)
    v_mfma_f32_16x16x32_bf16 a[104:107], v[60:63], v[36:39], a[104:107]
    v_mfma_f32_16x16x32_bf16 a[108:111], v[60:63], v[40:43], a[108:111]
    s_waitcnt lgkmcnt(11)
    v_mfma_f32_16x16x32_bf16 a[112:115], v[64:67], v[36:39], a[112:115]
    v_mfma_f32_16x16x32_bf16 a[116:119], v[64:67], v[40:43], a[116:119]
    ds_read_b64_tr_b16 v[56:57], v19 offset:96
    ds_read_b64_tr_b16 v[58:59], v20 offset:96
    s_waitcnt lgkmcnt(12)
    v_mfma_f32_16x16x32_bf16 a[120:123], v[68:71], v[36:39], a[120:123]
    v_mfma_f32_16x16x32_bf16 a[124:127], v[68:71], v[40:43], a[124:127]
    s_waitcnt lgkmcnt(11)
    v_mfma_f32_16x16x32_bf16 a[128:131], v[72:75], v[36:39], a[128:131]
    v_mfma_f32_16x16x32_bf16 a[132:135], v[72:75], v[40:43], a[132:135]
    ds_read_b64_tr_b16 v[60:61], v19 offset:128
    ds_read_b64_tr_b16 v[62:63], v20 offset:128
    s_waitcnt lgkmcnt(12)
    v_mfma_f32_16x16x32_bf16 a[136:139], v[76:79], v[36:39], a[136:139]
    v_mfma_f32_16x16x32_bf16 a[140:143], v[76:79], v[40:43], a[140:143]
    ds_read_b64_tr_b16 v[64:65], v19 offset:160
    ds_read_b64_tr_b16 v[66:67], v20 offset:160
    ds_read_b64_tr_b16 v[68:69], v19 offset:192
    ds_read_b64_tr_b16 v[70:71], v20 offset:192
    s_waitcnt lgkmcnt(12)
    v_mfma_f32_16x16x32_bf16 a[0:3], v[44:47], v[28:31], a[0:3]
    v_mfma_f32_16x16x32_bf16 a[4:7], v[44:47], v[32:35], a[4:7]
    ds_read_b64_tr_b16 v[72:73], v21 offset:0
    ds_read_b64_tr_b16 v[74:75], v22 offset:0
    s_waitcnt lgkmcnt(12)
    v_mfma_f32_16x16x32_bf16 a[8:11], v[48:51], v[28:31], a[8:11]
    v_mfma_f32_16x16x32_bf16 a[12:15], v[48:51], v[32:35], a[12:15]
    ds_read_b64_tr_b16 v[76:77], v21 offset:32
    ds_read_b64_tr_b16 v[78:79], v22 offset:32
    s_waitcnt lgkmcnt(12)
    v_mfma_f32_16x16x32_bf16 a[16:19], v[52:55], v[28:31], a[16:19]
    v_mfma_f32_16x16x32_bf16 a[20:23], v[52:55], v[32:35], a[20:23]
    ds_read_b64_tr_b16 v[44:45], v21 offset:64
    ds_read_b64_tr_b16 v[46:47], v22 offset:64
    s_waitcnt lgkmcnt(12)
    v_mfma_f32_16x16x32_bf16 a[24:27], v[56:59], v[28:31], a[24:27]
    v_mfma_f32_16x16x32_bf16 a[28:31], v[56:59], v[32:35], a[28:31]
    ds_read_b64_tr_b16 v[48:49], v21 offset:96
    ds_read_b64_tr_b16 v[50:51], v22 offset:96
    s_waitcnt lgkmcnt(12)
    v_mfma_f32_16x16x32_bf16 a[32:35], v[60:63], v[28:31], a[32:35]
    v_mfma_f32_16x16x32_bf16 a[36:39], v[60:63], v[32:35], a[36:39]
    ds_read_b64_tr_b16 v[52:53], v21 offset:128
    ds_read_b64_tr_b16 v[54:55], v22 offset:128
    s_waitcnt lgkmcnt(12)
    v_mfma_f32_16x16x32_bf16 a[40:43], v[64:67], v[28:31], a[40:43]
    v_mfma_f32_16x16x32_bf16 a[44:47], v[64:67], v[32:35], a[44:47]
    ds_read_b64_tr_b16 v[56:57], v21 offset:160
    ds_read_b64_tr_b16 v[58:59], v22 offset:160
    s_waitcnt lgkmcnt(12)
    v_mfma_f32_16x16x32_bf16 a[48:51], v[68:71], v[28:31], a[48:51]
    v_mfma_f32_16x16x32_bf16 a[52:55], v[68:71], v[32:35], a[52:55]
    ds_read_b64_tr_b16 v[60:61], v21 offset:192
    ds_read_b64_tr_b16 v[62:63], v22 offset:192
    s_waitcnt lgkmcnt(12)
    v_mfma_f32_16x16x32_bf16 a[56:59], v[72:75], v[28:31], a[56:59]
    v_mfma_f32_16x16x32_bf16 a[60:63], v[72:75], v[32:35], a[60:63]
    ds_read_b128 v[64:67], v23 offset:0
    ds_read_b128 v[68:71], v24 offset:0
    s_waitcnt lgkmcnt(12)
    v_mfma_f32_16x16x32_bf16 a[64:67], v[76:79], v[28:31], a[64:67]
    v_mfma_f32_16x16x32_bf16 a[68:71], v[76:79], v[32:35], a[68:71]
    ds_read_b128 v[72:75], v23 offset:1024
    ds_read_b128 v[76:79], v24 offset:1024
    s_waitcnt lgkmcnt(12)
    v_mfma_f32_16x16x32_bf16 a[72:75], v[44:47], v[28:31], a[72:75]
    v_mfma_f32_16x16x32_bf16 a[76:79], v[44:47], v[32:35], a[76:79]
    s_lshl_b32 s97, 1, s40
    s_and_b32 s97, s97, 6
    s_cbranch_scc1 L_gemm1_kernel_w_52
    s_waitcnt vmcnt(4)
    s_branch L_gemm1_kernel_w_53
L_gemm1_kernel_w_52:
    s_waitcnt vmcnt(5)
L_gemm1_kernel_w_53:
    s_barrier
    s_add_u32 m0, s75, 34816
    s_nop 0
    buffer_load_dwordx4 v5, s[4:7], s44 offen lds
    s_add_u32 m0, s75, 43008
    s_nop 0
    buffer_load_dwordx4 v6, s[4:7], s44 offen lds
    s_add_u32 s44, s44, 64
    s_cmp_lt_u32 s75, 7168
    s_cbranch_scc0 L_gemm1_kernel_dskip_54
    s_add_u32 m0, s75, 51200
    s_nop 0
    buffer_load_dwordx4 v7, s[8:11], s45 offen lds
L_gemm1_kernel_dskip_54:
    s_add_u32 s45, s45, 229376
    s_cmp_lt_u32 s77, 7168
    s_cbranch_scc0 L_gemm1_kernel_dskip_55
    s_add_u32 m0, s77, 58368
    s_nop 0
    buffer_load_dwordx4 v8, s[12:15], s46 offen lds
L_gemm1_kernel_dskip_55:
    s_add_u32 s46, s46, 229376
    s_cmp_lt_u32 s79, 2048
    s_cbranch_scc0 L_gemm1_kernel_dskip_56
    s_add_u32 m0, s79, 65536
    s_nop 0
    buffer_load_dwordx4 v9, s[16:19], s47 offen lds
L_gemm1_kernel_dskip_56:
    s_add_u32 s47, s47, 64
    s_cmp_lt_u32 s77, 2048
    s_cbranch_scc0 L_gemm1_kernel_dskip_57
    s_add_u32 m0, s77, 67584
    s_nop 0
    buffer_load_dwordx4 v10, s[20:23], s48 offen lds
L_gemm1_kernel_dskip_57:
    s_add_u32 s48, s48, 64
    ds_read_b128 v[36:39], v18 offset:34816
    ds_read_b128 v[40:43], v18 offset:35840
    s_waitcnt lgkmcnt(12)
    v_mfma_f32_16x16x32_bf16 a[80:83], v[48:51], v[28:31], a[80:83]
    v_mfma_f32_16x16x32_bf16 a[84:87], v[48:51], v[32:35], a[84:87]
    ds_read_b64_tr_b16 v[44:45], v19 offset:34816
    ds_read_b64_tr_b16 v[46:47], v20 offset:34816
    s_waitcnt lgkmcnt(12)
    v_mfma_f32_16x16x32_bf16 a[88:91], v[52:55], v[28:31], a[88:91]
    v_mfma_f32_16x16x32_bf16 a[92:95], v[52:55], v[32:35], a[92:95]
    ds_read_b64_tr_b16 v[48:49], v19 offset:34848
    ds_read_b64_tr_b16 v[50:51], v20 offset:34848
    s_waitcnt lgkmcnt(12)
    v_mfma_f32_16x16x32_bf16 a[96:99], v[56:59], v[28:31], a[96:99]
    v_mfma_f32_16x16x32_bf16 a[100:103], v[56:59], v[32:35], a[100:103]
    ds_read_b64_tr_b16 v[52:53], v19 offset:34880
    ds_read_b64_tr_b16 v[54:55], v20 offset:34880
    s_waitcnt lgkmcnt(12)
    v_mfma_f32_16x16x32_bf16 a[104:107], v[60:63], v[28:31], a[104:107]
    v_mfma_f32_16x16x32_bf16 a[108:111], v[60:63], v[32:35], a[108:111]
    s_waitcnt lgkmcnt(11)
    v_mfma_f32_16x16x32_bf16 a[112:115], v[64:67], v[28:31], a[112:115]
    v_mfma_f32_16x16x32_bf16 a[116:119], v[64:67], v[32:35], a[116:119]
    ds_read_b64_tr_b16 v[56:57], v19 offset:34912
    ds_read_b64_tr_b16 v[58:59], v20 offset:34912
    s_waitcnt lgkmcnt(12)
    v_mfma_f32_16x16x32_bf16 a[120:123], v[68:71], v[28:31], a[120:123]
    v_mfma_f32_16x16x32_bf16 a[124:127], v[68:71], v[32:35], a[124:127]
    s_waitcnt lgkmcnt(11)
    v_mfma_f32_16x16x32_bf16 a[128:131], v[72:75], v[28:31], a[128:131]
    v_mfma_f32_16x16x32_bf16 a[132:135], v[72:75], v[32:35], a[132:135]
    ds_read_b64_tr_b16 v[60:61], v19 offset:34944
    ds_read_b64_tr_b16 v[62:63], v20 offset:34944
    s_waitcnt lgkmcnt(12)
    v_mfma_f32_16x16x32_bf16 a[136:139], v[76:79], v[28:31], a[136:139]
    v_mfma_f32_16x16x32_bf16 a[140:143], v[76:79], v[32:35], a[140:143]
    ds_read_b64_tr_b16 v[64:65], v19 offset:34976
    ds_read_b64_tr_b16 v[66:67], v20 offset:34976
    ds_read_b64_tr_b16 v[68:69], v19 offset:35008
    ds_read_b64_tr_b16 v[70:71], v20 offset:35008
    s_waitcnt lgkmcnt(12)
    v_mfma_f32_16x16x32_bf16 a[0:3], v[44:47], v[36:39], a[0:3]
    v_mfma_f32_16x16x32_bf16 a[4:7], v[44:47], v[40:43], a[4:7]
    ds_read_b64_tr_b16 v[72:73], v21 offset:34816
    ds_read_b64_tr_b16 v[74:75], v22 offset:34816
    s_waitcnt lgkmcnt(12)
    v_mfma_f32_16x16x32_bf16 a[8:11], v[48:51], v[36:39], a[8:11]
    v_mfma_f32_16x16x32_bf16 a[12:15], v[48:51], v[40:43], a[12:15]
    ds_read_b64_tr_b16 v[76:77], v21 offset:34848
    ds_read_b64_tr_b16 v[78:79], v22 offset:34848
    s_waitcnt lgkmcnt(12)
    v_mfma_f32_16x16x32_bf16 a[16:19], v[52:55], v[36:39], a[16:19]
    v_mfma_f32_16x16x32_bf16 a[20:23], v[52:55], v[40:43], a[20:23]
    ds_read_b64_tr_b16 v[44:45], v21 offset:34880
    ds_read_b64_tr_b16 v[46:47], v22 offset:34880
    s_waitcnt lgkmcnt(12)
    v_mfma_f32_16x16x32_bf16 a[24:27], v[56:59], v[36:39], a[24:27]
    v_mfma_f32_16x16x32_bf16 a[28:31], v[56:59], v[40:43], a[28:31]
    ds_read_b64_tr_b16 v[48:49], v21 offset:34912
    ds_read_b64_tr_b16 v[50:51], v22 offset:34912
    s_waitcnt lgkmcnt(12)
    v_mfma_f32_16x16x32_bf16 a[32:35], v[60:63], v[36:39], a[32:35]
    v_mfma_f32_16x16x32_bf16 a[36:39], v[60:63], v[40:43], a[36:39]
    ds_read_b64_tr_b16 v[52:53], v21 offset:34944
    ds_read_b64_tr_b16 v[54:55], v22 offset:34944
    s_waitcnt lgkmcnt(12)
    v_mfma_f32_16x16x32_bf16 a[40:43], v[64:67], v[36:39], a[40:43]
    v_mfma_f32_16x16x32_bf16 a[44:47], v[64:67], v[40:43], a[44:47]
    ds_read_b64_tr_b16 v[56:57], v21 offset:34976
    ds_read_b64_tr_b16 v[58:59], v22 offset:34976
    s_waitcnt lgkmcnt(12)
    v_mfma_f32_16x16x32_bf16 a[48:51], v[68:71], v[36:39], a[48:51]
    v_mfma_f32_16x16x32_bf16 a[52:55], v[68:71], v[40:43], a[52:55]
    ds_read_b64_tr_b16 v[60:61], v21 offset:35008
    ds_read_b64_tr_b16 v[62:63], v22 offset:35008
    s_waitcnt lgkmcnt(12)
    v_mfma_f32_16x16x32_bf16 a[56:59], v[72:75], v[36:39], a[56:59]
    v_mfma_f32_16x16x32_bf16 a[60:63], v[72:75], v[40:43], a[60:63]
    ds_read_b128 v[64:67], v23 offset:34816
    ds_read_b128 v[68:71], v24 offset:34816
    s_waitcnt lgkmcnt(12)
    v_mfma_f32_16x16x32_bf16 a[64:67], v[76:79], v[36:39], a[64:67]
    v_mfma_f32_16x16x32_bf16 a[68:71], v[76:79], v[40:43], a[68:71]
    ds_read_b128 v[72:75], v23 offset:35840
    ds_read_b128 v[76:79], v24 offset:35840
    s_waitcnt lgkmcnt(12)
    v_mfma_f32_16x16x32_bf16 a[72:75], v[44:47], v[36:39], a[72:75]
    v_mfma_f32_16x16x32_bf16 a[76:79], v[44:47], v[40:43], a[76:79]
    s_lshl_b32 s97, 1, s40
    s_and_b32 s97, s97, 6
    s_cbranch_scc1 L_gemm1_kernel_w_58
    s_waitcnt vmcnt(4)
    s_branch L_gemm1_kernel_w_59
L_gemm1_kernel_w_58:
    s_waitcnt vmcnt(5)
L_gemm1_kernel_w_59:
    s_barrier
    s_add_u32 m0, s75, 69632
    s_nop 0
    buffer_load_dwordx4 v5, s[4:7], s44 offen lds
    s_add_u32 m0, s75, 77824
    s_nop 0
    buffer_load_dwordx4 v6, s[4:7], s44 offen lds
    s_add_u32 s44, s44, 64
    s_cmp_lt_u32 s75, 7168
    s_cbranch_scc0 L_gemm1_kernel_dskip_60
    s_add_u32 m0, s75, 86016
    s_nop 0
    buffer_load_dwordx4 v7, s[8:11], s45 offen lds
L_gemm1_kernel_dskip_60:
    s_add_u32 s45, s45, 229376
    s_cmp_lt_u32 s77, 7168
    s_cbranch_scc0 L_gemm1_kernel_dskip_61
    s_add_u32 m0, s77, 93184
    s_nop 0
    buffer_load_dwordx4 v8, s[12:15], s46 offen lds
L_gemm1_kernel_dskip_61:
    s_add_u32 s46, s46, 229376
    s_cmp_lt_u32 s79, 2048
    s_cbranch_scc0 L_gemm1_kernel_dskip_62
    s_add_u32 m0, s79, 100352
    s_nop 0
    buffer_load_dwordx4 v9, s[16:19], s47 offen lds
L_gemm1_kernel_dskip_62:
    s_add_u32 s47, s47, 64
    s_cmp_lt_u32 s77, 2048
    s_cbranch_scc0 L_gemm1_kernel_dskip_63
    s_add_u32 m0, s77, 102400
    s_nop 0
    buffer_load_dwordx4 v10, s[20:23], s48 offen lds
L_gemm1_kernel_dskip_63:
    s_add_u32 s48, s48, 64
    ds_read_b128 v[28:31], v11 offset:0
    ds_read_b128 v[32:35], v11 offset:1024
    s_waitcnt lgkmcnt(12)
    v_mfma_f32_16x16x32_bf16 a[80:83], v[48:51], v[36:39], a[80:83]
    v_mfma_f32_16x16x32_bf16 a[84:87], v[48:51], v[40:43], a[84:87]
    ds_read_b64_tr_b16 v[44:45], v12 offset:0
    ds_read_b64_tr_b16 v[46:47], v13 offset:0
    s_waitcnt lgkmcnt(12)
    v_mfma_f32_16x16x32_bf16 a[88:91], v[52:55], v[36:39], a[88:91]
    v_mfma_f32_16x16x32_bf16 a[92:95], v[52:55], v[40:43], a[92:95]
    ds_read_b64_tr_b16 v[48:49], v12 offset:32
    ds_read_b64_tr_b16 v[50:51], v13 offset:32
    s_waitcnt lgkmcnt(12)
    v_mfma_f32_16x16x32_bf16 a[96:99], v[56:59], v[36:39], a[96:99]
    v_mfma_f32_16x16x32_bf16 a[100:103], v[56:59], v[40:43], a[100:103]
    ds_read_b64_tr_b16 v[52:53], v12 offset:64
    ds_read_b64_tr_b16 v[54:55], v13 offset:64
    s_waitcnt lgkmcnt(12)
    v_mfma_f32_16x16x32_bf16 a[104:107], v[60:63], v[36:39], a[104:107]
    v_mfma_f32_16x16x32_bf16 a[108:111], v[60:63], v[40:43], a[108:111]
    s_waitcnt lgkmcnt(11)
    v_mfma_f32_16x16x32_bf16 a[112:115], v[64:67], v[36:39], a[112:115]
    v_mfma_f32_16x16x32_bf16 a[116:119], v[64:67], v[40:43], a[116:119]
    ds_read_b64_tr_b16 v[56:57], v12 offset:96
    ds_read_b64_tr_b16 v[58:59], v13 offset:96
    s_waitcnt lgkmcnt(12)
    v_mfma_f32_16x16x32_bf16 a[120:123], v[68:71], v[36:39], a[120:123]
    v_mfma_f32_16x16x32_bf16 a[124:127], v[68:71], v[40:43], a[124:127]
    s_waitcnt lgkmcnt(11)
    v_mfma_f32_16x16x32_bf16 a[128:131], v[72:75], v[36:39], a[128:131]
    v_mfma_f32_16x16x32_bf16 a[132:135], v[72:75], v[40:43], a[132:135]
    s_waitcnt lgkmcnt(10)
    v_mfma_f32_16x16x32_bf16 a[136:139], v[76:79], v[36:39], a[136:139]
    v_mfma_f32_16x16x32_bf16 a[140:143], v[76:79], v[40:43], a[140:143]
    s_add_u32 s59, s59, 1
    s_cmp_lt_u32 s59, 7
    s_cbranch_scc1 L_gemm1_kernel_loop_39
    ds_read_b64_tr_b16 v[60:61], v12 offset:128
    ds_read_b64_tr_b16 v[62:63], v13 offset:128
    ds_read_b64_tr_b16 v[64:65], v12 offset:160
    ds_read_b64_tr_b16 v[66:67], v13 offset:160
    ds_read_b64_tr_b16 v[68:69], v12 offset:192
    ds_read_b64_tr_b16 v[70:71], v13 offset:192
    s_waitcnt lgkmcnt(12)
    v_mfma_f32_16x16x32_bf16 a[0:3], v[44:47], v[28:31], a[0:3]
    v_mfma_f32_16x16x32_bf16 a[4:7], v[44:47], v[32:35], a[4:7]
    ds_read_b64_tr_b16 v[72:73], v14 offset:0
    ds_read_b64_tr_b16 v[74:75], v15 offset:0
    s_waitcnt lgkmcnt(12)
    v_mfma_f32_16x16x32_bf16 a[8:11], v[48:51], v[28:31], a[8:11]
    v_mfma_f32_16x16x32_bf16 a[12:15], v[48:51], v[32:35], a[12:15]
    ds_read_b64_tr_b16 v[76:77], v14 offset:32
    ds_read_b64_tr_b16 v[78:79], v15 offset:32
    s_waitcnt lgkmcnt(12)
    v_mfma_f32_16x16x32_bf16 a[16:19], v[52:55], v[28:31], a[16:19]
    v_mfma_f32_16x16x32_bf16 a[20:23], v[52:55], v[32:35], a[20:23]
    ds_read_b64_tr_b16 v[44:45], v14 offset:64
    ds_read_b64_tr_b16 v[46:47], v15 offset:64
    s_waitcnt lgkmcnt(12)
    v_mfma_f32_16x16x32_bf16 a[24:27], v[56:59], v[28:31], a[24:27]
    v_mfma_f32_16x16x32_bf16 a[28:31], v[56:59], v[32:35], a[28:31]
    ds_read_b64_tr_b16 v[48:49], v14 offset:96
    ds_read_b64_tr_b16 v[50:51], v15 offset:96
    s_waitcnt lgkmcnt(12)
    v_mfma_f32_16x16x32_bf16 a[32:35], v[60:63], v[28:31], a[32:35]
    v_mfma_f32_16x16x32_bf16 a[36:39], v[60:63], v[32:35], a[36:39]
    ds_read_b64_tr_b16 v[52:53], v14 offset:128
    ds_read_b64_tr_b16 v[54:55], v15 offset:128
    s_waitcnt lgkmcnt(12)
    v_mfma_f32_16x16x32_bf16 a[40:43], v[64:67], v[28:31], a[40:43]
    v_mfma_f32_16x16x32_bf16 a[44:47], v[64:67], v[32:35], a[44:47]
    ds_read_b64_tr_b16 v[56:57], v14 offset:160
    ds_read_b64_tr_b16 v[58:59], v15 offset:160
    s_waitcnt lgkmcnt(12)
    v_mfma_f32_16x16x32_bf16 a[48:51], v[68:71], v[28:31], a[48:51]
    v_mfma_f32_16x16x32_bf16 a[52:55], v[68:71], v[32:35], a[52:55]
    ds_read_b64_tr_b16 v[60:61], v14 offset:192
    ds_read_b64_tr_b16 v[62:63], v15 offset:192
    s_waitcnt lgkmcnt(12)
    v_mfma_f32_16x16x32_bf16 a[56:59], v[72:75], v[28:31], a[56:59]
    v_mfma_f32_16x16x32_bf16 a[60:63], v[72:75], v[32:35], a[60:63]
    ds_read_b128 v[64:67], v16 offset:0
    ds_read_b128 v[68:71], v17 offset:0
    s_waitcnt lgkmcnt(12)
    v_mfma_f32_16x16x32_bf16 a[64:67], v[76:79], v[28:31], a[64:67]
    v_mfma_f32_16x16x32_bf16 a[68:71], v[76:79], v[32:35], a[68:71]
    ds_read_b128 v[72:75], v16 offset:1024
    ds_read_b128 v[76:79], v17 offset:1024
    s_waitcnt lgkmcnt(12)
    v_mfma_f32_16x16x32_bf16 a[72:75], v[44:47], v[28:31], a[72:75]
    v_mfma_f32_16x16x32_bf16 a[76:79], v[44:47], v[32:35], a[76:79]
    s_lshl_b32 s97, 1, s40
    s_and_b32 s97, s97, 6
    s_cbranch_scc1 L_gemm1_kernel_w_64
    s_waitcnt vmcnt(4)
    s_branch L_gemm1_kernel_w_65
L_gemm1_kernel_w_64:
    s_waitcnt vmcnt(5)
L_gemm1_kernel_w_65:
    s_barrier
    s_add_u32 m0, s75, 104448
    s_nop 0
    buffer_load_dwordx4 v5, s[4:7], s44 offen lds
    s_add_u32 m0, s75, 112640
    s_nop 0
    buffer_load_dwordx4 v6, s[4:7], s44 offen lds
    s_add_u32 s44, s44, 64
    s_cmp_lt_u32 s75, 7168
    s_cbranch_scc0 L_gemm1_kernel_dskip_66
    s_add_u32 m0, s75, 120832
    s_nop 0
    buffer_load_dwordx4 v7, s[8:11], s45 offen lds
L_gemm1_kernel_dskip_66:
    s_add_u32 s45, s45, 229376
    s_cmp_lt_u32 s77, 7168
    s_cbranch_scc0 L_gemm1_kernel_dskip_67
    s_add_u32 m0, s77, 128000
    s_nop 0
    buffer_load_dwordx4 v8, s[12:15], s46 offen lds
L_gemm1_kernel_dskip_67:
    s_add_u32 s46, s46, 229376
    s_cmp_lt_u32 s79, 2048
    s_cbranch_scc0 L_gemm1_kernel_dskip_68
    s_add_u32 m0, s79, 135168
    s_nop 0
    buffer_load_dwordx4 v9, s[16:19], s47 offen lds
L_gemm1_kernel_dskip_68:
    s_add_u32 s47, s47, 64
    s_cmp_lt_u32 s77, 2048
    s_cbranch_scc0 L_gemm1_kernel_dskip_69
    s_add_u32 m0, s77, 137216
    s_nop 0
    buffer_load_dwordx4 v10, s[20:23], s48 offen lds
L_gemm1_kernel_dskip_69:
    s_add_u32 s48, s48, 64
    ds_read_b128 v[36:39], v11 offset:34816
    ds_read_b128 v[40:43], v11 offset:35840
    s_waitcnt lgkmcnt(12)
    v_mfma_f32_16x16x32_bf16 a[80:83], v[48:51], v[28:31], a[80:83]
    v_mfma_f32_16x16x32_bf16 a[84:87], v[48:51], v[32:35], a[84:87]
    ds_read_b64_tr_b16 v[44:45], v12 offset:34816
    ds_read_b64_tr_b16 v[46:47], v13 offset:34816
    s_waitcnt lgkmcnt(12)
    v_mfma_f32_16x16x32_bf16 a[88:91], v[52:55], v[28:31], a[88:91]
    v_mfma_f32_16x16x32_bf16 a[92:95], v[52:55], v[32:35], a[92:95]
    ds_read_b64_tr_b16 v[48:49], v12 offset:34848
    ds_read_b64_tr_b16 v[50:51], v13 offset:34848
    s_waitcnt lgkmcnt(12)
    v_mfma_f32_16x16x32_bf16 a[96:99], v[56:59], v[28:31], a[96:99]
    v_mfma_f32_16x16x32_bf16 a[100:103], v[56:59], v[32:35], a[100:103]
    ds_read_b64_tr_b16 v[52:53], v12 offset:34880
    ds_read_b64_tr_b16 v[54:55], v13 offset:34880
    s_waitcnt lgkmcnt(12)
    v_mfma_f32_16x16x32_bf16 a[104:107], v[60:63], v[28:31], a[104:107]
    v_mfma_f32_16x16x32_bf16 a[108:111], v[60:63], v[32:35], a[108:111]
    s_waitcnt lgkmcnt(11)
    v_mfma_f32_16x16x32_bf16 a[112:115], v[64:67], v[28:31], a[112:115]
    v_mfma_f32_16x16x32_bf16 a[116:119], v[64:67], v[32:35], a[116:119]
    ds_read_b64_tr_b16 v[56:57], v12 offset:34912
    ds_read_b64_tr_b16 v[58:59], v13 offset:34912
    s_waitcnt lgkmcnt(12)
    v_mfma_f32_16x16x32_bf16 a[120:123], v[68:71], v[28:31], a[120:123]
    v_mfma_f32_16x16x32_bf16 a[124:127], v[68:71], v[32:35], a[124:127]
    s_waitcnt lgkmcnt(11)
    v_mfma_f32_16x16x32_bf16 a[128:131], v[72:75], v[28:31], a[128:131]
    v_mfma_f32_16x16x32_bf16 a[132:135], v[72:75], v[32:35], a[132:135]
    ds_read_b64_tr_b16 v[60:61], v12 offset:34944
    ds_read_b64_tr_b16 v[62:63], v13 offset:34944
    s_waitcnt lgkmcnt(12)
    v_mfma_f32_16x16x32_bf16 a[136:139], v[76:79], v[28:31], a[136:139]
    v_mfma_f32_16x16x32_bf16 a[140:143], v[76:79], v[32:35], a[140:143]
    ds_read_b64_tr_b16 v[64:65], v12 offset:34976
    ds_read_b64_tr_b16 v[66:67], v13 offset:34976
    ds_read_b64_tr_b16 v[68:69], v12 offset:35008
    ds_read_b64_tr_b16 v[70:71], v13 offset:35008
    s_waitcnt lgkmcnt(12)
    v_mfma_f32_16x16x32_bf16 a[0:3], v[44:47], v[36:39], a[0:3]
    v_mfma_f32_16x16x32_bf16 a[4:7], v[44:47], v[40:43], a[4:7]
    ds_read_b64_tr_b16 v[72:73], v14 offset:34816
    ds_read_b64_tr_b16 v[74:75], v15 offset:34816
    s_waitcnt lgkmcnt(12)
    v_mfma_f32_16x16x32_bf16 a[8:11], v[48:51], v[36:39], a[8:11]
    v_mfma_f32_16x16x32_bf16 a[12:15], v[48:51], v[40:43], a[12:15]
    ds_read_b64_tr_b16 v[76:77], v14 offset:34848
    ds_read_b64_tr_b16 v[78:79], v15 offset:34848
    s_waitcnt lgkmcnt(12)
    v_mfma_f32_16x16x32_bf16 a[16:19], v[52:55], v[36:39], a[16:19]
    v_mfma_f32_16x16x32_bf16 a[20:23], v[52:55], v[40:43], a[20:23]
    ds_read_b64_tr_b16 v[44:45], v14 offset:34880
    ds_read_b64_tr_b16 v[46:47], v15 offset:34880
    s_waitcnt lgkmcnt(12)
    v_mfma_f32_16x16x32_bf16 a[24:27], v[56:59], v[36:39], a[24:27]
    v_mfma_f32_16x16x32_bf16 a[28:31], v[56:59], v[40:43], a[28:31]
    ds_read_b64_tr_b16 v[48:49], v14 offset:34912
    ds_read_b64_tr_b16 v[50:51], v15 offset:34912
    s_waitcnt lgkmcnt(12)
    v_mfma_f32_16x16x32_bf16 a[32:35], v[60:63], v[36:39], a[32:35]
    v_mfma_f32_16x16x32_bf16 a[36:39], v[60:63], v[40:43], a[36:39]
    ds_read_b64_tr_b16 v[52:53], v14 offset:34944
    ds_read_b64_tr_b16 v[54:55], v15 offset:34944
    s_waitcnt lgkmcnt(12)
    v_mfma_f32_16x16x32_bf16 a[40:43], v[64:67], v[36:39], a[40:43]
    v_mfma_f32_16x16x32_bf16 a[44:47], v[64:67], v[40:43], a[44:47]
    ds_read_b64_tr_b16 v[56:57], v14 offset:34976
    ds_read_b64_tr_b16 v[58:59], v15 offset:34976
    s_waitcnt lgkmcnt(12)
    v_mfma_f32_16x16x32_bf16 a[48:51], v[68:71], v[36:39], a[48:51]
    v_mfma_f32_16x16x32_bf16 a[52:55], v[68:71], v[40:43], a[52:55]
    ds_read_b64_tr_b16 v[60:61], v14 offset:35008
    ds_read_b64_tr_b16 v[62:63], v15 offset:35008
    s_waitcnt lgkmcnt(12)
    v_mfma_f32_16x16x32_bf16 a[56:59], v[72:75], v[36:39], a[56:59]
    v_mfma_f32_16x16x32_bf16 a[60:63], v[72:75], v[40:43], a[60:63]
    ds_read_b128 v[64:67], v16 offset:34816
    ds_read_b128 v[68:71], v17 offset:34816
    s_waitcnt lgkmcnt(12)
    v_mfma_f32_16x16x32_bf16 a[64:67], v[76:79], v[36:39], a[64:67]
    v_mfma_f32_16x16x32_bf16 a[68:71], v[76:79], v[40:43], a[68:71]
    ds_read_b128 v[72:75], v16 offset:35840
    ds_read_b128 v[76:79], v17 offset:35840
    s_waitcnt lgkmcnt(12)
    v_mfma_f32_16x16x32_bf16 a[72:75], v[44:47], v[36:39], a[72:75]
    v_mfma_f32_16x16x32_bf16 a[76:79], v[44:47], v[40:43], a[76:79]
    s_lshl_b32 s97, 1, s40
    s_and_b32 s97, s97, 6
    s_cbranch_scc1 L_gemm1_kernel_w_70
    s_waitcnt vmcnt(4)
    s_branch L_gemm1_kernel_w_71
L_gemm1_kernel_w_70:
    s_waitcnt vmcnt(5)
L_gemm1_kernel_w_71:
    s_barrier
    ds_read_b128 v[28:31], v18 offset:0
    ds_read_b128 v[32:35], v18 offset:1024
    s_waitcnt lgkmcnt(12)
    v_mfma_f32_16x16x32_bf16 a[80:83], v[48:51], v[36:39], a[80:83]
    v_mfma_f32_16x16x32_bf16 a[84:87], v[48:51], v[40:43], a[84:87]
    ds_read_b64_tr_b16 v[44:45], v19 offset:0
    ds_read_b64_tr_b16 v[46:47], v20 offset:0
    s_waitcnt lgkmcnt(12)
    v_mfma_f32_16x16x32_bf16 a[88:91], v[52:55], v[36:39], a[88:91]
    v_mfma_f32_16x16x32_bf16 a[92:95], v[52:55], v[40:43], a[92:95]
    ds_read_b64_tr_b16 v[48:49], v19 offset:32
    ds_read_b64_tr_b16 v[50:51], v20 offset:32
    s_waitcnt lgkmcnt(12)
    v_mfma_f32_16x16x32_bf16 a[96:99], v[56:59], v[36:39], a[96:99]
    v_mfma_f32_16x16x32_bf16 a[100:103], v[56:59], v[40:43], a[100:103]
    ds_read_b64_tr_b16 v[52:53], v19 offset:64
    ds_read_b64_tr_b16 v[54:55], v20 offset:64
    s_waitcnt lgkmcnt(12)
    v_mfma_f32_16x16x32_bf16 a[104:107], v[60:63], v[36:39], a[104:107]
    v_mfma_f32_16x16x32_bf16 a[108:111], v[60:63], v[40:43], a[108:111]
    s_waitcnt lgkmcnt(11)
    v_mfma_f32_16x16x32_bf16 a[112:115], v[64:67], v[36:39], a[112:115]
    v_mfma_f32_16x16x32_bf16 a[116:119], v[64:67], v[40:43], a[116:119]
    ds_read_b64_tr_b16 v[56:57], v19 offset:96
    ds_read_b64_tr_b16 v[58:59], v20 offset:96
    s_waitcnt lgkmcnt(12)
    v_mfma_f32_16x16x32_bf16 a[120:123], v[68:71], v[36:39], a[120:123]
    v_mfma_f32_16x16x32_bf16 a[124:127], v[68:71], v[40:43], a[124:127]
    s_waitcnt lgkmcnt(11)
    v_mfma_f32_16x16x32_bf16 a[128:131], v[72:75], v[36:39], a[128:131]
    v_mfma_f32_16x16x32_bf16 a[132:135], v[72:75], v[40:43], a[132:135]
    ds_read_b64_tr_b16 v[60:61], v19 offset:128
    ds_read_b64_tr_b16 v[62:63], v20 offset:128
    s_waitcnt lgkmcnt(12)
    v_mfma_f32_16x16x32_bf16 a[136:139], v[76:79], v[36:39], a[136:139]
    v_mfma_f32_16x16x32_bf16 a[140:143], v[76:79], v[40:43], a[140:143]
    ds_read_b64_tr_b16 v[64:65], v19 offset:160
    ds_read_b64_tr_b16 v[66:67], v20 offset:160
    ds_read_b64_tr_b16 v[68:69], v19 offset:192
    ds_read_b64_tr_b16 v[70:71], v20 offset:192
    s_waitcnt lgkmcnt(12)
    v_mfma_f32_16x16x32_bf16 a[0:3], v[44:47], v[28:31], a[0:3]
    v_mfma_f32_16x16x32_bf16 a[4:7], v[44:47], v[32:35], a[4:7]
    ds_read_b64_tr_b16 v[72:73], v21 offset:0
    ds_read_b64_tr_b16 v[74:75], v22 offset:0
    s_waitcnt lgkmcnt(12)
    v_mfma_f32_16x16x32_bf16 a[8:11], v[48:51], v[28:31], a[8:11]
    v_mfma_f32_16x16x32_bf16 a[12:15], v[48:51], v[32:35], a[12:15]
    ds_read_b64_tr_b16 v[76:77], v21 offset:32
    ds_read_b64_tr_b16 v[78:79], v22 offset:32
    s_waitcnt lgkmcnt(12)
    v_mfma_f32_16x16x32_bf16 a[16:19], v[52:55], v[28:31], a[16:19]
    v_mfma_f32_16x16x32_bf16 a[20:23], v[52:55], v[32:35], a[20:23]
    ds_read_b64_tr_b16 v[44:45], v21 offset:64
    ds_read_b64_tr_b16 v[46:47], v22 offset:64
    s_waitcnt lgkmcnt(12)
    v_mfma_f32_16x16x32_bf16 a[24:27], v[56:59], v[28:31], a[24:27]
    v_mfma_f32_16x16x32_bf16 a[28:31], v[56:59], v[32:35], a[28:31]
    ds_read_b64_tr_b16 v[48:49], v21 offset:96
    ds_read_b64_tr_b16 v[50:51], v22 offset:96
    s_waitcnt lgkmcnt(12)
    v_mfma_f32_16x16x32_bf16 a[32:35], v[60:63], v[28:31], a[32:35]
    v_mfma_f32_16x16x32_bf16 a[36:39], v[60:63], v[32:35], a[36:39]
    ds_read_b64_tr_b16 v[52:53], v21 offset:128
    ds_read_b64_tr_b16 v[54:55], v22 offset:128
    s_waitcnt lgkmcnt(12)
    v_mfma_f32_16x16x32_bf16 a[40:43], v[64:67], v[28:31], a[40:43]
    v_mfma_f32_16x16x32_bf16 a[44:47], v[64:67], v[32:35], a[44:47]
    ds_read_b64_tr_b16 v[56:57], v21 offset:160
    ds_read_b64_tr_b16 v[58:59], v22 offset:160
    s_waitcnt lgkmcnt(12)
    v_mfma_f32_16x16x32_bf16 a[48:51], v[68:71], v[28:31], a[48:51]
    v_mfma_f32_16x16x32_bf16 a[52:55], v[68:71], v[32:35], a[52:55]
    ds_read_b64_tr_b16 v[60:61], v21 offset:192
    ds_read_b64_tr_b16 v[62:63], v22 offset:192
    s_waitcnt lgkmcnt(12)
    v_mfma_f32_16x16x32_bf16 a[56:59], v[72:75], v[28:31], a[56:59]
    v_mfma_f32_16x16x32_bf16 a[60:63], v[72:75], v[32:35], a[60:63]
    ds_read_b128 v[64:67], v23 offset:0
    ds_read_b128 v[68:71], v24 offset:0
    s_waitcnt lgkmcnt(12)
    v_mfma_f32_16x16x32_bf16 a[64:67], v[76:79], v[28:31], a[64:67]
    v_mfma_f32_16x16x32_bf16 a[68:71], v[76:79], v[32:35], a[68:71]
    ds_read_b128 v[72:75], v23 offset:1024
    ds_read_b128 v[76:79], v24 offset:1024
    s_waitcnt lgkmcnt(12)
    v_mfma_f32_16x16x32_bf16 a[72:75], v[44:47], v[28:31], a[72:75]
    v_mfma_f32_16x16x32_bf16 a[76:79], v[44:47], v[32:35], a[76:79]
    s_waitcnt vmcnt(0)
    s_barrier
    ds_read_b128 v[36:39], v18 offset:34816
    ds_read_b128 v[40:43], v18 offset:35840
    s_waitcnt lgkmcnt(12)
    v_mfma_f32_16x16x32_bf16 a[80:83], v[48:51], v[28:31], a[80:83]
    v_mfma_f32_16x16x32_bf16 a[84:87], v[48:51], v[32:35], a[84:87]
    ds_read_b64_tr_b16 v[44:45], v19 offset:34816
    ds_read_b64_tr_b16 v[46:47], v20 offset:34816
    s_waitcnt lgkmcnt(12)
    v_mfma_f32_16x16x32_bf16 a[88:91], v[52:55], v[28:31], a[88:91]
    v_mfma_f32_16x16x32_bf16 a[92:95], v[52:55], v[32:35], a[92:95]
    ds_read_b64_tr_b16 v[48:49], v19 offset:34848
    ds_read_b64_tr_b16 v[50:51], v20 offset:34848
    s_waitcnt lgkmcnt(12)
    v_mfma_f32_16x16x32_bf16 a[96:99], v[56:59], v[28:31], a[96:99]
    v_mfma_f32_16x16x32_bf16 a[100:103], v[56:59], v[32:35], a[100:103]
    ds_read_b64_tr_b16 v[52:53], v19 offset:34880
    ds_read_b64_tr_b16 v[54:55], v20 offset:34880
    s_waitcnt lgkmcnt(12)
    v_mfma_f32_16x16x32_bf16 a[104:107], v[60:63], v[28:31], a[104:107]
    v_mfma_f32_16x16x32_bf16 a[108:111], v[60:63], v[32:35], a[108:111]
    s_waitcnt lgkmcnt(11)
    v_mfma_f32_16x16x32_bf16 a[112:115], v[64:67], v[28:31], a[112:115]
    v_mfma_f32_16x16x32_bf16 a[116:119], v[64:67], v[32:35], a[116:119]
    ds_read_b64_tr_b16 v[56:57], v19 offset:34912
    ds_read_b64_tr_b16 v[58:59], v20 offset:34912
    s_waitcnt lgkmcnt(12)
    v_mfma_f32_16x16x32_bf16 a[120:123], v[68:71], v[28:31], a[120:123]
    v_mfma_f32_16x16x32_bf16 a[124:127], v[68:71], v[32:35], a[124:127]
    s_waitcnt lgkmcnt(11)
    v_mfma_f32_16x16x32_bf16 a[128:131], v[72:75], v[28:31], a[128:131]
    v_mfma_f32_16x16x32_bf16 a[132:135], v[72:75], v[32:35], a[132:135]
    ds_read_b64_tr_b16 v[60:61], v19 offset:34944
    ds_read_b64_tr_b16 v[62:63], v20 offset:34944
    s_waitcnt lgkmcnt(12)
    v_mfma_f32_16x16x32_bf16 a[136:139], v[76:79], v[28:31], a[136:139]
    v_mfma_f32_16x16x32_bf16 a[140:143], v[76:79], v[32:35], a[140:143]
    ds_read_b64_tr_b16 v[64:65], v19 offset:34976
    ds_read_b64_tr_b16 v[66:67], v20 offset:34976
    ds_read_b64_tr_b16 v[68:69], v19 offset:35008
    ds_read_b64_tr_b16 v[70:71], v20 offset:35008
    s_waitcnt lgkmcnt(12)
    v_mfma_f32_16x16x32_bf16 a[0:3], v[44:47], v[36:39], a[0:3]
    v_mfma_f32_16x16x32_bf16 a[4:7], v[44:47], v[40:43], a[4:7]
    ds_read_b64_tr_b16 v[72:73], v21 offset:34816
    ds_read_b64_tr_b16 v[74:75], v22 offset:34816
    s_waitcnt lgkmcnt(12)
    v_mfma_f32_16x16x32_bf16 a[8:11], v[48:51], v[36:39], a[8:11]
    v_mfma_f32_16x16x32_bf16 a[12:15], v[48:51], v[40:43], a[12:15]
    ds_read_b64_tr_b16 v[76:77], v21 offset:34848
    ds_read_b64_tr_b16 v[78:79], v22 offset:34848
    s_waitcnt lgkmcnt(12)
    v_mfma_f32_16x16x32_bf16 a[16:19], v[52:55], v[36:39], a[16:19]
    v_mfma_f32_16x16x32_bf16 a[20:23], v[52:55], v[40:43], a[20:23]
    ds_read_b64_tr_b16 v[44:45], v21 offset:34880
    ds_read_b64_tr_b16 v[46:47], v22 offset:34880
    s_waitcnt lgkmcnt(12)
    v_mfma_f32_16x16x32_bf16 a[24:27], v[56:59], v[36:39], a[24:27]
    v_mfma_f32_16x16x32_bf16 a[28:31], v[56:59], v[40:43], a[28:31]
    ds_read_b64_tr_b16 v[48:49], v21 offset:34912
    ds_read_b64_tr_b16 v[50:51], v22 offset:34912
    s_waitcnt lgkmcnt(12)
    v_mfma_f32_16x16x32_bf16 a[32:35], v[60:63], v[36:39], a[32:35]
    v_mfma_f32_16x16x32_bf16 a[36:39], v[60:63], v[40:43], a[36:39]
    ds_read_b64_tr_b16 v[52:53], v21 offset:34944
    ds_read_b64_tr_b16 v[54:55], v22 offset:34944
    s_waitcnt lgkmcnt(12)
    v_mfma_f32_16x16x32_bf16 a[40:43], v[64:67], v[36:39], a[40:43]
    v_mfma_f32_16x16x32_bf16 a[44:47], v[64:67], v[40:43], a[44:47]
    ds_read_b64_tr_b16 v[56:57], v21 offset:34976
    ds_read_b64_tr_b16 v[58:59], v22 offset:34976
    s_waitcnt lgkmcnt(12)
    v_mfma_f32_16x16x32_bf16 a[48:51], v[68:71], v[36:39], a[48:51]
    v_mfma_f32_16x16x32_bf16 a[52:55], v[68:71], v[40:43], a[52:55]
    ds_read_b64_tr_b16 v[60:61], v21 offset:35008
    ds_read_b64_tr_b16 v[62:63], v22 offset:35008
    s_waitcnt lgkmcnt(12)
    v_mfma_f32_16x16x32_bf16 a[56:59], v[72:75], v[36:39], a[56:59]
    v_mfma_f32_16x16x32_bf16 a[60:63], v[72:75], v[40:43], a[60:63]
    ds_read_b128 v[64:67], v23 offset:34816
    ds_read_b128 v[68:71], v24 offset:34816
    s_waitcnt lgkmcnt(12)
    v_mfma_f32_16x16x32_bf16 a[64:67], v[76:79], v[36:39], a[64:67]
    v_mfma_f32_16x16x32_bf16 a[68:71], v[76:79], v[40:43], a[68:71]
    ds_read_b128 v[72:75], v23 offset:35840
    ds_read_b128 v[76:79], v24 offset:35840
    s_waitcnt lgkmcnt(12)
    v_mfma_f32_16x16x32_bf16 a[72:75], v[44:47], v[36:39], a[72:75]
    v_mfma_f32_16x16x32_bf16 a[76:79], v[44:47], v[40:43], a[76:79]
    s_waitcnt lgkmcnt(10)
    v_mfma_f32_16x16x32_bf16 a[80:83], v[48:51], v[36:39], a[80:83]
    v_mfma_f32_16x16x32_bf16 a[84:87], v[48:51], v[40:43], a[84:87]
    s_waitcnt lgkmcnt(8)
    v_mfma_f32_16x16x32_bf16 a[88:91], v[52:55], v[36:39], a[88:91]
    v_mfma_f32_16x16x32_bf16 a[92:95], v[52:55], v[40:43], a[92:95]
    s_waitcnt lgkmcnt(6)
    v_mfma_f32_16x16x32_bf16 a[96:99], v[56:59], v[36:39], a[96:99]
    v_mfma_f32_16x16x32_bf16 a[100:103], v[56:59], v[40:43], a[100:103]
    s_waitcnt lgkmcnt(4)
    v_mfma_f32_16x16x32_bf16 a[104:107], v[60:63], v[36:39], a[104:107]
    v_mfma_f32_16x16x32_bf16 a[108:111], v[60:63], v[40:43], a[108:111]
    s_waitcnt lgkmcnt(3)
    v_mfma_f32_16x16x32_bf16 a[112:115], v[64:67], v[36:39], a[112:115]
    v_mfma_f32_16x16x32_bf16 a[116:119], v[64:67], v[40:43], a[116:119]
    s_waitcnt lgkmcnt(2)
    v_mfma_f32_16x16x32_bf16 a[120:123], v[68:71], v[36:39], a[120:123]
    v_mfma_f32_16x16x32_bf16 a[124:127], v[68:71], v[40:43], a[124:127]
    s_waitcnt lgkmcnt(1)
    v_mfma_f32_16x16x32_bf16 a[128:131], v[72:75], v[36:39], a[128:131]
    v_mfma_f32_16x16x32_bf16 a[132:135], v[72:75], v[40:43], a[132:135]
    s_waitcnt lgkmcnt(0)
    v_mfma_f32_16x16x32_bf16 a[136:139], v[76:79], v[36:39], a[136:139]
    v_mfma_f32_16x16x32_bf16 a[140:143], v[76:79], v[40:43], a[140:143]
    s_nop 7
    s_nop 7
    v_and_b32 v2, 15, v1
    s_lshl_b32 s58, s57, 8
    s_lshl_b32 s59, s40, 5
    s_add_u32 s58, s58, s59
    v_add_u32 v2, s58, v2
    v_lshrrev_b32 v3, 4, v1
    v_lshlrev_b32 v3, 2, v3
    s_mov_b32 s58, 7168
    v_mul_lo_u32 v5, v2, s58
    s_mul_i32 s59, s56, 224
    v_lshlrev_b32 v6, 1, v3
    v_add3_u32 v5, v5, v6, s59
    v_lshlrev_b32 v7, 12, v2
    s_lshl_b32 s59, s56, 7
    v_lshlrev_b32 v6, 2, v3
    v_add3_u32 v7, v7, v6, s59
    v_accvgpr_read_b32 v8, a0
    v_accvgpr_read_b32 v12, a56
    v_accvgpr_read_b32 v9, a1
    v_accvgpr_read_b32 v13, a57
    v_accvgpr_read_b32 v10, a2
    v_accvgpr_read_b32 v14, a58
    v_accvgpr_read_b32 v11, a3
    v_accvgpr_read_b32 v15, a59
    v_cvt_pk_bf16_f32 v16, v8, v9
    v_cvt_pk_bf16_f32 v17, v10, v11
    v_cvt_pk_bf16_f32 v18, v12, v13
    v_cvt_pk_bf16_f32 v19, v14, v15
    v_lshlrev_b32 v8, 16, v16
    v_lshlrev_b32 v12, 16, v18
    v_and_b32 v9, 0xffff0000, v16
    v_and_b32 v13, 0xffff0000, v18
    v_lshlrev_b32 v10, 16, v17
    v_lshlrev_b32 v14, 16, v19
    v_and_b32 v11, 0xffff0000, v17
    v_and_b32 v15, 0xffff0000, v19
    v_mul_f32 v20, v8, v8
    v_mul_f32 v21, 0x3d372713, v20
    v_fma_f32 v21, v21, v8, v8
    v_mul_f32 v21, 0x40135761, v21
    v_exp_f32 v21, v21
    s_nop 0
    v_add_f32 v21, 1.0, v21
    v_rcp_f32 v21, v21
    s_nop 0
    v_fma_f32 v21, v21, -2.0, 1.0
    v_add_f32 v21, 1.0, v21
    v_mul_f32 v20, 0.5, v8
    v_mul_f32 v8, v20, v21
    v_mul_f32 v20, v9, v9
    v_mul_f32 v21, 0x3d372713, v20
    v_fma_f32 v21, v21, v9, v9
    v_mul_f32 v21, 0x40135761, v21
    v_exp_f32 v21, v21
    s_nop 0
    v_add_f32 v21, 1.0, v21
    v_rcp_f32 v21, v21
    s_nop 0
    v_fma_f32 v21, v21, -2.0, 1.0
    v_add_f32 v21, 1.0, v21
    v_mul_f32 v20, 0.5, v9
    v_mul_f32 v9, v20, v21
    v_mul_f32 v20, v10, v10
    v_mul_f32 v21, 0x3d372713, v20
    v_fma_f32 v21, v21, v10, v10
    v_mul_f32 v21, 0x40135761, v21
    v_exp_f32 v21, v21
    s_nop 0
    v_add_f32 v21, 1.0, v21
    v_rcp_f32 v21, v21
    s_nop 0
    v_fma_f32 v21, v21, -2.0, 1.0
    v_add_f32 v21, 1.0, v21
    v_mul_f32 v20, 0.5, v10
    v_mul_f32 v10, v20, v21
    v_mul_f32 v20, v11, v11
    v_mul_f32 v21, 0x3d372713, v20
    v_fma_f32 v21, v21, v11, v11
    v_mul_f32 v21, 0x40135761, v21
    v_exp_f32 v21, v21
    s_nop 0
    v_add_f32 v21, 1.0, v21
    v_rcp_f32 v21, v21
    s_nop 0
    v_fma_f32 v21, v21, -2.0, 1.0
    v_add_f32 v21, 1.0, v21
    v_mul_f32 v20, 0.5, v11
    v_mul_f32 v11, v20, v21
    v_cvt_pk_bf16_f32 v16, v8, v9
    v_cvt_pk_bf16_f32 v17, v10, v11
    v_lshlrev_b32 v8, 16, v16
    v_mul_f32 v8, v8, v12
    v_and_b32 v9, 0xffff0000, v16
    v_mul_f32 v9, v9, v13
    v_lshlrev_b32 v10, 16, v17
    v_mul_f32 v10, v10, v14
    v_and_b32 v11, 0xffff0000, v17
    v_mul_f32 v11, v11, v15
    v_cvt_pk_bf16_f32 v22, v8, v9
    v_cvt_pk_bf16_f32 v23, v10, v11
    buffer_store_dwordx2 v[22:23], v5, s[24:27], 0 offen offset:0
    s_nop 1
    v_accvgpr_read_b32 v8, a4
    v_accvgpr_read_b32 v12, a60
    v_accvgpr_read_b32 v9, a5
    v_accvgpr_read_b32 v13, a61
    v_accvgpr_read_b32 v10, a6
    v_accvgpr_read_b32 v14, a62
    v_accvgpr_read_b32 v11, a7
    v_accvgpr_read_b32 v15, a63
    v_cvt_pk_bf16_f32 v16, v8, v9
    v_cvt_pk_bf16_f32 v17, v10, v11
    v_cvt_pk_bf16_f32 v18, v12, v13
    v_cvt_pk_bf16_f32 v19, v14, v15
    v_lshlrev_b32 v8, 16, v16
    v_lshlrev_b32 v12, 16, v18
    v_and_b32 v9, 0xffff0000, v16
    v_and_b32 v13, 0xffff0000, v18
    v_lshlrev_b32 v10, 16, v17
    v_lshlrev_b32 v14, 16, v19
    v_and_b32 v11, 0xffff0000, v17
    v_and_b32 v15, 0xffff0000, v19
    v_mul_f32 v20, v8, v8
    v_mul_f32 v21, 0x3d372713, v20
    v_fma_f32 v21, v21, v8, v8
    v_mul_f32 v21, 0x40135761, v21
    v_exp_f32 v21, v21
    s_nop 0
    v_add_f32 v21, 1.0, v21
    v_rcp_f32 v21, v21
    s_nop 0
    v_fma_f32 v21, v21, -2.0, 1.0
    v_add_f32 v21, 1.0, v21
    v_mul_f32 v20, 0.5, v8
    v_mul_f32 v8, v20, v21
    v_mul_f32 v20, v9, v9
    v_mul_f32 v21, 0x3d372713, v20
    v_fma_f32 v21, v21, v9, v9
    v_mul_f32 v21, 0x40135761, v21
    v_exp_f32 v21, v21
    s_nop 0
    v_add_f32 v21, 1.0, v21
    v_rcp_f32 v21, v21
    s_nop 0
    v_fma_f32 v21, v21, -2.0, 1.0
    v_add_f32 v21, 1.0, v21
    v_mul_f32 v20, 0.5, v9
    v_mul_f32 v9, v20, v21
    v_mul_f32 v20, v10, v10
    v_mul_f32 v21, 0x3d372713, v20
    v_fma_f32 v21, v21, v10, v10
    v_mul_f32 v21, 0x40135761, v21
    v_exp_f32 v21, v21
    s_nop 0
    v_add_f32 v21, 1.0, v21
    v_rcp_f32 v21, v21
    s_nop 0
    v_fma_f32 v21, v21, -2.0, 1.0
    v_add_f32 v21, 1.0, v21
    v_mul_f32 v20, 0.5, v10
    v_mul_f32 v10, v20, v21
    v_mul_f32 v20, v11, v11
    v_mul_f32 v21, 0x3d372713, v20
    v_fma_f32 v21, v21, v11, v11
    v_mul_f32 v21, 0x40135761, v21
    v_exp_f32 v21, v21
    s_nop 0
    v_add_f32 v21, 1.0, v21
    v_rcp_f32 v21, v21
    s_nop 0
    v_fma_f32 v21, v21, -2.0, 1.0
    v_add_f32 v21, 1.0, v21
    v_mul_f32 v20, 0.5, v11
    v_mul_f32 v11, v20, v21
    v_cvt_pk_bf16_f32 v16, v8, v9
    v_cvt_pk_bf16_f32 v17, v10, v11
    v_lshlrev_b32 v8, 16, v16
    v_mul_f32 v8, v8, v12
    v_and_b32 v9, 0xffff0000, v16
    v_mul_f32 v9, v9, v13
    v_lshlrev_b32 v10, 16, v17
    v_mul_f32 v10, v10, v14
    v_and_b32 v11, 0xffff0000, v17
    v_mul_f32 v11, v11, v15
    v_cvt_pk_bf16_f32 v22, v8, v9
    v_cvt_pk_bf16_f32 v23, v10, v11
    v_add_u32 v6, 114688, v5
    buffer_store_dwordx2 v[22:23], v6, s[24:27], 0 offen offset:0
    s_nop 1
    v_accvgpr_read_b32 v8, a8
    v_accvgpr_read_b32 v12, a64
    v_accvgpr_read_b32 v9, a9
    v_accvgpr_read_b32 v13, a65
    v_accvgpr_read_b32 v10, a10
    v_accvgpr_read_b32 v14, a66
    v_accvgpr_read_b32 v11, a11
    v_accvgpr_read_b32 v15, a67
    v_cvt_pk_bf16_f32 v16, v8, v9
    v_cvt_pk_bf16_f32 v17, v10, v11
    v_cvt_pk_bf16_f32 v18, v12, v13
    v_cvt_pk_bf16_f32 v19, v14, v15
    v_lshlrev_b32 v8, 16, v16
    v_lshlrev_b32 v12, 16, v18
    v_and_b32 v9, 0xffff0000, v16
    v_and_b32 v13, 0xffff0000, v18
    v_lshlrev_b32 v10, 16, v17
    v_lshlrev_b32 v14, 16, v19
    v_and_b32 v11, 0xffff0000, v17
    v_and_b32 v15, 0xffff0000, v19
    v_mul_f32 v20, v8, v8
    v_mul_f32 v21, 0x3d372713, v20
    v_fma_f32 v21, v21, v8, v8
    v_mul_f32 v21, 0x40135761, v21
    v_exp_f32 v21, v21
    s_nop 0
    v_add_f32 v21, 1.0, v21
    v_rcp_f32 v21, v21
    s_nop 0
    v_fma_f32 v21, v21, -2.0, 1.0
    v_add_f32 v21, 1.0, v21
    v_mul_f32 v20, 0.5, v8
    v_mul_f32 v8, v20, v21
    v_mul_f32 v20, v9, v9
    v_mul_f32 v21, 0x3d372713, v20
    v_fma_f32 v21, v21, v9, v9
    v_mul_f32 v21, 0x40135761, v21
    v_exp_f32 v21, v21
    s_nop 0
    v_add_f32 v21, 1.0, v21
    v_rcp_f32 v21, v21
    s_nop 0
    v_fma_f32 v21, v21, -2.0, 1.0
    v_add_f32 v21, 1.0, v21
    v_mul_f32 v20, 0.5, v9
    v_mul_f32 v9, v20, v21
    v_mul_f32 v20, v10, v10
    v_mul_f32 v21, 0x3d372713, v20
    v_fma_f32 v21, v21, v10, v10
    v_mul_f32 v21, 0x40135761, v21
    v_exp_f32 v21, v21
    s_nop 0
    v_add_f32 v21, 1.0, v21
    v_rcp_f32 v21, v21
    s_nop 0
    v_fma_f32 v21, v21, -2.0, 1.0
    v_add_f32 v21, 1.0, v21
    v_mul_f32 v20, 0.5, v10
    v_mul_f32 v10, v20, v21
    v_mul_f32 v20, v11, v11
    v_mul_f32 v21, 0x3d372713, v20
    v_fma_f32 v21, v21, v11, v11
    v_mul_f32 v21, 0x40135761, v21
    v_exp_f32 v21, v21
    s_nop 0
    v_add_f32 v21, 1.0, v21
    v_rcp_f32 v21, v21
    s_nop 0
    v_fma_f32 v21, v21, -2.0, 1.0
    v_add_f32 v21, 1.0, v21
    v_mul_f32 v20, 0.5, v11
    v_mul_f32 v11, v20, v21
    v_cvt_pk_bf16_f32 v16, v8, v9
    v_cvt_pk_bf16_f32 v17, v10, v11
    v_lshlrev_b32 v8, 16, v16
    v_mul_f32 v8, v8, v12
    v_and_b32 v9, 0xffff0000, v16
    v_mul_f32 v9, v9, v13
    v_lshlrev_b32 v10, 16, v17
    v_mul_f32 v10, v10, v14
    v_and_b32 v11, 0xffff0000, v17
    v_mul_f32 v11, v11, v15
    v_cvt_pk_bf16_f32 v22, v8, v9
    v_cvt_pk_bf16_f32 v23, v10, v11
    buffer_store_dwordx2 v[22:23], v5, s[24:27], 0 offen offset:32
    s_nop 1
    v_accvgpr_read_b32 v8, a12
    v_accvgpr_read_b32 v12, a68
    v_accvgpr_read_b32 v9, a13
    v_accvgpr_read_b32 v13, a69
    v_accvgpr_read_b32 v10, a14
    v_accvgpr_read_b32 v14, a70
    v_accvgpr_read_b32 v11, a15
    v_accvgpr_read_b32 v15, a71
    v_cvt_pk_bf16_f32 v16, v8, v9
    v_cvt_pk_bf16_f32 v17, v10, v11
    v_cvt_pk_bf16_f32 v18, v12, v13
    v_cvt_pk_bf16_f32 v19, v14, v15
    v_lshlrev_b32 v8, 16, v16
    v_lshlrev_b32 v12, 16, v18
    v_and_b32 v9, 0xffff0000, v16
    v_and_b32 v13, 0xffff0000, v18
    v_lshlrev_b32 v10, 16, v17
    v_lshlrev_b32 v14, 16, v19
    v_and_b32 v11, 0xffff0000, v17
    v_and_b32 v15, 0xffff0000, v19
    v_mul_f32 v20, v8, v8
    v_mul_f32 v21, 0x3d372713, v20
    v_fma_f32 v21, v21, v8, v8
    v_mul_f32 v21, 0x40135761, v21
    v_exp_f32 v21, v21
    s_nop 0
    v_add_f32 v21, 1.0, v21
    v_rcp_f32 v21, v21
    s_nop 0
    v_fma_f32 v21, v21, -2.0, 1.0
    v_add_f32 v21, 1.0, v21
    v_mul_f32 v20, 0.5, v8
    v_mul_f32 v8, v20, v21
    v_mul_f32 v20, v9, v9
    v_mul_f32 v21, 0x3d372713, v20
    v_fma_f32 v21, v21, v9, v9
    v_mul_f32 v21, 0x40135761, v21
    v_exp_f32 v21, v21
    s_nop 0
    v_add_f32 v21, 1.0, v21
    v_rcp_f32 v21, v21
    s_nop 0
    v_fma_f32 v21, v21, -2.0, 1.0
    v_add_f32 v21, 1.0, v21
    v_mul_f32 v20, 0.5, v9
    v_mul_f32 v9, v20, v21
    v_mul_f32 v20, v10, v10
    v_mul_f32 v21, 0x3d372713, v20
    v_fma_f32 v21, v21, v10, v10
    v_mul_f32 v21, 0x40135761, v21
    v_exp_f32 v21, v21
    s_nop 0
    v_add_f32 v21, 1.0, v21
    v_rcp_f32 v21, v21
    s_nop 0
    v_fma_f32 v21, v21, -2.0, 1.0
    v_add_f32 v21, 1.0, v21
    v_mul_f32 v20, 0.5, v10
    v_mul_f32 v10, v20, v21
    v_mul_f32 v20, v11, v11
    v_mul_f32 v21, 0x3d372713, v20
    v_fma_f32 v21, v21, v11, v11
    v_mul_f32 v21, 0x40135761, v21
    v_exp_f32 v21, v21
    s_nop 0
    v_add_f32 v21, 1.0, v21
    v_rcp_f32 v21, v21
    s_nop 0
    v_fma_f32 v21, v21, -2.0, 1.0
    v_add_f32 v21, 1.0, v21
    v_mul_f32 v20, 0.5, v11
    v_mul_f32 v11, v20, v21
    v_cvt_pk_bf16_f32 v16, v8, v9
    v_cvt_pk_bf16_f32 v17, v10, v11
    v_lshlrev_b32 v8, 16, v16
    v_mul_f32 v8, v8, v12
    v_and_b32 v9, 0xffff0000, v16
    v_mul_f32 v9, v9, v13
    v_lshlrev_b32 v10, 16, v17
    v_mul_f32 v10, v10, v14
    v_and_b32 v11, 0xffff0000, v17
    v_mul_f32 v11, v11, v15
    v_cvt_pk_bf16_f32 v22, v8, v9
    v_cvt_pk_bf16_f32 v23, v10, v11
    v_add_u32 v6, 114688, v5
    buffer_store_dwordx2 v[22:23], v6, s[24:27], 0 offen offset:32
    s_nop 1
    v_accvgpr_read_b32 v8, a16
    v_accvgpr_read_b32 v12, a72
    v_accvgpr_read_b32 v9, a17
    v_accvgpr_read_b32 v13, a73
    v_accvgpr_read_b32 v10, a18
    v_accvgpr_read_b32 v14, a74
    v_accvgpr_read_b32 v11, a19
    v_accvgpr_read_b32 v15, a75
    v_cvt_pk_bf16_f32 v16, v8, v9
    v_cvt_pk_bf16_f32 v17, v10, v11
    v_cvt_pk_bf16_f32 v18, v12, v13
    v_cvt_pk_bf16_f32 v19, v14, v15
    v_lshlrev_b32 v8, 16, v16
    v_lshlrev_b32 v12, 16, v18
    v_and_b32 v9, 0xffff0000, v16
    v_and_b32 v13, 0xffff0000, v18
    v_lshlrev_b32 v10, 16, v17
    v_lshlrev_b32 v14, 16, v19
    v_and_b32 v11, 0xffff0000, v17
    v_and_b32 v15, 0xffff0000, v19
    v_mul_f32 v20, v8, v8
    v_mul_f32 v21, 0x3d372713, v20
    v_fma_f32 v21, v21, v8, v8
    v_mul_f32 v21, 0x40135761, v21
    v_exp_f32 v21, v21
    s_nop 0
    v_add_f32 v21, 1.0, v21
    v_rcp_f32 v21, v21
    s_nop 0
    v_fma_f32 v21, v21, -2.0, 1.0
    v_add_f32 v21, 1.0, v21
    v_mul_f32 v20, 0.5, v8
    v_mul_f32 v8, v20, v21
    v_mul_f32 v20, v9, v9
    v_mul_f32 v21, 0x3d372713, v20
    v_fma_f32 v21, v21, v9, v9
    v_mul_f32 v21, 0x40135761, v21
    v_exp_f32 v21, v21
    s_nop 0
    v_add_f32 v21, 1.0, v21
    v_rcp_f32 v21, v21
    s_nop 0
    v_fma_f32 v21, v21, -2.0, 1.0
    v_add_f32 v21, 1.0, v21
    v_mul_f32 v20, 0.5, v9
    v_mul_f32 v9, v20, v21
    v_mul_f32 v20, v10, v10
    v_mul_f32 v21, 0x3d372713, v20
    v_fma_f32 v21, v21, v10, v10
    v_mul_f32 v21, 0x40135761, v21
    v_exp_f32 v21, v21
    s_nop 0
    v_add_f32 v21, 1.0, v21
    v_rcp_f32 v21, v21
    s_nop 0
    v_fma_f32 v21, v21, -2.0, 1.0
    v_add_f32 v21, 1.0, v21
    v_mul_f32 v20, 0.5, v10
    v_mul_f32 v10, v20, v21
    v_mul_f32 v20, v11, v11
    v_mul_f32 v21, 0x3d372713, v20
    v_fma_f32 v21, v21, v11, v11
    v_mul_f32 v21, 0x40135761, v21
    v_exp_f32 v21, v21
    s_nop 0
    v_add_f32 v21, 1.0, v21
    v_rcp_f32 v21, v21
    s_nop 0
    v_fma_f32 v21, v21, -2.0, 1.0
    v_add_f32 v21, 1.0, v21
    v_mul_f32 v20, 0.5, v11
    v_mul_f32 v11, v20, v21
    v_cvt_pk_bf16_f32 v16, v8, v9
    v_cvt_pk_bf16_f32 v17, v10, v11
    v_lshlrev_b32 v8, 16, v16
    v_mul_f32 v8, v8, v12
    v_and_b32 v9, 0xffff0000, v16
    v_mul_f32 v9, v9, v13
    v_lshlrev_b32 v10, 16, v17
    v_mul_f32 v10, v10, v14
    v_and_b32 v11, 0xffff0000, v17
    v_mul_f32 v11, v11, v15
    v_cvt_pk_bf16_f32 v22, v8, v9
    v_cvt_pk_bf16_f32 v23, v10, v11
    buffer_store_dwordx2 v[22:23], v5, s[24:27], 0 offen offset:64
    s_nop 1
    v_accvgpr_read_b32 v8, a20
    v_accvgpr_read_b32 v12, a76
    v_accvgpr_read_b32 v9, a21
    v_accvgpr_read_b32 v13, a77
    v_accvgpr_read_b32 v10, a22
    v_accvgpr_read_b32 v14, a78
    v_accvgpr_read_b32 v11, a23
    v_accvgpr_read_b32 v15, a79
    v_cvt_pk_bf16_f32 v16, v8, v9
    v_cvt_pk_bf16_f32 v17, v10, v11
    v_cvt_pk_bf16_f32 v18, v12, v13
    v_cvt_pk_bf16_f32 v19, v14, v15
    v_lshlrev_b32 v8, 16, v16
    v_lshlrev_b32 v12, 16, v18
    v_and_b32 v9, 0xffff0000, v16
    v_and_b32 v13, 0xffff0000, v18
    v_lshlrev_b32 v10, 16, v17
    v_lshlrev_b32 v14, 16, v19
    v_and_b32 v11, 0xffff0000, v17
    v_and_b32 v15, 0xffff0000, v19
    v_mul_f32 v20, v8, v8
    v_mul_f32 v21, 0x3d372713, v20
    v_fma_f32 v21, v21, v8, v8
    v_mul_f32 v21, 0x40135761, v21
    v_exp_f32 v21, v21
    s_nop 0
    v_add_f32 v21, 1.0, v21
    v_rcp_f32 v21, v21
    s_nop 0
    v_fma_f32 v21, v21, -2.0, 1.0
    v_add_f32 v21, 1.0, v21
    v_mul_f32 v20, 0.5, v8
    v_mul_f32 v8, v20, v21
    v_mul_f32 v20, v9, v9
    v_mul_f32 v21, 0x3d372713, v20
    v_fma_f32 v21, v21, v9, v9
    v_mul_f32 v21, 0x40135761, v21
    v_exp_f32 v21, v21
    s_nop 0
    v_add_f32 v21, 1.0, v21
    v_rcp_f32 v21, v21
    s_nop 0
    v_fma_f32 v21, v21, -2.0, 1.0
    v_add_f32 v21, 1.0, v21
    v_mul_f32 v20, 0.5, v9
    v_mul_f32 v9, v20, v21
    v_mul_f32 v20, v10, v10
    v_mul_f32 v21, 0x3d372713, v20
    v_fma_f32 v21, v21, v10, v10
    v_mul_f32 v21, 0x40135761, v21
    v_exp_f32 v21, v21
    s_nop 0
    v_add_f32 v21, 1.0, v21
    v_rcp_f32 v21, v21
    s_nop 0
    v_fma_f32 v21, v21, -2.0, 1.0
    v_add_f32 v21, 1.0, v21
    v_mul_f32 v20, 0.5, v10
    v_mul_f32 v10, v20, v21
    v_mul_f32 v20, v11, v11
    v_mul_f32 v21, 0x3d372713, v20
    v_fma_f32 v21, v21, v11, v11
    v_mul_f32 v21, 0x40135761, v21
    v_exp_f32 v21, v21
    s_nop 0
    v_add_f32 v21, 1.0, v21
    v_rcp_f32 v21, v21
    s_nop 0
    v_fma_f32 v21, v21, -2.0, 1.0
    v_add_f32 v21, 1.0, v21
    v_mul_f32 v20, 0.5, v11
    v_mul_f32 v11, v20, v21
    v_cvt_pk_bf16_f32 v16, v8, v9
    v_cvt_pk_bf16_f32 v17, v10, v11
    v_lshlrev_b32 v8, 16, v16
    v_mul_f32 v8, v8, v12
    v_and_b32 v9, 0xffff0000, v16
    v_mul_f32 v9, v9, v13
    v_lshlrev_b32 v10, 16, v17
    v_mul_f32 v10, v10, v14
    v_and_b32 v11, 0xffff0000, v17
    v_mul_f32 v11, v11, v15
    v_cvt_pk_bf16_f32 v22, v8, v9
    v_cvt_pk_bf16_f32 v23, v10, v11
    v_add_u32 v6, 114688, v5
    buffer_store_dwordx2 v[22:23], v6, s[24:27], 0 offen offset:64
    s_nop 1
    v_accvgpr_read_b32 v8, a24
    v_accvgpr_read_b32 v12, a80
    v_accvgpr_read_b32 v9, a25
    v_accvgpr_read_b32 v13, a81
    v_accvgpr_read_b32 v10, a26
    v_accvgpr_read_b32 v14, a82
    v_accvgpr_read_b32 v11, a27
    v_accvgpr_read_b32 v15, a83
    v_cvt_pk_bf16_f32 v16, v8, v9
    v_cvt_pk_bf16_f32 v17, v10, v11
    v_cvt_pk_bf16_f32 v18, v12, v13
    v_cvt_pk_bf16_f32 v19, v14, v15
    v_lshlrev_b32 v8, 16, v16
    v_lshlrev_b32 v12, 16, v18
    v_and_b32 v9, 0xffff0000, v16
    v_and_b32 v13, 0xffff0000, v18
    v_lshlrev_b32 v10, 16, v17
    v_lshlrev_b32 v14, 16, v19
    v_and_b32 v11, 0xffff0000, v17
    v_and_b32 v15, 0xffff0000, v19
    v_mul_f32 v20, v8, v8
    v_mul_f32 v21, 0x3d372713, v20
    v_fma_f32 v21, v21, v8, v8
    v_mul_f32 v21, 0x40135761, v21
    v_exp_f32 v21, v21
    s_nop 0
    v_add_f32 v21, 1.0, v21
    v_rcp_f32 v21, v21
    s_nop 0
    v_fma_f32 v21, v21, -2.0, 1.0
    v_add_f32 v21, 1.0, v21
    v_mul_f32 v20, 0.5, v8
    v_mul_f32 v8, v20, v21
    v_mul_f32 v20, v9, v9
    v_mul_f32 v21, 0x3d372713, v20
    v_fma_f32 v21, v21, v9, v9
    v_mul_f32 v21, 0x40135761, v21
    v_exp_f32 v21, v21
    s_nop 0
    v_add_f32 v21, 1.0, v21
    v_rcp_f32 v21, v21
    s_nop 0
    v_fma_f32 v21, v21, -2.0, 1.0
    v_add_f32 v21, 1.0, v21
    v_mul_f32 v20, 0.5, v9
    v_mul_f32 v9, v20, v21
    v_mul_f32 v20, v10, v10
    v_mul_f32 v21, 0x3d372713, v20
    v_fma_f32 v21, v21, v10, v10
    v_mul_f32 v21, 0x40135761, v21
    v_exp_f32 v21, v21
    s_nop 0
    v_add_f32 v21, 1.0, v21
    v_rcp_f32 v21, v21
    s_nop 0
    v_fma_f32 v21, v21, -2.0, 1.0
    v_add_f32 v21, 1.0, v21
    v_mul_f32 v20, 0.5, v10
    v_mul_f32 v10, v20, v21
    v_mul_f32 v20, v11, v11
    v_mul_f32 v21, 0x3d372713, v20
    v_fma_f32 v21, v21, v11, v11
    v_mul_f32 v21, 0x40135761, v21
    v_exp_f32 v21, v21
    s_nop 0
    v_add_f32 v21, 1.0, v21
    v_rcp_f32 v21, v21
    s_nop 0
    v_fma_f32 v21, v21, -2.0, 1.0
    v_add_f32 v21, 1.0, v21
    v_mul_f32 v20, 0.5, v11
    v_mul_f32 v11, v20, v21
    v_cvt_pk_bf16_f32 v16, v8, v9
    v_cvt_pk_bf16_f32 v17, v10, v11
    v_lshlrev_b32 v8, 16, v16
    v_mul_f32 v8, v8, v12
    v_and_b32 v9, 0xffff0000, v16
    v_mul_f32 v9, v9, v13
    v_lshlrev_b32 v10, 16, v17
    v_mul_f32 v10, v10, v14
    v_and_b32 v11, 0xffff0000, v17
    v_mul_f32 v11, v11, v15
    v_cvt_pk_bf16_f32 v22, v8, v9
    v_cvt_pk_bf16_f32 v23, v10, v11
    buffer_store_dwordx2 v[22:23], v5, s[24:27], 0 offen offset:96
    s_nop 1
    v_accvgpr_read_b32 v8, a28
    v_accvgpr_read_b32 v12, a84
    v_accvgpr_read_b32 v9, a29
    v_accvgpr_read_b32 v13, a85
    v_accvgpr_read_b32 v10, a30
    v_accvgpr_read_b32 v14, a86
    v_accvgpr_read_b32 v11, a31
    v_accvgpr_read_b32 v15, a87
    v_cvt_pk_bf16_f32 v16, v8, v9
    v_cvt_pk_bf16_f32 v17, v10, v11
    v_cvt_pk_bf16_f32 v18, v12, v13
    v_cvt_pk_bf16_f32 v19, v14, v15
    v_lshlrev_b32 v8, 16, v16
    v_lshlrev_b32 v12, 16, v18
    v_and_b32 v9, 0xffff0000, v16
    v_and_b32 v13, 0xffff0000, v18
    v_lshlrev_b32 v10, 16, v17
    v_lshlrev_b32 v14, 16, v19
    v_and_b32 v11, 0xffff0000, v17
    v_and_b32 v15, 0xffff0000, v19
    v_mul_f32 v20, v8, v8
    v_mul_f32 v21, 0x3d372713, v20
    v_fma_f32 v21, v21, v8, v8
    v_mul_f32 v21, 0x40135761, v21
    v_exp_f32 v21, v21
    s_nop 0
    v_add_f32 v21, 1.0, v21
    v_rcp_f32 v21, v21
    s_nop 0
    v_fma_f32 v21, v21, -2.0, 1.0
    v_add_f32 v21, 1.0, v21
    v_mul_f32 v20, 0.5, v8
    v_mul_f32 v8, v20, v21
    v_mul_f32 v20, v9, v9
    v_mul_f32 v21, 0x3d372713, v20
    v_fma_f32 v21, v21, v9, v9
    v_mul_f32 v21, 0x40135761, v21
    v_exp_f32 v21, v21
    s_nop 0
    v_add_f32 v21, 1.0, v21
    v_rcp_f32 v21, v21
    s_nop 0
    v_fma_f32 v21, v21, -2.0, 1.0
    v_add_f32 v21, 1.0, v21
    v_mul_f32 v20, 0.5, v9
    v_mul_f32 v9, v20, v21
    v_mul_f32 v20, v10, v10
    v_mul_f32 v21, 0x3d372713, v20
    v_fma_f32 v21, v21, v10, v10
    v_mul_f32 v21, 0x40135761, v21
    v_exp_f32 v21, v21
    s_nop 0
    v_add_f32 v21, 1.0, v21
    v_rcp_f32 v21, v21
    s_nop 0
    v_fma_f32 v21, v21, -2.0, 1.0
    v_add_f32 v21, 1.0, v21
    v_mul_f32 v20, 0.5, v10
    v_mul_f32 v10, v20, v21
    v_mul_f32 v20, v11, v11
    v_mul_f32 v21, 0x3d372713, v20
    v_fma_f32 v21, v21, v11, v11
    v_mul_f32 v21, 0x40135761, v21
    v_exp_f32 v21, v21
    s_nop 0
    v_add_f32 v21, 1.0, v21
    v_rcp_f32 v21, v21
    s_nop 0
    v_fma_f32 v21, v21, -2.0, 1.0
    v_add_f32 v21, 1.0, v21
    v_mul_f32 v20, 0.5, v11
    v_mul_f32 v11, v20, v21
    v_cvt_pk_bf16_f32 v16, v8, v9
    v_cvt_pk_bf16_f32 v17, v10, v11
    v_lshlrev_b32 v8, 16, v16
    v_mul_f32 v8, v8, v12
    v_and_b32 v9, 0xffff0000, v16
    v_mul_f32 v9, v9, v13
    v_lshlrev_b32 v10, 16, v17
    v_mul_f32 v10, v10, v14
    v_and_b32 v11, 0xffff0000, v17
    v_mul_f32 v11, v11, v15
    v_cvt_pk_bf16_f32 v22, v8, v9
    v_cvt_pk_bf16_f32 v23, v10, v11
    v_add_u32 v6, 114688, v5
    buffer_store_dwordx2 v[22:23], v6, s[24:27], 0 offen offset:96
    s_nop 1
    v_accvgpr_read_b32 v8, a32
    v_accvgpr_read_b32 v12, a88
    v_accvgpr_read_b32 v9, a33
    v_accvgpr_read_b32 v13, a89
    v_accvgpr_read_b32 v10, a34
    v_accvgpr_read_b32 v14, a90
    v_accvgpr_read_b32 v11, a35
    v_accvgpr_read_b32 v15, a91
    v_cvt_pk_bf16_f32 v16, v8, v9
    v_cvt_pk_bf16_f32 v17, v10, v11
    v_cvt_pk_bf16_f32 v18, v12, v13
    v_cvt_pk_bf16_f32 v19, v14, v15
    v_lshlrev_b32 v8, 16, v16
    v_lshlrev_b32 v12, 16, v18
    v_and_b32 v9, 0xffff0000, v16
    v_and_b32 v13, 0xffff0000, v18
    v_lshlrev_b32 v10, 16, v17
    v_lshlrev_b32 v14, 16, v19
    v_and_b32 v11, 0xffff0000, v17
    v_and_b32 v15, 0xffff0000, v19
    v_mul_f32 v20, v8, v8
    v_mul_f32 v21, 0x3d372713, v20
    v_fma_f32 v21, v21, v8, v8
    v_mul_f32 v21, 0x40135761, v21
    v_exp_f32 v21, v21
    s_nop 0
    v_add_f32 v21, 1.0, v21
    v_rcp_f32 v21, v21
    s_nop 0
    v_fma_f32 v21, v21, -2.0, 1.0
    v_add_f32 v21, 1.0, v21
    v_mul_f32 v20, 0.5, v8
    v_mul_f32 v8, v20, v21
    v_mul_f32 v20, v9, v9
    v_mul_f32 v21, 0x3d372713, v20
    v_fma_f32 v21, v21, v9, v9
    v_mul_f32 v21, 0x40135761, v21
    v_exp_f32 v21, v21
    s_nop 0
    v_add_f32 v21, 1.0, v21
    v_rcp_f32 v21, v21
    s_nop 0
    v_fma_f32 v21, v21, -2.0, 1.0
    v_add_f32 v21, 1.0, v21
    v_mul_f32 v20, 0.5, v9
    v_mul_f32 v9, v20, v21
    v_mul_f32 v20, v10, v10
    v_mul_f32 v21, 0x3d372713, v20
    v_fma_f32 v21, v21, v10, v10
    v_mul_f32 v21, 0x40135761, v21
    v_exp_f32 v21, v21
    s_nop 0
    v_add_f32 v21, 1.0, v21
    v_rcp_f32 v21, v21
    s_nop 0
    v_fma_f32 v21, v21, -2.0, 1.0
    v_add_f32 v21, 1.0, v21
    v_mul_f32 v20, 0.5, v10
    v_mul_f32 v10, v20, v21
    v_mul_f32 v20, v11, v11
    v_mul_f32 v21, 0x3d372713, v20
    v_fma_f32 v21, v21, v11, v11
    v_mul_f32 v21, 0x40135761, v21
    v_exp_f32 v21, v21
    s_nop 0
    v_add_f32 v21, 1.0, v21
    v_rcp_f32 v21, v21
    s_nop 0
    v_fma_f32 v21, v21, -2.0, 1.0
    v_add_f32 v21, 1.0, v21
    v_mul_f32 v20, 0.5, v11
    v_mul_f32 v11, v20, v21
    v_cvt_pk_bf16_f32 v16, v8, v9
    v_cvt_pk_bf16_f32 v17, v10, v11
    v_lshlrev_b32 v8, 16, v16
    v_mul_f32 v8, v8, v12
    v_and_b32 v9, 0xffff0000, v16
    v_mul_f32 v9, v9, v13
    v_lshlrev_b32 v10, 16, v17
    v_mul_f32 v10, v10, v14
    v_and_b32 v11, 0xffff0000, v17
    v_mul_f32 v11, v11, v15
    v_cvt_pk_bf16_f32 v22, v8, v9
    v_cvt_pk_bf16_f32 v23, v10, v11
    buffer_store_dwordx2 v[22:23], v5, s[24:27], 0 offen offset:128
    s_nop 1
    v_accvgpr_read_b32 v8, a36
    v_accvgpr_read_b32 v12, a92
    v_accvgpr_read_b32 v9, a37
    v_accvgpr_read_b32 v13, a93
    v_accvgpr_read_b32 v10, a38
    v_accvgpr_read_b32 v14, a94
    v_accvgpr_read_b32 v11, a39
    v_accvgpr_read_b32 v15, a95
    v_cvt_pk_bf16_f32 v16, v8, v9
    v_cvt_pk_bf16_f32 v17, v10, v11
    v_cvt_pk_bf16_f32 v18, v12, v13
    v_cvt_pk_bf16_f32 v19, v14, v15
    v_lshlrev_b32 v8, 16, v16
    v_lshlrev_b32 v12, 16, v18
    v_and_b32 v9, 0xffff0000, v16
    v_and_b32 v13, 0xffff0000, v18
    v_lshlrev_b32 v10, 16, v17
    v_lshlrev_b32 v14, 16, v19
    v_and_b32 v11, 0xffff0000, v17
    v_and_b32 v15, 0xffff0000, v19
    v_mul_f32 v20, v8, v8
    v_mul_f32 v21, 0x3d372713, v20
    v_fma_f32 v21, v21, v8, v8
    v_mul_f32 v21, 0x40135761, v21
    v_exp_f32 v21, v21
    s_nop 0
    v_add_f32 v21, 1.0, v21
    v_rcp_f32 v21, v21
    s_nop 0
    v_fma_f32 v21, v21, -2.0, 1.0
    v_add_f32 v21, 1.0, v21
    v_mul_f32 v20, 0.5, v8
    v_mul_f32 v8, v20, v21
    v_mul_f32 v20, v9, v9
    v_mul_f32 v21, 0x3d372713, v20
    v_fma_f32 v21, v21, v9, v9
    v_mul_f32 v21, 0x40135761, v21
    v_exp_f32 v21, v21
    s_nop 0
    v_add_f32 v21, 1.0, v21
    v_rcp_f32 v21, v21
    s_nop 0
    v_fma_f32 v21, v21, -2.0, 1.0
    v_add_f32 v21, 1.0, v21
    v_mul_f32 v20, 0.5, v9
    v_mul_f32 v9, v20, v21
    v_mul_f32 v20, v10, v10
    v_mul_f32 v21, 0x3d372713, v20
    v_fma_f32 v21, v21, v10, v10
    v_mul_f32 v21, 0x40135761, v21
    v_exp_f32 v21, v21
    s_nop 0
    v_add_f32 v21, 1.0, v21
    v_rcp_f32 v21, v21
    s_nop 0
    v_fma_f32 v21, v21, -2.0, 1.0
    v_add_f32 v21, 1.0, v21
    v_mul_f32 v20, 0.5, v10
    v_mul_f32 v10, v20, v21
    v_mul_f32 v20, v11, v11
    v_mul_f32 v21, 0x3d372713, v20
    v_fma_f32 v21, v21, v11, v11
    v_mul_f32 v21, 0x40135761, v21
    v_exp_f32 v21, v21
    s_nop 0
    v_add_f32 v21, 1.0, v21
    v_rcp_f32 v21, v21
    s_nop 0
    v_fma_f32 v21, v21, -2.0, 1.0
    v_add_f32 v21, 1.0, v21
    v_mul_f32 v20, 0.5, v11
    v_mul_f32 v11, v20, v21
    v_cvt_pk_bf16_f32 v16, v8, v9
    v_cvt_pk_bf16_f32 v17, v10, v11
    v_lshlrev_b32 v8, 16, v16
    v_mul_f32 v8, v8, v12
    v_and_b32 v9, 0xffff0000, v16
    v_mul_f32 v9, v9, v13
    v_lshlrev_b32 v10, 16, v17
    v_mul_f32 v10, v10, v14
    v_and_b32 v11, 0xffff0000, v17
    v_mul_f32 v11, v11, v15
    v_cvt_pk_bf16_f32 v22, v8, v9
    v_cvt_pk_bf16_f32 v23, v10, v11
    v_add_u32 v6, 114688, v5
    buffer_store_dwordx2 v[22:23], v6, s[24:27], 0 offen offset:128
    s_nop 1
    v_accvgpr_read_b32 v8, a40
    v_accvgpr_read_b32 v12, a96
    v_accvgpr_read_b32 v9, a41
    v_accvgpr_read_b32 v13, a97
    v_accvgpr_read_b32 v10, a42
    v_accvgpr_read_b32 v14, a98
    v_accvgpr_read_b32 v11, a43
    v_accvgpr_read_b32 v15, a99
    v_cvt_pk_bf16_f32 v16, v8, v9
    v_cvt_pk_bf16_f32 v17, v10, v11
    v_cvt_pk_bf16_f32 v18, v12, v13
    v_cvt_pk_bf16_f32 v19, v14, v15
    v_lshlrev_b32 v8, 16, v16
    v_lshlrev_b32 v12, 16, v18
    v_and_b32 v9, 0xffff0000, v16
    v_and_b32 v13, 0xffff0000, v18
    v_lshlrev_b32 v10, 16, v17
    v_lshlrev_b32 v14, 16, v19
    v_and_b32 v11, 0xffff0000, v17
    v_and_b32 v15, 0xffff0000, v19
    v_mul_f32 v20, v8, v8
    v_mul_f32 v21, 0x3d372713, v20
    v_fma_f32 v21, v21, v8, v8
    v_mul_f32 v21, 0x40135761, v21
    v_exp_f32 v21, v21
    s_nop 0
    v_add_f32 v21, 1.0, v21
    v_rcp_f32 v21, v21
    s_nop 0
    v_fma_f32 v21, v21, -2.0, 1.0
    v_add_f32 v21, 1.0, v21
    v_mul_f32 v20, 0.5, v8
    v_mul_f32 v8, v20, v21
    v_mul_f32 v20, v9, v9
    v_mul_f32 v21, 0x3d372713, v20
    v_fma_f32 v21, v21, v9, v9
    v_mul_f32 v21, 0x40135761, v21
    v_exp_f32 v21, v21
    s_nop 0
    v_add_f32 v21, 1.0, v21
    v_rcp_f32 v21, v21
    s_nop 0
    v_fma_f32 v21, v21, -2.0, 1.0
    v_add_f32 v21, 1.0, v21
    v_mul_f32 v20, 0.5, v9
    v_mul_f32 v9, v20, v21
    v_mul_f32 v20, v10, v10
    v_mul_f32 v21, 0x3d372713, v20
    v_fma_f32 v21, v21, v10, v10
    v_mul_f32 v21, 0x40135761, v21
    v_exp_f32 v21, v21
    s_nop 0
    v_add_f32 v21, 1.0, v21
    v_rcp_f32 v21, v21
    s_nop 0
    v_fma_f32 v21, v21, -2.0, 1.0
    v_add_f32 v21, 1.0, v21
    v_mul_f32 v20, 0.5, v10
    v_mul_f32 v10, v20, v21
    v_mul_f32 v20, v11, v11
    v_mul_f32 v21, 0x3d372713, v20
    v_fma_f32 v21, v21, v11, v11
    v_mul_f32 v21, 0x40135761, v21
    v_exp_f32 v21, v21
    s_nop 0
    v_add_f32 v21, 1.0, v21
    v_rcp_f32 v21, v21
    s_nop 0
    v_fma_f32 v21, v21, -2.0, 1.0
    v_add_f32 v21, 1.0, v21
    v_mul_f32 v20, 0.5, v11
    v_mul_f32 v11, v20, v21
    v_cvt_pk_bf16_f32 v16, v8, v9
    v_cvt_pk_bf16_f32 v17, v10, v11
    v_lshlrev_b32 v8, 16, v16
    v_mul_f32 v8, v8, v12
    v_and_b32 v9, 0xffff0000, v16
    v_mul_f32 v9, v9, v13
    v_lshlrev_b32 v10, 16, v17
    v_mul_f32 v10, v10, v14
    v_and_b32 v11, 0xffff0000, v17
    v_mul_f32 v11, v11, v15
    v_cvt_pk_bf16_f32 v22, v8, v9
    v_cvt_pk_bf16_f32 v23, v10, v11
    buffer_store_dwordx2 v[22:23], v5, s[24:27], 0 offen offset:160
    s_nop 1
    v_accvgpr_read_b32 v8, a44
    v_accvgpr_read_b32 v12, a100
    v_accvgpr_read_b32 v9, a45
    v_accvgpr_read_b32 v13, a101
    v_accvgpr_read_b32 v10, a46
    v_accvgpr_read_b32 v14, a102
    v_accvgpr_read_b32 v11, a47
    v_accvgpr_read_b32 v15, a103
    v_cvt_pk_bf16_f32 v16, v8, v9
    v_cvt_pk_bf16_f32 v17, v10, v11
    v_cvt_pk_bf16_f32 v18, v12, v13
    v_cvt_pk_bf16_f32 v19, v14, v15
    v_lshlrev_b32 v8, 16, v16
    v_lshlrev_b32 v12, 16, v18
    v_and_b32 v9, 0xffff0000, v16
    v_and_b32 v13, 0xffff0000, v18
    v_lshlrev_b32 v10, 16, v17
    v_lshlrev_b32 v14, 16, v19
    v_and_b32 v11, 0xffff0000, v17
    v_and_b32 v15, 0xffff0000, v19
    v_mul_f32 v20, v8, v8
    v_mul_f32 v21, 0x3d372713, v20
    v_fma_f32 v21, v21, v8, v8
    v_mul_f32 v21, 0x40135761, v21
    v_exp_f32 v21, v21
    s_nop 0
    v_add_f32 v21, 1.0, v21
    v_rcp_f32 v21, v21
    s_nop 0
    v_fma_f32 v21, v21, -2.0, 1.0
    v_add_f32 v21, 1.0, v21
    v_mul_f32 v20, 0.5, v8
    v_mul_f32 v8, v20, v21
    v_mul_f32 v20, v9, v9
    v_mul_f32 v21, 0x3d372713, v20
    v_fma_f32 v21, v21, v9, v9
    v_mul_f32 v21, 0x40135761, v21
    v_exp_f32 v21, v21
    s_nop 0
    v_add_f32 v21, 1.0, v21
    v_rcp_f32 v21, v21
    s_nop 0
    v_fma_f32 v21, v21, -2.0, 1.0
    v_add_f32 v21, 1.0, v21
    v_mul_f32 v20, 0.5, v9
    v_mul_f32 v9, v20, v21
    v_mul_f32 v20, v10, v10
    v_mul_f32 v21, 0x3d372713, v20
    v_fma_f32 v21, v21, v10, v10
    v_mul_f32 v21, 0x40135761, v21
    v_exp_f32 v21, v21
    s_nop 0
    v_add_f32 v21, 1.0, v21
    v_rcp_f32 v21, v21
    s_nop 0
    v_fma_f32 v21, v21, -2.0, 1.0
    v_add_f32 v21, 1.0, v21
    v_mul_f32 v20, 0.5, v10
    v_mul_f32 v10, v20, v21
    v_mul_f32 v20, v11, v11
    v_mul_f32 v21, 0x3d372713, v20
    v_fma_f32 v21, v21, v11, v11
    v_mul_f32 v21, 0x40135761, v21
    v_exp_f32 v21, v21
    s_nop 0
    v_add_f32 v21, 1.0, v21
    v_rcp_f32 v21, v21
    s_nop 0
    v_fma_f32 v21, v21, -2.0, 1.0
    v_add_f32 v21, 1.0, v21
    v_mul_f32 v20, 0.5, v11
    v_mul_f32 v11, v20, v21
    v_cvt_pk_bf16_f32 v16, v8, v9
    v_cvt_pk_bf16_f32 v17, v10, v11
    v_lshlrev_b32 v8, 16, v16
    v_mul_f32 v8, v8, v12
    v_and_b32 v9, 0xffff0000, v16
    v_mul_f32 v9, v9, v13
    v_lshlrev_b32 v10, 16, v17
    v_mul_f32 v10, v10, v14
    v_and_b32 v11, 0xffff0000, v17
    v_mul_f32 v11, v11, v15
    v_cvt_pk_bf16_f32 v22, v8, v9
    v_cvt_pk_bf16_f32 v23, v10, v11
    v_add_u32 v6, 114688, v5
    buffer_store_dwordx2 v[22:23], v6, s[24:27], 0 offen offset:160
    s_nop 1
    v_accvgpr_read_b32 v8, a48
    v_accvgpr_read_b32 v12, a104
    v_accvgpr_read_b32 v9, a49
    v_accvgpr_read_b32 v13, a105
    v_accvgpr_read_b32 v10, a50
    v_accvgpr_read_b32 v14, a106
    v_accvgpr_read_b32 v11, a51
    v_accvgpr_read_b32 v15, a107
    v_cvt_pk_bf16_f32 v16, v8, v9
    v_cvt_pk_bf16_f32 v17, v10, v11
    v_cvt_pk_bf16_f32 v18, v12, v13
    v_cvt_pk_bf16_f32 v19, v14, v15
    v_lshlrev_b32 v8, 16, v16
    v_lshlrev_b32 v12, 16, v18
    v_and_b32 v9, 0xffff0000, v16
    v_and_b32 v13, 0xffff0000, v18
    v_lshlrev_b32 v10, 16, v17
    v_lshlrev_b32 v14, 16, v19
    v_and_b32 v11, 0xffff0000, v17
    v_and_b32 v15, 0xffff0000, v19
    v_mul_f32 v20, v8, v8
    v_mul_f32 v21, 0x3d372713, v20
    v_fma_f32 v21, v21, v8, v8
    v_mul_f32 v21, 0x40135761, v21
    v_exp_f32 v21, v21
    s_nop 0
    v_add_f32 v21, 1.0, v21
    v_rcp_f32 v21, v21
    s_nop 0
    v_fma_f32 v21, v21, -2.0, 1.0
    v_add_f32 v21, 1.0, v21
    v_mul_f32 v20, 0.5, v8
    v_mul_f32 v8, v20, v21
    v_mul_f32 v20, v9, v9
    v_mul_f32 v21, 0x3d372713, v20
    v_fma_f32 v21, v21, v9, v9
    v_mul_f32 v21, 0x40135761, v21
    v_exp_f32 v21, v21
    s_nop 0
    v_add_f32 v21, 1.0, v21
    v_rcp_f32 v21, v21
    s_nop 0
    v_fma_f32 v21, v21, -2.0, 1.0
    v_add_f32 v21, 1.0, v21
    v_mul_f32 v20, 0.5, v9
    v_mul_f32 v9, v20, v21
    v_mul_f32 v20, v10, v10
    v_mul_f32 v21, 0x3d372713, v20
    v_fma_f32 v21, v21, v10, v10
    v_mul_f32 v21, 0x40135761, v21
    v_exp_f32 v21, v21
    s_nop 0
    v_add_f32 v21, 1.0, v21
    v_rcp_f32 v21, v21
    s_nop 0
    v_fma_f32 v21, v21, -2.0, 1.0
    v_add_f32 v21, 1.0, v21
    v_mul_f32 v20, 0.5, v10
    v_mul_f32 v10, v20, v21
    v_mul_f32 v20, v11, v11
    v_mul_f32 v21, 0x3d372713, v20
    v_fma_f32 v21, v21, v11, v11
    v_mul_f32 v21, 0x40135761, v21
    v_exp_f32 v21, v21
    s_nop 0
    v_add_f32 v21, 1.0, v21
    v_rcp_f32 v21, v21
    s_nop 0
    v_fma_f32 v21, v21, -2.0, 1.0
    v_add_f32 v21, 1.0, v21
    v_mul_f32 v20, 0.5, v11
    v_mul_f32 v11, v20, v21
    v_cvt_pk_bf16_f32 v16, v8, v9
    v_cvt_pk_bf16_f32 v17, v10, v11
    v_lshlrev_b32 v8, 16, v16
    v_mul_f32 v8, v8, v12
    v_and_b32 v9, 0xffff0000, v16
    v_mul_f32 v9, v9, v13
    v_lshlrev_b32 v10, 16, v17
    v_mul_f32 v10, v10, v14
    v_and_b32 v11, 0xffff0000, v17
    v_mul_f32 v11, v11, v15
    v_cvt_pk_bf16_f32 v22, v8, v9
    v_cvt_pk_bf16_f32 v23, v10, v11
    buffer_store_dwordx2 v[22:23], v5, s[24:27], 0 offen offset:192
    s_nop 1
    v_accvgpr_read_b32 v8, a52
    v_accvgpr_read_b32 v12, a108
    v_accvgpr_read_b32 v9, a53
    v_accvgpr_read_b32 v13, a109
    v_accvgpr_read_b32 v10, a54
    v_accvgpr_read_b32 v14, a110
    v_accvgpr_read_b32 v11, a55
    v_accvgpr_read_b32 v15, a111
    v_cvt_pk_bf16_f32 v16, v8, v9
    v_cvt_pk_bf16_f32 v17, v10, v11
    v_cvt_pk_bf16_f32 v18, v12, v13
    v_cvt_pk_bf16_f32 v19, v14, v15
    v_lshlrev_b32 v8, 16, v16
    v_lshlrev_b32 v12, 16, v18
    v_and_b32 v9, 0xffff0000, v16
    v_and_b32 v13, 0xffff0000, v18
    v_lshlrev_b32 v10, 16, v17
    v_lshlrev_b32 v14, 16, v19
    v_and_b32 v11, 0xffff0000, v17
    v_and_b32 v15, 0xffff0000, v19
    v_mul_f32 v20, v8, v8
    v_mul_f32 v21, 0x3d372713, v20
    v_fma_f32 v21, v21, v8, v8
    v_mul_f32 v21, 0x40135761, v21
    v_exp_f32 v21, v21
    s_nop 0
    v_add_f32 v21, 1.0, v21
    v_rcp_f32 v21, v21
    s_nop 0
    v_fma_f32 v21, v21, -2.0, 1.0
    v_add_f32 v21, 1.0, v21
    v_mul_f32 v20, 0.5, v8
    v_mul_f32 v8, v20, v21
    v_mul_f32 v20, v9, v9
    v_mul_f32 v21, 0x3d372713, v20
    v_fma_f32 v21, v21, v9, v9
    v_mul_f32 v21, 0x40135761, v21
    v_exp_f32 v21, v21
    s_nop 0
    v_add_f32 v21, 1.0, v21
    v_rcp_f32 v21, v21
    s_nop 0
    v_fma_f32 v21, v21, -2.0, 1.0
    v_add_f32 v21, 1.0, v21
    v_mul_f32 v20, 0.5, v9
    v_mul_f32 v9, v20, v21
    v_mul_f32 v20, v10, v10
    v_mul_f32 v21, 0x3d372713, v20
    v_fma_f32 v21, v21, v10, v10
    v_mul_f32 v21, 0x40135761, v21
    v_exp_f32 v21, v21
    s_nop 0
    v_add_f32 v21, 1.0, v21
    v_rcp_f32 v21, v21
    s_nop 0
    v_fma_f32 v21, v21, -2.0, 1.0
    v_add_f32 v21, 1.0, v21
    v_mul_f32 v20, 0.5, v10
    v_mul_f32 v10, v20, v21
    v_mul_f32 v20, v11, v11
    v_mul_f32 v21, 0x3d372713, v20
    v_fma_f32 v21, v21, v11, v11
    v_mul_f32 v21, 0x40135761, v21
    v_exp_f32 v21, v21
    s_nop 0
    v_add_f32 v21, 1.0, v21
    v_rcp_f32 v21, v21
    s_nop 0
    v_fma_f32 v21, v21, -2.0, 1.0
    v_add_f32 v21, 1.0, v21
    v_mul_f32 v20, 0.5, v11
    v_mul_f32 v11, v20, v21
    v_cvt_pk_bf16_f32 v16, v8, v9
    v_cvt_pk_bf16_f32 v17, v10, v11
    v_lshlrev_b32 v8, 16, v16
    v_mul_f32 v8, v8, v12
    v_and_b32 v9, 0xffff0000, v16
    v_mul_f32 v9, v9, v13
    v_lshlrev_b32 v10, 16, v17
    v_mul_f32 v10, v10, v14
    v_and_b32 v11, 0xffff0000, v17
    v_mul_f32 v11, v11, v15
    v_cvt_pk_bf16_f32 v22, v8, v9
    v_cvt_pk_bf16_f32 v23, v10, v11
    v_add_u32 v6, 114688, v5
    buffer_store_dwordx2 v[22:23], v6, s[24:27], 0 offen offset:192
    s_nop 1
    v_accvgpr_read_b32 v8, a112
    v_accvgpr_read_b32 v9, a113
    v_accvgpr_read_b32 v10, a114
    v_accvgpr_read_b32 v11, a115
    buffer_store_dwordx4 v[8:11], v7, s[28:31], 0 offen offset:0
    s_nop 1
    v_accvgpr_read_b32 v8, a116
    v_accvgpr_read_b32 v9, a117
    v_accvgpr_read_b32 v10, a118
    v_accvgpr_read_b32 v11, a119
    v_add_u32 v6, 65536, v7
    buffer_store_dwordx4 v[8:11], v6, s[28:31], 0 offen offset:0
    s_nop 1
    v_accvgpr_read_b32 v8, a120
    v_accvgpr_read_b32 v9, a121
    v_accvgpr_read_b32 v10, a122
    v_accvgpr_read_b32 v11, a123
    buffer_store_dwordx4 v[8:11], v7, s[32:35], 0 offen offset:0
    s_nop 1
    v_accvgpr_read_b32 v8, a124
    v_accvgpr_read_b32 v9, a125
    v_accvgpr_read_b32 v10, a126
    v_accvgpr_read_b32 v11, a127
    v_add_u32 v6, 65536, v7
    buffer_store_dwordx4 v[8:11], v6, s[32:35], 0 offen offset:0
    s_nop 1
    v_accvgpr_read_b32 v8, a128
    v_accvgpr_read_b32 v9, a129
    v_accvgpr_read_b32 v10, a130
    v_accvgpr_read_b32 v11, a131
    buffer_store_dwordx4 v[8:11], v7, s[28:31], 0 offen offset:64
    s_nop 1
    v_accvgpr_read_b32 v8, a132
    v_accvgpr_read_b32 v9, a133
    v_accvgpr_read_b32 v10, a134
    v_accvgpr_read_b32 v11, a135
    v_add_u32 v6, 65536, v7
    buffer_store_dwordx4 v[8:11], v6, s[28:31], 0 offen offset:64
    s_nop 1
    v_accvgpr_read_b32 v8, a136
    v_accvgpr_read_b32 v9, a137
    v_accvgpr_read_b32 v10, a138
    v_accvgpr_read_b32 v11, a139
    buffer_store_dwordx4 v[8:11], v7, s[32:35], 0 offen offset:64
    s_nop 1
    v_accvgpr_read_b32 v8, a140
    v_accvgpr_read_b32 v9, a141
    v_accvgpr_read_b32 v10, a142
    v_accvgpr_read_b32 v11, a143
    v_add_u32 v6, 65536, v7
    buffer_store_dwordx4 v[8:11], v6, s[32:35], 0 offen offset:64
    s_nop 1
gemm1_kernel_end:
    s_endpgm
.section .rodata,"a"
.p2align 6
.amdhsa_kernel gemm1_kernel
  .amdhsa_next_free_vgpr 224
  .amdhsa_next_free_sgpr 102
  .amdhsa_accum_offset 80
  .amdhsa_group_segment_fixed_size 0
  .amdhsa_kernarg_size 128
  .amdhsa_user_sgpr_count 2
  .amdhsa_user_sgpr_kernarg_segment_ptr 1
  .amdhsa_system_sgpr_workgroup_id_x 1
.end_amdhsa_kernel

.text
.globl scan_kernel
.p2align 8
.type scan_kernel,@function
scan_kernel:
    s_cmp_ge_u32 s2, 64
    s_cbranch_scc1 scan_kernel_end
    s_load_dwordx2 s[4:5], s[0:1], 8
    s_load_dwordx2 s[6:7], s[0:1], 16
    s_load_dwordx2 s[8:9], s[0:1], 56
    s_load_dwordx2 s[10:11], s[0:1], 120
    v_and_b32 v1, 15, v0
    v_lshrrev_b32 v2, 4, v0
    s_lshl_b32 s3, s2, 4
    v_add_u32 v3, s3, v1
    v_lshlrev_b32 v4, 1, v3
    s_waitcnt lgkmcnt(0)
    s_mov_b32 s12, s4
    s_mov_b32 s13, s5
    s_mov_b32 s14, 2048
    s_mov_b32 s15, 0x20000
    s_mov_b32 s16, s6
    s_mov_b32 s17, s7
    s_mov_b32 s18, 2048
    s_mov_b32 s19, 0x20000
    s_mov_b32 s20, s8
    s_mov_b32 s21, s9
    s_mov_b32 s22, 2048
    s_mov_b32 s23, 0x20000
    s_add_u32 s24, s10, 8388608
    s_addc_u32 s25, s11, 0
    s_mov_b32 s26, 8388608
    s_mov_b32 s27, 0x20000
    s_add_u32 s28, s10, 16777216
    s_addc_u32 s29, s11, 0
    s_mov_b32 s30, 8388608
    s_mov_b32 s31, 0x20000
    s_add_u32 s32, s10, 50331648
    s_addc_u32 s33, s11, 0
    s_mov_b32 s34, 8388608
    s_mov_b32 s35, 0x20000
    buffer_load_ushort v5, v4, s[12:15], 0 offen
    buffer_load_ushort v6, v4, s[16:19], 0 offen
    buffer_load_ushort v7, v4, s[20:23], 0 offen
    v_lshlrev_b32 v8, 18, v2
    v_lshlrev_b32 v9, 2, v3
    v_add_u32 v8, v8, v9
    s_mov_b32 s40, 0
    buffer_load_dword v32, v8, s[24:27], s40 offen
    buffer_load_dword v96, v8, s[28:31], s40 offen
    s_mov_b32 s40, 4096
    buffer_load_dword v33, v8, s[24:27], s40 offen
    buffer_load_dword v97, v8, s[28:31], s40 offen
    s_mov_b32 s40, 8192
    buffer_load_dword v34, v8, s[24:27], s40 offen
    buffer_load_dword v98, v8, s[28:31], s40 offen
    s_mov_b32 s40, 12288
    buffer_load_dword v35, v8, s[24:27], s40 offen
    buffer_load_dword v99, v8, s[28:31], s40 offen
    s_mov_b32 s40, 16384
    buffer_load_dword v36, v8, s[24:27], s40 offen
    buffer_load_dword v100, v8, s[28:31], s40 offen
    s_mov_b32 s40, 20480
    buffer_load_dword v37, v8, s[24:27], s40 offen
    buffer_load_dword v101, v8, s[28:31], s40 offen
    s_mov_b32 s40, 24576
    buffer_load_dword v38, v8, s[24:27], s40 offen
    buffer_load_dword v102, v8, s[28:31], s40 offen
    s_mov_b32 s40, 28672
    buffer_load_dword v39, v8, s[24:27], s40 offen
    buffer_load_dword v103, v8, s[28:31], s40 offen
    s_mov_b32 s40, 32768
    buffer_load_dword v40, v8, s[24:27], s40 offen
    buffer_load_dword v104, v8, s[28:31], s40 offen
    s_mov_b32 s40, 36864
    buffer_load_dword v41, v8, s[24:27], s40 offen
    buffer_load_dword v105, v8, s[28:31], s40 offen
    s_mov_b32 s40, 40960
    buffer_load_dword v42, v8, s[24:27], s40 offen
    buffer_load_dword v106, v8, s[28:31], s40 offen
    s_mov_b32 s40, 45056
    buffer_load_dword v43, v8, s[24:27], s40 offen
    buffer_load_dword v107, v8, s[28:31], s40 offen
    s_mov_b32 s40, 49152
    buffer_load_dword v44, v8, s[24:27], s40 offen
    buffer_load_dword v108, v8, s[28:31], s40 offen
    s_mov_b32 s40, 53248
    buffer_load_dword v45, v8, s[24:27], s40 offen
    buffer_load_dword v109, v8, s[28:31], s40 offen
    s_mov_b32 s40, 57344
    buffer_load_dword v46, v8, s[24:27], s40 offen
    buffer_load_dword v110, v8, s[28:31], s40 offen
    s_mov_b32 s40, 61440
    buffer_load_dword v47, v8, s[24:27], s40 offen
    buffer_load_dword v111, v8, s[28:31], s40 offen
    s_mov_b32 s40, 65536
    buffer_load_dword v48, v8, s[24:27], s40 offen
    buffer_load_dword v112, v8, s[28:31], s40 offen
    s_mov_b32 s40, 69632
    buffer_load_dword v49, v8, s[24:27], s40 offen
    buffer_load_dword v113, v8, s[28:31], s40 offen
    s_mov_b32 s40, 73728
    buffer_load_dword v50, v8, s[24:27], s40 offen
    buffer_load_dword v114, v8, s[28:31], s40 offen
    s_mov_b32 s40, 77824
    buffer_load_dword v51, v8, s[24:27], s40 offen
    buffer_load_dword v115, v8, s[28:31], s40 offen
    s_mov_b32 s40, 81920
    buffer_load_dword v52, v8, s[24:27], s40 offen
    buffer_load_dword v116, v8, s[28:31], s40 offen
    s_mov_b32 s40, 86016
    buffer_load_dword v53, v8, s[24:27], s40 offen
    buffer_load_dword v117, v8, s[28:31], s40 offen
    s_mov_b32 s40, 90112
    buffer_load_dword v54, v8, s[24:27], s40 offen
    buffer_load_dword v118, v8, s[28:31], s40 offen
    s_mov_b32 s40, 94208
    buffer_load_dword v55, v8, s[24:27], s40 offen
    buffer_load_dword v119, v8, s[28:31], s40 offen
    s_mov_b32 s40, 98304
    buffer_load_dword v56, v8, s[24:27], s40 offen
    buffer_load_dword v120, v8, s[28:31], s40 offen
    s_mov_b32 s40, 102400
    buffer_load_dword v57, v8, s[24:27], s40 offen
    buffer_load_dword v121, v8, s[28:31], s40 offen
    s_mov_b32 s40, 106496
    buffer_load_dword v58, v8, s[24:27], s40 offen
    buffer_load_dword v122, v8, s[28:31], s40 offen
    s_mov_b32 s40, 110592
    buffer_load_dword v59, v8, s[24:27], s40 offen
    buffer_load_dword v123, v8, s[28:31], s40 offen
    s_mov_b32 s40, 114688
    buffer_load_dword v60, v8, s[24:27], s40 offen
    buffer_load_dword v124, v8, s[28:31], s40 offen
    s_mov_b32 s40, 118784
    buffer_load_dword v61, v8, s[24:27], s40 offen
    buffer_load_dword v125, v8, s[28:31], s40 offen
    s_mov_b32 s40, 122880
    buffer_load_dword v62, v8, s[24:27], s40 offen
    buffer_load_dword v126, v8, s[28:31], s40 offen
    s_mov_b32 s40, 126976
    buffer_load_dword v63, v8, s[24:27], s40 offen
    buffer_load_dword v127, v8, s[28:31], s40 offen
    s_mov_b32 s40, 131072
    buffer_load_dword v64, v8, s[24:27], s40 offen
    buffer_load_dword v128, v8, s[28:31], s40 offen
    s_mov_b32 s40, 135168
    buffer_load_dword v65, v8, s[24:27], s40 offen
    buffer_load_dword v129, v8, s[28:31], s40 offen
    s_mov_b32 s40, 139264
    buffer_load_dword v66, v8, s[24:27], s40 offen
    buffer_load_dword v130, v8, s[28:31], s40 offen
    s_mov_b32 s40, 143360
    buffer_load_dword v67, v8, s[24:27], s40 offen
    buffer_load_dword v131, v8, s[28:31], s40 offen
    s_mov_b32 s40, 147456
    buffer_load_dword v68, v8, s[24:27], s40 offen
    buffer_load_dword v132, v8, s[28:31], s40 offen
    s_mov_b32 s40, 151552
    buffer_load_dword v69, v8, s[24:27], s40 offen
    buffer_load_dword v133, v8, s[28:31], s40 offen
    s_mov_b32 s40, 155648
    buffer_load_dword v70, v8, s[24:27], s40 offen
    buffer_load_dword v134, v8, s[28:31], s40 offen
    s_mov_b32 s40, 159744
    buffer_load_dword v71, v8, s[24:27], s40 offen
    buffer_load_dword v135, v8, s[28:31], s40 offen
    s_mov_b32 s40, 163840
    buffer_load_dword v72, v8, s[24:27], s40 offen
    buffer_load_dword v136, v8, s[28:31], s40 offen
    s_mov_b32 s40, 167936
    buffer_load_dword v73, v8, s[24:27], s40 offen
    buffer_load_dword v137, v8, s[28:31], s40 offen
    s_mov_b32 s40, 172032
    buffer_load_dword v74, v8, s[24:27], s40 offen
    buffer_load_dword v138, v8, s[28:31], s40 offen
    s_mov_b32 s40, 176128
    buffer_load_dword v75, v8, s[24:27], s40 offen
    buffer_load_dword v139, v8, s[28:31], s40 offen
    s_mov_b32 s40, 180224
    buffer_load_dword v76, v8, s[24:27], s40 offen
    buffer_load_dword v140, v8, s[28:31], s40 offen
    s_mov_b32 s40, 184320
    buffer_load_dword v77, v8, s[24:27], s40 offen
    buffer_load_dword v141, v8, s[28:31], s40 offen
    s_mov_b32 s40, 188416
    buffer_load_dword v78, v8, s[24:27], s40 offen
    buffer_load_dword v142, v8, s[28:31], s40 offen
    s_mov_b32 s40, 192512
    buffer_load_dword v79, v8, s[24:27], s40 offen
    buffer_load_dword v143, v8, s[28:31], s40 offen
    s_mov_b32 s40, 196608
    buffer_load_dword v80, v8, s[24:27], s40 offen
    buffer_load_dword v144, v8, s[28:31], s40 offen
    s_mov_b32 s40, 200704
    buffer_load_dword v81, v8, s[24:27], s40 offen
    buffer_load_dword v145, v8, s[28:31], s40 offen
    s_mov_b32 s40, 204800
    buffer_load_dword v82, v8, s[24:27], s40 offen
    buffer_load_dword v146, v8, s[28:31], s40 offen
    s_mov_b32 s40, 208896
    buffer_load_dword v83, v8, s[24:27], s40 offen
    buffer_load_dword v147, v8, s[28:31], s40 offen
    s_mov_b32 s40, 212992
    buffer_load_dword v84, v8, s[24:27], s40 offen
    buffer_load_dword v148, v8, s[28:31], s40 offen
    s_mov_b32 s40, 217088
    buffer_load_dword v85, v8, s[24:27], s40 offen
    buffer_load_dword v149, v8, s[28:31], s40 offen
    s_mov_b32 s40, 221184
    buffer_load_dword v86, v8, s[24:27], s40 offen
    buffer_load_dword v150, v8, s[28:31], s40 offen
    s_mov_b32 s40, 225280
    buffer_load_dword v87, v8, s[24:27], s40 offen
    buffer_load_dword v151, v8, s[28:31], s40 offen
    s_mov_b32 s40, 229376
    buffer_load_dword v88, v8, s[24:27], s40 offen
    buffer_load_dword v152, v8, s[28:31], s40 offen
    s_mov_b32 s40, 233472
    buffer_load_dword v89, v8, s[24:27], s40 offen
    buffer_load_dword v153, v8, s[28:31], s40 offen
    s_mov_b32 s40, 237568
    buffer_load_dword v90, v8, s[24:27], s40 offen
    buffer_load_dword v154, v8, s[28:31], s40 offen
    s_mov_b32 s40, 241664
    buffer_load_dword v91, v8, s[24:27], s40 offen
    buffer_load_dword v155, v8, s[28:31], s40 offen
    s_mov_b32 s40, 245760
    buffer_load_dword v92, v8, s[24:27], s40 offen
    buffer_load_dword v156, v8, s[28:31], s40 offen
    s_mov_b32 s40, 249856
    buffer_load_dword v93, v8, s[24:27], s40 offen
    buffer_load_dword v157, v8, s[28:31], s40 offen
    s_mov_b32 s40, 253952
    buffer_load_dword v94, v8, s[24:27], s40 offen
    buffer_load_dword v158, v8, s[28:31], s40 offen
    s_mov_b32 s40, 258048
    buffer_load_dword v95, v8, s[24:27], s40 offen
    buffer_load_dword v159, v8, s[28:31], s40 offen
    s_waitcnt vmcnt(63)
    v_lshlrev_b32 v5, 16, v5
    v_lshlrev_b32 v6, 16, v6
    v_lshlrev_b32 v7, 16, v7
    v_mul_f32 v7, 0x3fb8aa3b, v7
    v_exp_f32 v7, v7
    s_nop 0
    v_cvt_pk_bf16_f32 v7, v7, v7
    v_lshlrev_b32 v7, 16, v7
    v_mul_f32 v9, v7, v5
    v_mul_f32 v10, v7, v6
    v_mul_f32 v9, 0x3fb8aa3b, v9
    v_exp_f32 v9, v9
    v_mul_f32 v10, 0.15915494, v10
    v_cos_f32 v11, v10
    v_sin_f32 v12, v10
    s_nop 0
    v_mul_f32 v11, v9, v11
    v_mul_f32 v12, v9, v12
    v_add_f32 v13, -1.0, v11
    v_mul_f32 v14, v5, v5
    v_fmac_f32 v14, v6, v6
    v_rcp_f32 v14, v14
    v_mul_f32 v15, v13, v5
    v_fmac_f32 v15, v12, v6
    v_mul_f32 v16, v12, v5
    v_fma_f32 v16, -v13, v6, v16
    v_mul_f32 v15, v15, v14
    v_mul_f32 v16, v16, v14
    v_mov_b32 v17, 0
    v_mov_b32 v18, 0
    s_waitcnt vmcnt(63)
    v_mul_f32 v19, v15, v32
    v_mul_f32 v20, v15, v96
    v_fma_f32 v19, -v16, v96, v19
    v_fmac_f32 v20, v16, v32
    v_fmac_f32 v19, v11, v17
    v_fmac_f32 v20, v11, v18
    v_fma_f32 v19, -v12, v18, v19
    v_fmac_f32 v20, v12, v17
    v_mov_b32 v17, v19
    v_mov_b32 v18, v20
    v_mov_b32 v32, v19
    v_mov_b32 v96, v20
    s_waitcnt vmcnt(63)
    v_mul_f32 v19, v15, v33
    v_mul_f32 v20, v15, v97
    v_fma_f32 v19, -v16, v97, v19
    v_fmac_f32 v20, v16, v33
    v_fmac_f32 v19, v11, v17
    v_fmac_f32 v20, v11, v18
    v_fma_f32 v19, -v12, v18, v19
    v_fmac_f32 v20, v12, v17
    v_mov_b32 v17, v19
    v_mov_b32 v18, v20
    v_mov_b32 v33, v19
    v_mov_b32 v97, v20
    s_waitcnt vmcnt(63)
    v_mul_f32 v19, v15, v34
    v_mul_f32 v20, v15, v98
    v_fma_f32 v19, -v16, v98, v19
    v_fmac_f32 v20, v16, v34
    v_fmac_f32 v19, v11, v17
    v_fmac_f32 v20, v11, v18
    v_fma_f32 v19, -v12, v18, v19
    v_fmac_f32 v20, v12, v17
    v_mov_b32 v17, v19
    v_mov_b32 v18, v20
    v_mov_b32 v34, v19
    v_mov_b32 v98, v20
    s_waitcnt vmcnt(63)
    v_mul_f32 v19, v15, v35
    v_mul_f32 v20, v15, v99
    v_fma_f32 v19, -v16, v99, v19
    v_fmac_f32 v20, v16, v35
    v_fmac_f32 v19, v11, v17
    v_fmac_f32 v20, v11, v18
    v_fma_f32 v19, -v12, v18, v19
    v_fmac_f32 v20, v12, v17
    v_mov_b32 v17, v19
    v_mov_b32 v18, v20
    v_mov_b32 v35, v19
    v_mov_b32 v99, v20
    s_waitcnt vmcnt(63)
    v_mul_f32 v19, v15, v36
    v_mul_f32 v20, v15, v100
    v_fma_f32 v19, -v16, v100, v19
    v_fmac_f32 v20, v16, v36
    v_fmac_f32 v19, v11, v17
    v_fmac_f32 v20, v11, v18
    v_fma_f32 v19, -v12, v18, v19
    v_fmac_f32 v20, v12, v17
    v_mov_b32 v17, v19
    v_mov_b32 v18, v20
    v_mov_b32 v36, v19
    v_mov_b32 v100, v20
    s_waitcnt vmcnt(63)
    v_mul_f32 v19, v15, v37
    v_mul_f32 v20, v15, v101
    v_fma_f32 v19, -v16, v101, v19
    v_fmac_f32 v20, v16, v37
    v_fmac_f32 v19, v11, v17
    v_fmac_f32 v20, v11, v18
    v_fma_f32 v19, -v12, v18, v19
    v_fmac_f32 v20, v12, v17
    v_mov_b32 v17, v19
    v_mov_b32 v18, v20
    v_mov_b32 v37, v19
    v_mov_b32 v101, v20
    s_waitcnt vmcnt(63)
    v_mul_f32 v19, v15, v38
    v_mul_f32 v20, v15, v102
    v_fma_f32 v19, -v16, v102, v19
    v_fmac_f32 v20, v16, v38
    v_fmac_f32 v19, v11, v17
    v_fmac_f32 v20, v11, v18
    v_fma_f32 v19, -v12, v18, v19
    v_fmac_f32 v20, v12, v17
    v_mov_b32 v17, v19
    v_mov_b32 v18, v20
    v_mov_b32 v38, v19
    v_mov_b32 v102, v20
    s_waitcnt vmcnt(63)
    v_mul_f32 v19, v15, v39
    v_mul_f32 v20, v15, v103
    v_fma_f32 v19, -v16, v103, v19
    v_fmac_f32 v20, v16, v39
    v_fmac_f32 v19, v11, v17
    v_fmac_f32 v20, v11, v18
    v_fma_f32 v19, -v12, v18, v19
    v_fmac_f32 v20, v12, v17
    v_mov_b32 v17, v19
    v_mov_b32 v18, v20
    v_mov_b32 v39, v19
    v_mov_b32 v103, v20
    s_waitcnt vmcnt(63)
    v_mul_f32 v19, v15, v40
    v_mul_f32 v20, v15, v104
    v_fma_f32 v19, -v16, v104, v19
    v_fmac_f32 v20, v16, v40
    v_fmac_f32 v19, v11, v17
    v_fmac_f32 v20, v11, v18
    v_fma_f32 v19, -v12, v18, v19
    v_fmac_f32 v20, v12, v17
    v_mov_b32 v17, v19
    v_mov_b32 v18, v20
    v_mov_b32 v40, v19
    v_mov_b32 v104, v20
    s_waitcnt vmcnt(63)
    v_mul_f32 v19, v15, v41
    v_mul_f32 v20, v15, v105
    v_fma_f32 v19, -v16, v105, v19
    v_fmac_f32 v20, v16, v41
    v_fmac_f32 v19, v11, v17
    v_fmac_f32 v20, v11, v18
    v_fma_f32 v19, -v12, v18, v19
    v_fmac_f32 v20, v12, v17
    v_mov_b32 v17, v19
    v_mov_b32 v18, v20
    v_mov_b32 v41, v19
    v_mov_b32 v105, v20
    s_waitcnt vmcnt(63)
    v_mul_f32 v19, v15, v42
    v_mul_f32 v20, v15, v106
    v_fma_f32 v19, -v16, v106, v19
    v_fmac_f32 v20, v16, v42
    v_fmac_f32 v19, v11, v17
    v_fmac_f32 v20, v11, v18
    v_fma_f32 v19, -v12, v18, v19
    v_fmac_f32 v20, v12, v17
    v_mov_b32 v17, v19
    v_mov_b32 v18, v20
    v_mov_b32 v42, v19
    v_mov_b32 v106, v20
    s_waitcnt vmcnt(63)
    v_mul_f32 v19, v15, v43
    v_mul_f32 v20, v15, v107
    v_fma_f32 v19, -v16, v107, v19
    v_fmac_f32 v20, v16, v43
    v_fmac_f32 v19, v11, v17
    v_fmac_f32 v20, v11, v18
    v_fma_f32 v19, -v12, v18, v19
    v_fmac_f32 v20, v12, v17
    v_mov_b32 v17, v19
    v_mov_b32 v18, v20
    v_mov_b32 v43, v19
    v_mov_b32 v107, v20
    s_waitcnt vmcnt(63)
    v_mul_f32 v19, v15, v44
    v_mul_f32 v20, v15, v108
    v_fma_f32 v19, -v16, v108, v19
    v_fmac_f32 v20, v16, v44
    v_fmac_f32 v19, v11, v17
    v_fmac_f32 v20, v11, v18
    v_fma_f32 v19, -v12, v18, v19
    v_fmac_f32 v20, v12, v17
    v_mov_b32 v17, v19
    v_mov_b32 v18, v20
    v_mov_b32 v44, v19
    v_mov_b32 v108, v20
    s_waitcnt vmcnt(63)
    v_mul_f32 v19, v15, v45
    v_mul_f32 v20, v15, v109
    v_fma_f32 v19, -v16, v109, v19
    v_fmac_f32 v20, v16, v45
    v_fmac_f32 v19, v11, v17
    v_fmac_f32 v20, v11, v18
    v_fma_f32 v19, -v12, v18, v19
    v_fmac_f32 v20, v12, v17
    v_mov_b32 v17, v19
    v_mov_b32 v18, v20
    v_mov_b32 v45, v19
    v_mov_b32 v109, v20
    s_waitcnt vmcnt(63)
    v_mul_f32 v19, v15, v46
    v_mul_f32 v20, v15, v110
    v_fma_f32 v19, -v16, v110, v19
    v_fmac_f32 v20, v16, v46
    v_fmac_f32 v19, v11, v17
    v_fmac_f32 v20, v11, v18
    v_fma_f32 v19, -v12, v18, v19
    v_fmac_f32 v20, v12, v17
    v_mov_b32 v17, v19
    v_mov_b32 v18, v20
    v_mov_b32 v46, v19
    v_mov_b32 v110, v20
    s_waitcnt vmcnt(63)
    v_mul_f32 v19, v15, v47
    v_mul_f32 v20, v15, v111
    v_fma_f32 v19, -v16, v111, v19
    v_fmac_f32 v20, v16, v47
    v_fmac_f32 v19, v11, v17
    v_fmac_f32 v20, v11, v18
    v_fma_f32 v19, -v12, v18, v19
    v_fmac_f32 v20, v12, v17
    v_mov_b32 v17, v19
    v_mov_b32 v18, v20
    v_mov_b32 v47, v19
    v_mov_b32 v111, v20
    s_waitcnt vmcnt(63)
    v_mul_f32 v19, v15, v48
    v_mul_f32 v20, v15, v112
    v_fma_f32 v19, -v16, v112, v19
    v_fmac_f32 v20, v16, v48
    v_fmac_f32 v19, v11, v17
    v_fmac_f32 v20, v11, v18
    v_fma_f32 v19, -v12, v18, v19
    v_fmac_f32 v20, v12, v17
    v_mov_b32 v17, v19
    v_mov_b32 v18, v20
    v_mov_b32 v48, v19
    v_mov_b32 v112, v20
    s_waitcnt vmcnt(63)
    v_mul_f32 v19, v15, v49
    v_mul_f32 v20, v15, v113
    v_fma_f32 v19, -v16, v113, v19
    v_fmac_f32 v20, v16, v49
    v_fmac_f32 v19, v11, v17
    v_fmac_f32 v20, v11, v18
    v_fma_f32 v19, -v12, v18, v19
    v_fmac_f32 v20, v12, v17
    v_mov_b32 v17, v19
    v_mov_b32 v18, v20
    v_mov_b32 v49, v19
    v_mov_b32 v113, v20
    s_waitcnt vmcnt(63)
    v_mul_f32 v19, v15, v50
    v_mul_f32 v20, v15, v114
    v_fma_f32 v19, -v16, v114, v19
    v_fmac_f32 v20, v16, v50
    v_fmac_f32 v19, v11, v17
    v_fmac_f32 v20, v11, v18
    v_fma_f32 v19, -v12, v18, v19
    v_fmac_f32 v20, v12, v17
    v_mov_b32 v17, v19
    v_mov_b32 v18, v20
    v_mov_b32 v50, v19
    v_mov_b32 v114, v20
    s_waitcnt vmcnt(63)
    v_mul_f32 v19, v15, v51
    v_mul_f32 v20, v15, v115
    v_fma_f32 v19, -v16, v115, v19
    v_fmac_f32 v20, v16, v51
    v_fmac_f32 v19, v11, v17
    v_fmac_f32 v20, v11, v18
    v_fma_f32 v19, -v12, v18, v19
    v_fmac_f32 v20, v12, v17
    v_mov_b32 v17, v19
    v_mov_b32 v18, v20
    v_mov_b32 v51, v19
    v_mov_b32 v115, v20
    s_waitcnt vmcnt(63)
    v_mul_f32 v19, v15, v52
    v_mul_f32 v20, v15, v116
    v_fma_f32 v19, -v16, v116, v19
    v_fmac_f32 v20, v16, v52
    v_fmac_f32 v19, v11, v17
    v_fmac_f32 v20, v11, v18
    v_fma_f32 v19, -v12, v18, v19
    v_fmac_f32 v20, v12, v17
    v_mov_b32 v17, v19
    v_mov_b32 v18, v20
    v_mov_b32 v52, v19
    v_mov_b32 v116, v20
    s_waitcnt vmcnt(63)
    v_mul_f32 v19, v15, v53
    v_mul_f32 v20, v15, v117
    v_fma_f32 v19, -v16, v117, v19
    v_fmac_f32 v20, v16, v53
    v_fmac_f32 v19, v11, v17
    v_fmac_f32 v20, v11, v18
    v_fma_f32 v19, -v12, v18, v19
    v_fmac_f32 v20, v12, v17
    v_mov_b32 v17, v19
    v_mov_b32 v18, v20
    v_mov_b32 v53, v19
    v_mov_b32 v117, v20
    s_waitcnt vmcnt(63)
    v_mul_f32 v19, v15, v54
    v_mul_f32 v20, v15, v118
    v_fma_f32 v19, -v16, v118, v19
    v_fmac_f32 v20, v16, v54
    v_fmac_f32 v19, v11, v17
    v_fmac_f32 v20, v11, v18
    v_fma_f32 v19, -v12, v18, v19
    v_fmac_f32 v20, v12, v17
    v_mov_b32 v17, v19
    v_mov_b32 v18, v20
    v_mov_b32 v54, v19
    v_mov_b32 v118, v20
    s_waitcnt vmcnt(63)
    v_mul_f32 v19, v15, v55
    v_mul_f32 v20, v15, v119
    v_fma_f32 v19, -v16, v119, v19
    v_fmac_f32 v20, v16, v55
    v_fmac_f32 v19, v11, v17
    v_fmac_f32 v20, v11, v18
    v_fma_f32 v19, -v12, v18, v19
    v_fmac_f32 v20, v12, v17
    v_mov_b32 v17, v19
    v_mov_b32 v18, v20
    v_mov_b32 v55, v19
    v_mov_b32 v119, v20
    s_waitcnt vmcnt(63)
    v_mul_f32 v19, v15, v56
    v_mul_f32 v20, v15, v120
    v_fma_f32 v19, -v16, v120, v19
    v_fmac_f32 v20, v16, v56
    v_fmac_f32 v19, v11, v17
    v_fmac_f32 v20, v11, v18
    v_fma_f32 v19, -v12, v18, v19
    v_fmac_f32 v20, v12, v17
    v_mov_b32 v17, v19
    v_mov_b32 v18, v20
    v_mov_b32 v56, v19
    v_mov_b32 v120, v20
    s_waitcnt vmcnt(63)
    v_mul_f32 v19, v15, v57
    v_mul_f32 v20, v15, v121
    v_fma_f32 v19, -v16, v121, v19
    v_fmac_f32 v20, v16, v57
    v_fmac_f32 v19, v11, v17
    v_fmac_f32 v20, v11, v18
    v_fma_f32 v19, -v12, v18, v19
    v_fmac_f32 v20, v12, v17
    v_mov_b32 v17, v19
    v_mov_b32 v18, v20
    v_mov_b32 v57, v19
    v_mov_b32 v121, v20
    s_waitcnt vmcnt(63)
    v_mul_f32 v19, v15, v58
    v_mul_f32 v20, v15, v122
    v_fma_f32 v19, -v16, v122, v19
    v_fmac_f32 v20, v16, v58
    v_fmac_f32 v19, v11, v17
    v_fmac_f32 v20, v11, v18
    v_fma_f32 v19, -v12, v18, v19
    v_fmac_f32 v20, v12, v17
    v_mov_b32 v17, v19
    v_mov_b32 v18, v20
    v_mov_b32 v58, v19
    v_mov_b32 v122, v20
    s_waitcnt vmcnt(63)
    v_mul_f32 v19, v15, v59
    v_mul_f32 v20, v15, v123
    v_fma_f32 v19, -v16, v123, v19
    v_fmac_f32 v20, v16, v59
    v_fmac_f32 v19, v11, v17
    v_fmac_f32 v20, v11, v18
    v_fma_f32 v19, -v12, v18, v19
    v_fmac_f32 v20, v12, v17
    v_mov_b32 v17, v19
    v_mov_b32 v18, v20
    v_mov_b32 v59, v19
    v_mov_b32 v123, v20
    s_waitcnt vmcnt(63)
    v_mul_f32 v19, v15, v60
    v_mul_f32 v20, v15, v124
    v_fma_f32 v19, -v16, v124, v19
    v_fmac_f32 v20, v16, v60
    v_fmac_f32 v19, v11, v17
    v_fmac_f32 v20, v11, v18
    v_fma_f32 v19, -v12, v18, v19
    v_fmac_f32 v20, v12, v17
    v_mov_b32 v17, v19
    v_mov_b32 v18, v20
    v_mov_b32 v60, v19
    v_mov_b32 v124, v20
    s_waitcnt vmcnt(63)
    v_mul_f32 v19, v15, v61
    v_mul_f32 v20, v15, v125
    v_fma_f32 v19, -v16, v125, v19
    v_fmac_f32 v20, v16, v61
    v_fmac_f32 v19, v11, v17
    v_fmac_f32 v20, v11, v18
    v_fma_f32 v19, -v12, v18, v19
    v_fmac_f32 v20, v12, v17
    v_mov_b32 v17, v19
    v_mov_b32 v18, v20
    v_mov_b32 v61, v19
    v_mov_b32 v125, v20
    s_waitcnt vmcnt(63)
    v_mul_f32 v19, v15, v62
    v_mul_f32 v20, v15, v126
    v_fma_f32 v19, -v16, v126, v19
    v_fmac_f32 v20, v16, v62
    v_fmac_f32 v19, v11, v17
    v_fmac_f32 v20, v11, v18
    v_fma_f32 v19, -v12, v18, v19
    v_fmac_f32 v20, v12, v17
    v_mov_b32 v17, v19
    v_mov_b32 v18, v20
    v_mov_b32 v62, v19
    v_mov_b32 v126, v20
    s_waitcnt vmcnt(63)
    v_mul_f32 v19, v15, v63
    v_mul_f32 v20, v15, v127
    v_fma_f32 v19, -v16, v127, v19
    v_fmac_f32 v20, v16, v63
    v_fmac_f32 v19, v11, v17
    v_fmac_f32 v20, v11, v18
    v_fma_f32 v19, -v12, v18, v19
    v_fmac_f32 v20, v12, v17
    v_mov_b32 v17, v19
    v_mov_b32 v18, v20
    v_mov_b32 v63, v19
    v_mov_b32 v127, v20
    s_waitcnt vmcnt(62)
    v_mul_f32 v19, v15, v64
    v_mul_f32 v20, v15, v128
    v_fma_f32 v19, -v16, v128, v19
    v_fmac_f32 v20, v16, v64
    v_fmac_f32 v19, v11, v17
    v_fmac_f32 v20, v11, v18
    v_fma_f32 v19, -v12, v18, v19
    v_fmac_f32 v20, v12, v17
    v_mov_b32 v17, v19
    v_mov_b32 v18, v20
    v_mov_b32 v64, v19
    v_mov_b32 v128, v20
    s_waitcnt vmcnt(60)
    v_mul_f32 v19, v15, v65
    v_mul_f32 v20, v15, v129
    v_fma_f32 v19, -v16, v129, v19
    v_fmac_f32 v20, v16, v65
    v_fmac_f32 v19, v11, v17
    v_fmac_f32 v20, v11, v18
    v_fma_f32 v19, -v12, v18, v19
    v_fmac_f32 v20, v12, v17
    v_mov_b32 v17, v19
    v_mov_b32 v18, v20
    v_mov_b32 v65, v19
    v_mov_b32 v129, v20
    s_waitcnt vmcnt(58)
    v_mul_f32 v19, v15, v66
    v_mul_f32 v20, v15, v130
    v_fma_f32 v19, -v16, v130, v19
    v_fmac_f32 v20, v16, v66
    v_fmac_f32 v19, v11, v17
    v_fmac_f32 v20, v11, v18
    v_fma_f32 v19, -v12, v18, v19
    v_fmac_f32 v20, v12, v17
    v_mov_b32 v17, v19
    v_mov_b32 v18, v20
    v_mov_b32 v66, v19
    v_mov_b32 v130, v20
    s_waitcnt vmcnt(56)
    v_mul_f32 v19, v15, v67
    v_mul_f32 v20, v15, v131
    v_fma_f32 v19, -v16, v131, v19
    v_fmac_f32 v20, v16, v67
    v_fmac_f32 v19, v11, v17
    v_fmac_f32 v20, v11, v18
    v_fma_f32 v19, -v12, v18, v19
    v_fmac_f32 v20, v12, v17
    v_mov_b32 v17, v19
    v_mov_b32 v18, v20
    v_mov_b32 v67, v19
    v_mov_b32 v131, v20
    s_waitcnt vmcnt(54)
    v_mul_f32 v19, v15, v68
    v_mul_f32 v20, v15, v132
    v_fma_f32 v19, -v16, v132, v19
    v_fmac_f32 v20, v16, v68
    v_fmac_f32 v19, v11, v17
    v_fmac_f32 v20, v11, v18
    v_fma_f32 v19, -v12, v18, v19
    v_fmac_f32 v20, v12, v17
    v_mov_b32 v17, v19
    v_mov_b32 v18, v20
    v_mov_b32 v68, v19
    v_mov_b32 v132, v20
    s_waitcnt vmcnt(52)
    v_mul_f32 v19, v15, v69
    v_mul_f32 v20, v15, v133
    v_fma_f32 v19, -v16, v133, v19
    v_fmac_f32 v20, v16, v69
    v_fmac_f32 v19, v11, v17
    v_fmac_f32 v20, v11, v18
    v_fma_f32 v19, -v12, v18, v19
    v_fmac_f32 v20, v12, v17
    v_mov_b32 v17, v19
    v_mov_b32 v18, v20
    v_mov_b32 v69, v19
    v_mov_b32 v133, v20
    s_waitcnt vmcnt(50)
    v_mul_f32 v19, v15, v70
    v_mul_f32 v20, v15, v134
    v_fma_f32 v19, -v16, v134, v19
    v_fmac_f32 v20, v16, v70
    v_fmac_f32 v19, v11, v17
    v_fmac_f32 v20, v11, v18
    v_fma_f32 v19, -v12, v18, v19
    v_fmac_f32 v20, v12, v17
    v_mov_b32 v17, v19
    v_mov_b32 v18, v20
    v_mov_b32 v70, v19
    v_mov_b32 v134, v20
    s_waitcnt vmcnt(48)
    v_mul_f32 v19, v15, v71
    v_mul_f32 v20, v15, v135
    v_fma_f32 v19, -v16, v135, v19
    v_fmac_f32 v20, v16, v71
    v_fmac_f32 v19, v11, v17
    v_fmac_f32 v20, v11, v18
    v_fma_f32 v19, -v12, v18, v19
    v_fmac_f32 v20, v12, v17
    v_mov_b32 v17, v19
    v_mov_b32 v18, v20
    v_mov_b32 v71, v19
    v_mov_b32 v135, v20
    s_waitcnt vmcnt(46)
    v_mul_f32 v19, v15, v72
    v_mul_f32 v20, v15, v136
    v_fma_f32 v19, -v16, v136, v19
    v_fmac_f32 v20, v16, v72
    v_fmac_f32 v19, v11, v17
    v_fmac_f32 v20, v11, v18
    v_fma_f32 v19, -v12, v18, v19
    v_fmac_f32 v20, v12, v17
    v_mov_b32 v17, v19
    v_mov_b32 v18, v20
    v_mov_b32 v72, v19
    v_mov_b32 v136, v20
    s_waitcnt vmcnt(44)
    v_mul_f32 v19, v15, v73
    v_mul_f32 v20, v15, v137
    v_fma_f32 v19, -v16, v137, v19
    v_fmac_f32 v20, v16, v73
    v_fmac_f32 v19, v11, v17
    v_fmac_f32 v20, v11, v18
    v_fma_f32 v19, -v12, v18, v19
    v_fmac_f32 v20, v12, v17
    v_mov_b32 v17, v19
    v_mov_b32 v18, v20
    v_mov_b32 v73, v19
    v_mov_b32 v137, v20
    s_waitcnt vmcnt(42)
    v_mul_f32 v19, v15, v74
    v_mul_f32 v20, v15, v138
    v_fma_f32 v19, -v16, v138, v19
    v_fmac_f32 v20, v16, v74
    v_fmac_f32 v19, v11, v17
    v_fmac_f32 v20, v11, v18
    v_fma_f32 v19, -v12, v18, v19
    v_fmac_f32 v20, v12, v17
    v_mov_b32 v17, v19
    v_mov_b32 v18, v20
    v_mov_b32 v74, v19
    v_mov_b32 v138, v20
    s_waitcnt vmcnt(40)
    v_mul_f32 v19, v15, v75
    v_mul_f32 v20, v15, v139
    v_fma_f32 v19, -v16, v139, v19
    v_fmac_f32 v20, v16, v75
    v_fmac_f32 v19, v11, v17
    v_fmac_f32 v20, v11, v18
    v_fma_f32 v19, -v12, v18, v19
    v_fmac_f32 v20, v12, v17
    v_mov_b32 v17, v19
    v_mov_b32 v18, v20
    v_mov_b32 v75, v19
    v_mov_b32 v139, v20
    s_waitcnt vmcnt(38)
    v_mul_f32 v19, v15, v76
    v_mul_f32 v20, v15, v140
    v_fma_f32 v19, -v16, v140, v19
    v_fmac_f32 v20, v16, v76
    v_fmac_f32 v19, v11, v17
    v_fmac_f32 v20, v11, v18
    v_fma_f32 v19, -v12, v18, v19
    v_fmac_f32 v20, v12, v17
    v_mov_b32 v17, v19
    v_mov_b32 v18, v20
    v_mov_b32 v76, v19
    v_mov_b32 v140, v20
    s_waitcnt vmcnt(36)
    v_mul_f32 v19, v15, v77
    v_mul_f32 v20, v15, v141
    v_fma_f32 v19, -v16, v141, v19
    v_fmac_f32 v20, v16, v77
    v_fmac_f32 v19, v11, v17
    v_fmac_f32 v20, v11, v18
    v_fma_f32 v19, -v12, v18, v19
    v_fmac_f32 v20, v12, v17
    v_mov_b32 v17, v19
    v_mov_b32 v18, v20
    v_mov_b32 v77, v19
    v_mov_b32 v141, v20
    s_waitcnt vmcnt(34)
    v_mul_f32 v19, v15, v78
    v_mul_f32 v20, v15, v142
    v_fma_f32 v19, -v16, v142, v19
    v_fmac_f32 v20, v16, v78
    v_fmac_f32 v19, v11, v17
    v_fmac_f32 v20, v11, v18
    v_fma_f32 v19, -v12, v18, v19
    v_fmac_f32 v20, v12, v17
    v_mov_b32 v17, v19
    v_mov_b32 v18, v20
    v_mov_b32 v78, v19
    v_mov_b32 v142, v20
    s_waitcnt vmcnt(32)
    v_mul_f32 v19, v15, v79
    v_mul_f32 v20, v15, v143
    v_fma_f32 v19, -v16, v143, v19
    v_fmac_f32 v20, v16, v79
    v_fmac_f32 v19, v11, v17
    v_fmac_f32 v20, v11, v18
    v_fma_f32 v19, -v12, v18, v19
    v_fmac_f32 v20, v12, v17
    v_mov_b32 v17, v19
    v_mov_b32 v18, v20
    v_mov_b32 v79, v19
    v_mov_b32 v143, v20
    s_waitcnt vmcnt(30)
    v_mul_f32 v19, v15, v80
    v_mul_f32 v20, v15, v144
    v_fma_f32 v19, -v16, v144, v19
    v_fmac_f32 v20, v16, v80
    v_fmac_f32 v19, v11, v17
    v_fmac_f32 v20, v11, v18
    v_fma_f32 v19, -v12, v18, v19
    v_fmac_f32 v20, v12, v17
    v_mov_b32 v17, v19
    v_mov_b32 v18, v20
    v_mov_b32 v80, v19
    v_mov_b32 v144, v20
    s_waitcnt vmcnt(28)
    v_mul_f32 v19, v15, v81
    v_mul_f32 v20, v15, v145
    v_fma_f32 v19, -v16, v145, v19
    v_fmac_f32 v20, v16, v81
    v_fmac_f32 v19, v11, v17
    v_fmac_f32 v20, v11, v18
    v_fma_f32 v19, -v12, v18, v19
    v_fmac_f32 v20, v12, v17
    v_mov_b32 v17, v19
    v_mov_b32 v18, v20
    v_mov_b32 v81, v19
    v_mov_b32 v145, v20
    s_waitcnt vmcnt(26)
    v_mul_f32 v19, v15, v82
    v_mul_f32 v20, v15, v146
    v_fma_f32 v19, -v16, v146, v19
    v_fmac_f32 v20, v16, v82
    v_fmac_f32 v19, v11, v17
    v_fmac_f32 v20, v11, v18
    v_fma_f32 v19, -v12, v18, v19
    v_fmac_f32 v20, v12, v17
    v_mov_b32 v17, v19
    v_mov_b32 v18, v20
    v_mov_b32 v82, v19
    v_mov_b32 v146, v20
    s_waitcnt vmcnt(24)
    v_mul_f32 v19, v15, v83
    v_mul_f32 v20, v15, v147
    v_fma_f32 v19, -v16, v147, v19
    v_fmac_f32 v20, v16, v83
    v_fmac_f32 v19, v11, v17
    v_fmac_f32 v20, v11, v18
    v_fma_f32 v19, -v12, v18, v19
    v_fmac_f32 v20, v12, v17
    v_mov_b32 v17, v19
    v_mov_b32 v18, v20
    v_mov_b32 v83, v19
    v_mov_b32 v147, v20
    s_waitcnt vmcnt(22)
    v_mul_f32 v19, v15, v84
    v_mul_f32 v20, v15, v148
    v_fma_f32 v19, -v16, v148, v19
    v_fmac_f32 v20, v16, v84
    v_fmac_f32 v19, v11, v17
    v_fmac_f32 v20, v11, v18
    v_fma_f32 v19, -v12, v18, v19
    v_fmac_f32 v20, v12, v17
    v_mov_b32 v17, v19
    v_mov_b32 v18, v20
    v_mov_b32 v84, v19
    v_mov_b32 v148, v20
    s_waitcnt vmcnt(20)
    v_mul_f32 v19, v15, v85
    v_mul_f32 v20, v15, v149
    v_fma_f32 v19, -v16, v149, v19
    v_fmac_f32 v20, v16, v85
    v_fmac_f32 v19, v11, v17
    v_fmac_f32 v20, v11, v18
    v_fma_f32 v19, -v12, v18, v19
    v_fmac_f32 v20, v12, v17
    v_mov_b32 v17, v19
    v_mov_b32 v18, v20
    v_mov_b32 v85, v19
    v_mov_b32 v149, v20
    s_waitcnt vmcnt(18)
    v_mul_f32 v19, v15, v86
    v_mul_f32 v20, v15, v150
    v_fma_f32 v19, -v16, v150, v19
    v_fmac_f32 v20, v16, v86
    v_fmac_f32 v19, v11, v17
    v_fmac_f32 v20, v11, v18
    v_fma_f32 v19, -v12, v18, v19
    v_fmac_f32 v20, v12, v17
    v_mov_b32 v17, v19
    v_mov_b32 v18, v20
    v_mov_b32 v86, v19
    v_mov_b32 v150, v20
    s_waitcnt vmcnt(16)
    v_mul_f32 v19, v15, v87
    v_mul_f32 v20, v15, v151
    v_fma_f32 v19, -v16, v151, v19
    v_fmac_f32 v20, v16, v87
    v_fmac_f32 v19, v11, v17
    v_fmac_f32 v20, v11, v18
    v_fma_f32 v19, -v12, v18, v19
    v_fmac_f32 v20, v12, v17
    v_mov_b32 v17, v19
    v_mov_b32 v18, v20
    v_mov_b32 v87, v19
    v_mov_b32 v151, v20
    s_waitcnt vmcnt(14)
    v_mul_f32 v19, v15, v88
    v_mul_f32 v20, v15, v152
    v_fma_f32 v19, -v16, v152, v19
    v_fmac_f32 v20, v16, v88
    v_fmac_f32 v19, v11, v17
    v_fmac_f32 v20, v11, v18
    v_fma_f32 v19, -v12, v18, v19
    v_fmac_f32 v20, v12, v17
    v_mov_b32 v17, v19
    v_mov_b32 v18, v20
    v_mov_b32 v88, v19
    v_mov_b32 v152, v20
    s_waitcnt vmcnt(12)
    v_mul_f32 v19, v15, v89
    v_mul_f32 v20, v15, v153
    v_fma_f32 v19, -v16, v153, v19
    v_fmac_f32 v20, v16, v89
    v_fmac_f32 v19, v11, v17
    v_fmac_f32 v20, v11, v18
    v_fma_f32 v19, -v12, v18, v19
    v_fmac_f32 v20, v12, v17
    v_mov_b32 v17, v19
    v_mov_b32 v18, v20
    v_mov_b32 v89, v19
    v_mov_b32 v153, v20
    s_waitcnt vmcnt(10)
    v_mul_f32 v19, v15, v90
    v_mul_f32 v20, v15, v154
    v_fma_f32 v19, -v16, v154, v19
    v_fmac_f32 v20, v16, v90
    v_fmac_f32 v19, v11, v17
    v_fmac_f32 v20, v11, v18
    v_fma_f32 v19, -v12, v18, v19
    v_fmac_f32 v20, v12, v17
    v_mov_b32 v17, v19
    v_mov_b32 v18, v20
    v_mov_b32 v90, v19
    v_mov_b32 v154, v20
    s_waitcnt vmcnt(8)
    v_mul_f32 v19, v15, v91
    v_mul_f32 v20, v15, v155
    v_fma_f32 v19, -v16, v155, v19
    v_fmac_f32 v20, v16, v91
    v_fmac_f32 v19, v11, v17
    v_fmac_f32 v20, v11, v18
    v_fma_f32 v19, -v12, v18, v19
    v_fmac_f32 v20, v12, v17
    v_mov_b32 v17, v19
    v_mov_b32 v18, v20
    v_mov_b32 v91, v19
    v_mov_b32 v155, v20
    s_waitcnt vmcnt(6)
    v_mul_f32 v19, v15, v92
    v_mul_f32 v20, v15, v156
    v_fma_f32 v19, -v16, v156, v19
    v_fmac_f32 v20, v16, v92
    v_fmac_f32 v19, v11, v17
    v_fmac_f32 v20, v11, v18
    v_fma_f32 v19, -v12, v18, v19
    v_fmac_f32 v20, v12, v17
    v_mov_b32 v17, v19
    v_mov_b32 v18, v20
    v_mov_b32 v92, v19
    v_mov_b32 v156, v20
    s_waitcnt vmcnt(4)
    v_mul_f32 v19, v15, v93
    v_mul_f32 v20, v15, v157
    v_fma_f32 v19, -v16, v157, v19
    v_fmac_f32 v20, v16, v93
    v_fmac_f32 v19, v11, v17
    v_fmac_f32 v20, v11, v18
    v_fma_f32 v19, -v12, v18, v19
    v_fmac_f32 v20, v12, v17
    v_mov_b32 v17, v19
    v_mov_b32 v18, v20
    v_mov_b32 v93, v19
    v_mov_b32 v157, v20
    s_waitcnt vmcnt(2)
    v_mul_f32 v19, v15, v94
    v_mul_f32 v20, v15, v158
    v_fma_f32 v19, -v16, v158, v19
    v_fmac_f32 v20, v16, v94
    v_fmac_f32 v19, v11, v17
    v_fmac_f32 v20, v11, v18
    v_fma_f32 v19, -v12, v18, v19
    v_fmac_f32 v20, v12, v17
    v_mov_b32 v17, v19
    v_mov_b32 v18, v20
    v_mov_b32 v94, v19
    v_mov_b32 v158, v20
    s_waitcnt vmcnt(0)
    v_mul_f32 v19, v15, v95
    v_mul_f32 v20, v15, v159
    v_fma_f32 v19, -v16, v159, v19
    v_fmac_f32 v20, v16, v95
    v_fmac_f32 v19, v11, v17
    v_fmac_f32 v20, v11, v18
    v_fma_f32 v19, -v12, v18, v19
    v_fmac_f32 v20, v12, v17
    v_mov_b32 v17, v19
    v_mov_b32 v18, v20
    v_mov_b32 v95, v19
    v_mov_b32 v159, v20
    v_lshlrev_b32 v21, 3, v0
    v_mov_b32 v28, v17
    v_mov_b32 v29, v18
    ds_write_b64 v21, v[28:29]
    v_mov_b32 v22, v11
    v_mov_b32 v23, v12
    v_mul_f32 v24, v22, v22
    v_mul_f32 v25, v22, v23
    v_fma_f32 v22, -v23, v23, v24
    v_add_f32 v23, v25, v25
    v_mul_f32 v24, v22, v22
    v_mul_f32 v25, v22, v23
    v_fma_f32 v22, -v23, v23, v24
    v_add_f32 v23, v25, v25
    v_mul_f32 v24, v22, v22
    v_mul_f32 v25, v22, v23
    v_fma_f32 v22, -v23, v23, v24
    v_add_f32 v23, v25, v25
    v_mul_f32 v24, v22, v22
    v_mul_f32 v25, v22, v23
    v_fma_f32 v22, -v23, v23, v24
    v_add_f32 v23, v25, v25
    v_mul_f32 v24, v22, v22
    v_mul_f32 v25, v22, v23
    v_fma_f32 v22, -v23, v23, v24
    v_add_f32 v23, v25, v25
    v_mul_f32 v24, v22, v22
    v_mul_f32 v25, v22, v23
    v_fma_f32 v22, -v23, v23, v24
    v_add_f32 v23, v25, v25
    s_waitcnt lgkmcnt(0)
    s_barrier
    v_lshlrev_b32 v21, 3, v1
    v_mov_b32 v17, 0
    v_mov_b32 v18, 0
    ds_read_b64 v[160:161], v21 offset:0
    ds_read_b64 v[162:163], v21 offset:128
    ds_read_b64 v[164:165], v21 offset:256
    ds_read_b64 v[166:167], v21 offset:384
    ds_read_b64 v[168:169], v21 offset:512
    ds_read_b64 v[170:171], v21 offset:640
    ds_read_b64 v[172:173], v21 offset:768
    ds_read_b64 v[174:175], v21 offset:896
    ds_read_b64 v[176:177], v21 offset:1024
    ds_read_b64 v[178:179], v21 offset:1152
    ds_read_b64 v[180:181], v21 offset:1280
    ds_read_b64 v[182:183], v21 offset:1408
    ds_read_b64 v[184:185], v21 offset:1536
    ds_read_b64 v[186:187], v21 offset:1664
    ds_read_b64 v[188:189], v21 offset:1792
    ds_read_b64 v[190:191], v21 offset:1920
    s_waitcnt lgkmcnt(15)
    v_cmp_lt_u32 vcc, 0, v2
    v_mul_f32 v24, v22, v17
    v_mul_f32 v25, v22, v18
    v_fma_f32 v24, -v23, v18, v24
    v_fmac_f32 v25, v23, v17
    v_add_f32 v24, v24, v160
    v_add_f32 v25, v25, v161
    v_cndmask_b32 v17, v17, v24, vcc
    v_cndmask_b32 v18, v18, v25, vcc
    s_waitcnt lgkmcnt(14)
    v_cmp_lt_u32 vcc, 1, v2
    v_mul_f32 v24, v22, v17
    v_mul_f32 v25, v22, v18
    v_fma_f32 v24, -v23, v18, v24
    v_fmac_f32 v25, v23, v17
    v_add_f32 v24, v24, v162
    v_add_f32 v25, v25, v163
    v_cndmask_b32 v17, v17, v24, vcc
    v_cndmask_b32 v18, v18, v25, vcc
    s_waitcnt lgkmcnt(13)
    v_cmp_lt_u32 vcc, 2, v2
    v_mul_f32 v24, v22, v17
    v_mul_f32 v25, v22, v18
    v_fma_f32 v24, -v23, v18, v24
    v_fmac_f32 v25, v23, v17
    v_add_f32 v24, v24, v164
    v_add_f32 v25, v25, v165
    v_cndmask_b32 v17, v17, v24, vcc
    v_cndmask_b32 v18, v18, v25, vcc
    s_waitcnt lgkmcnt(12)
    v_cmp_lt_u32 vcc, 3, v2
    v_mul_f32 v24, v22, v17
    v_mul_f32 v25, v22, v18
    v_fma_f32 v24, -v23, v18, v24
    v_fmac_f32 v25, v23, v17
    v_add_f32 v24, v24, v166
    v_add_f32 v25, v25, v167
    v_cndmask_b32 v17, v17, v24, vcc
    v_cndmask_b32 v18, v18, v25, vcc
    s_waitcnt lgkmcnt(11)
    v_cmp_lt_u32 vcc, 4, v2
    v_mul_f32 v24, v22, v17
    v_mul_f32 v25, v22, v18
    v_fma_f32 v24, -v23, v18, v24
    v_fmac_f32 v25, v23, v17
    v_add_f32 v24, v24, v168
    v_add_f32 v25, v25, v169
    v_cndmask_b32 v17, v17, v24, vcc
    v_cndmask_b32 v18, v18, v25, vcc
    s_waitcnt lgkmcnt(10)
    v_cmp_lt_u32 vcc, 5, v2
    v_mul_f32 v24, v22, v17
    v_mul_f32 v25, v22, v18
    v_fma_f32 v24, -v23, v18, v24
    v_fmac_f32 v25, v23, v17
    v_add_f32 v24, v24, v170
    v_add_f32 v25, v25, v171
    v_cndmask_b32 v17, v17, v24, vcc
    v_cndmask_b32 v18, v18, v25, vcc
    s_waitcnt lgkmcnt(9)
    v_cmp_lt_u32 vcc, 6, v2
    v_mul_f32 v24, v22, v17
    v_mul_f32 v25, v22, v18
    v_fma_f32 v24, -v23, v18, v24
    v_fmac_f32 v25, v23, v17
    v_add_f32 v24, v24, v172
    v_add_f32 v25, v25, v173
    v_cndmask_b32 v17, v17, v24, vcc
    v_cndmask_b32 v18, v18, v25, vcc
    s_waitcnt lgkmcnt(8)
    v_cmp_lt_u32 vcc, 7, v2
    v_mul_f32 v24, v22, v17
    v_mul_f32 v25, v22, v18
    v_fma_f32 v24, -v23, v18, v24
    v_fmac_f32 v25, v23, v17
    v_add_f32 v24, v24, v174
    v_add_f32 v25, v25, v175
    v_cndmask_b32 v17, v17, v24, vcc
    v_cndmask_b32 v18, v18, v25, vcc
    s_waitcnt lgkmcnt(7)
    v_cmp_lt_u32 vcc, 8, v2
    v_mul_f32 v24, v22, v17
    v_mul_f32 v25, v22, v18
    v_fma_f32 v24, -v23, v18, v24
    v_fmac_f32 v25, v23, v17
    v_add_f32 v24, v24, v176
    v_add_f32 v25, v25, v177
    v_cndmask_b32 v17, v17, v24, vcc
    v_cndmask_b32 v18, v18, v25, vcc
    s_waitcnt lgkmcnt(6)
    v_cmp_lt_u32 vcc, 9, v2
    v_mul_f32 v24, v22, v17
    v_mul_f32 v25, v22, v18
    v_fma_f32 v24, -v23, v18, v24
    v_fmac_f32 v25, v23, v17
    v_add_f32 v24, v24, v178
    v_add_f32 v25, v25, v179
    v_cndmask_b32 v17, v17, v24, vcc
    v_cndmask_b32 v18, v18, v25, vcc
    s_waitcnt lgkmcnt(5)
    v_cmp_lt_u32 vcc, 10, v2
    v_mul_f32 v24, v22, v17
    v_mul_f32 v25, v22, v18
    v_fma_f32 v24, -v23, v18, v24
    v_fmac_f32 v25, v23, v17
    v_add_f32 v24, v24, v180
    v_add_f32 v25, v25, v181
    v_cndmask_b32 v17, v17, v24, vcc
    v_cndmask_b32 v18, v18, v25, vcc
    s_waitcnt lgkmcnt(4)
    v_cmp_lt_u32 vcc, 11, v2
    v_mul_f32 v24, v22, v17
    v_mul_f32 v25, v22, v18
    v_fma_f32 v24, -v23, v18, v24
    v_fmac_f32 v25, v23, v17
    v_add_f32 v24, v24, v182
    v_add_f32 v25, v25, v183
    v_cndmask_b32 v17, v17, v24, vcc
    v_cndmask_b32 v18, v18, v25, vcc
    s_waitcnt lgkmcnt(3)
    v_cmp_lt_u32 vcc, 12, v2
    v_mul_f32 v24, v22, v17
    v_mul_f32 v25, v22, v18
    v_fma_f32 v24, -v23, v18, v24
    v_fmac_f32 v25, v23, v17
    v_add_f32 v24, v24, v184
    v_add_f32 v25, v25, v185
    v_cndmask_b32 v17, v17, v24, vcc
    v_cndmask_b32 v18, v18, v25, vcc
    s_waitcnt lgkmcnt(2)
    v_cmp_lt_u32 vcc, 13, v2
    v_mul_f32 v24, v22, v17
    v_mul_f32 v25, v22, v18
    v_fma_f32 v24, -v23, v18, v24
    v_fmac_f32 v25, v23, v17
    v_add_f32 v24, v24, v186
    v_add_f32 v25, v25, v187
    v_cndmask_b32 v17, v17, v24, vcc
    v_cndmask_b32 v18, v18, v25, vcc
    s_waitcnt lgkmcnt(1)
    v_cmp_lt_u32 vcc, 14, v2
    v_mul_f32 v24, v22, v17
    v_mul_f32 v25, v22, v18
    v_fma_f32 v24, -v23, v18, v24
    v_fmac_f32 v25, v23, v17
    v_add_f32 v24, v24, v188
    v_add_f32 v25, v25, v189
    v_cndmask_b32 v17, v17, v24, vcc
    v_cndmask_b32 v18, v18, v25, vcc
    s_waitcnt lgkmcnt(0)
    v_cmp_lt_u32 vcc, 15, v2
    v_mul_f32 v24, v22, v17
    v_mul_f32 v25, v22, v18
    v_fma_f32 v24, -v23, v18, v24
    v_fmac_f32 v25, v23, v17
    v_add_f32 v24, v24, v190
    v_add_f32 v25, v25, v191
    v_cndmask_b32 v17, v17, v24, vcc
    v_cndmask_b32 v18, v18, v25, vcc
    ds_read_b64 v[160:161], v21 offset:2048
    ds_read_b64 v[162:163], v21 offset:2176
    ds_read_b64 v[164:165], v21 offset:2304
    ds_read_b64 v[166:167], v21 offset:2432
    ds_read_b64 v[168:169], v21 offset:2560
    ds_read_b64 v[170:171], v21 offset:2688
    ds_read_b64 v[172:173], v21 offset:2816
    ds_read_b64 v[174:175], v21 offset:2944
    ds_read_b64 v[176:177], v21 offset:3072
    ds_read_b64 v[178:179], v21 offset:3200
    ds_read_b64 v[180:181], v21 offset:3328
    ds_read_b64 v[182:183], v21 offset:3456
    ds_read_b64 v[184:185], v21 offset:3584
    ds_read_b64 v[186:187], v21 offset:3712
    ds_read_b64 v[188:189], v21 offset:3840
    s_waitcnt lgkmcnt(14)
    v_cmp_lt_u32 vcc, 16, v2
    v_mul_f32 v24, v22, v17
    v_mul_f32 v25, v22, v18
    v_fma_f32 v24, -v23, v18, v24
    v_fmac_f32 v25, v23, v17
    v_add_f32 v24, v24, v160
    v_add_f32 v25, v25, v161
    v_cndmask_b32 v17, v17, v24, vcc
    v_cndmask_b32 v18, v18, v25, vcc
    s_waitcnt lgkmcnt(13)
    v_cmp_lt_u32 vcc, 17, v2
    v_mul_f32 v24, v22, v17
    v_mul_f32 v25, v22, v18
    v_fma_f32 v24, -v23, v18, v24
    v_fmac_f32 v25, v23, v17
    v_add_f32 v24, v24, v162
    v_add_f32 v25, v25, v163
    v_cndmask_b32 v17, v17, v24, vcc
    v_cndmask_b32 v18, v18, v25, vcc
    s_waitcnt lgkmcnt(12)
    v_cmp_lt_u32 vcc, 18, v2
    v_mul_f32 v24, v22, v17
    v_mul_f32 v25, v22, v18
    v_fma_f32 v24, -v23, v18, v24
    v_fmac_f32 v25, v23, v17
    v_add_f32 v24, v24, v164
    v_add_f32 v25, v25, v165
    v_cndmask_b32 v17, v17, v24, vcc
    v_cndmask_b32 v18, v18, v25, vcc
    s_waitcnt lgkmcnt(11)
    v_cmp_lt_u32 vcc, 19, v2
    v_mul_f32 v24, v22, v17
    v_mul_f32 v25, v22, v18
    v_fma_f32 v24, -v23, v18, v24
    v_fmac_f32 v25, v23, v17
    v_add_f32 v24, v24, v166
    v_add_f32 v25, v25, v167
    v_cndmask_b32 v17, v17, v24, vcc
    v_cndmask_b32 v18, v18, v25, vcc
    s_waitcnt lgkmcnt(10)
    v_cmp_lt_u32 vcc, 20, v2
    v_mul_f32 v24, v22, v17
    v_mul_f32 v25, v22, v18
    v_fma_f32 v24, -v23, v18, v24
    v_fmac_f32 v25, v23, v17
    v_add_f32 v24, v24, v168
    v_add_f32 v25, v25, v169
    v_cndmask_b32 v17, v17, v24, vcc
    v_cndmask_b32 v18, v18, v25, vcc
    s_waitcnt lgkmcnt(9)
    v_cmp_lt_u32 vcc, 21, v2
    v_mul_f32 v24, v22, v17
    v_mul_f32 v25, v22, v18
    v_fma_f32 v24, -v23, v18, v24
    v_fmac_f32 v25, v23, v17
    v_add_f32 v24, v24, v170
    v_add_f32 v25, v25, v171
    v_cndmask_b32 v17, v17, v24, vcc
    v_cndmask_b32 v18, v18, v25, vcc
    s_waitcnt lgkmcnt(8)
    v_cmp_lt_u32 vcc, 22, v2
    v_mul_f32 v24, v22, v17
    v_mul_f32 v25, v22, v18
    v_fma_f32 v24, -v23, v18, v24
    v_fmac_f32 v25, v23, v17
    v_add_f32 v24, v24, v172
    v_add_f32 v25, v25, v173
    v_cndmask_b32 v17, v17, v24, vcc
    v_cndmask_b32 v18, v18, v25, vcc
    s_waitcnt lgkmcnt(7)
    v_cmp_lt_u32 vcc, 23, v2
    v_mul_f32 v24, v22, v17
    v_mul_f32 v25, v22, v18
    v_fma_f32 v24, -v23, v18, v24
    v_fmac_f32 v25, v23, v17
    v_add_f32 v24, v24, v174
    v_add_f32 v25, v25, v175
    v_cndmask_b32 v17, v17, v24, vcc
    v_cndmask_b32 v18, v18, v25, vcc
    s_waitcnt lgkmcnt(6)
    v_cmp_lt_u32 vcc, 24, v2
    v_mul_f32 v24, v22, v17
    v_mul_f32 v25, v22, v18
    v_fma_f32 v24, -v23, v18, v24
    v_fmac_f32 v25, v23, v17
    v_add_f32 v24, v24, v176
    v_add_f32 v25, v25, v177
    v_cndmask_b32 v17, v17, v24, vcc
    v_cndmask_b32 v18, v18, v25, vcc
    s_waitcnt lgkmcnt(5)
    v_cmp_lt_u32 vcc, 25, v2
    v_mul_f32 v24, v22, v17
    v_mul_f32 v25, v22, v18
    v_fma_f32 v24, -v23, v18, v24
    v_fmac_f32 v25, v23, v17
    v_add_f32 v24, v24, v178
    v_add_f32 v25, v25, v179
    v_cndmask_b32 v17, v17, v24, vcc
    v_cndmask_b32 v18, v18, v25, vcc
    s_waitcnt lgkmcnt(4)
    v_cmp_lt_u32 vcc, 26, v2
    v_mul_f32 v24, v22, v17
    v_mul_f32 v25, v22, v18
    v_fma_f32 v24, -v23, v18, v24
    v_fmac_f32 v25, v23, v17
    v_add_f32 v24, v24, v180
    v_add_f32 v25, v25, v181
    v_cndmask_b32 v17, v17, v24, vcc
    v_cndmask_b32 v18, v18, v25, vcc
    s_waitcnt lgkmcnt(3)
    v_cmp_lt_u32 vcc, 27, v2
    v_mul_f32 v24, v22, v17
    v_mul_f32 v25, v22, v18
    v_fma_f32 v24, -v23, v18, v24
    v_fmac_f32 v25, v23, v17
    v_add_f32 v24, v24, v182
    v_add_f32 v25, v25, v183
    v_cndmask_b32 v17, v17, v24, vcc
    v_cndmask_b32 v18, v18, v25, vcc
    s_waitcnt lgkmcnt(2)
    v_cmp_lt_u32 vcc, 28, v2
    v_mul_f32 v24, v22, v17
    v_mul_f32 v25, v22, v18
    v_fma_f32 v24, -v23, v18, v24
    v_fmac_f32 v25, v23, v17
    v_add_f32 v24, v24, v184
    v_add_f32 v25, v25, v185
    v_cndmask_b32 v17, v17, v24, vcc
    v_cndmask_b32 v18, v18, v25, vcc
    s_waitcnt lgkmcnt(1)
    v_cmp_lt_u32 vcc, 29, v2
    v_mul_f32 v24, v22, v17
    v_mul_f32 v25, v22, v18
    v_fma_f32 v24, -v23, v18, v24
    v_fmac_f32 v25, v23, v17
    v_add_f32 v24, v24, v186
    v_add_f32 v25, v25, v187
    v_cndmask_b32 v17, v17, v24, vcc
    v_cndmask_b32 v18, v18, v25, vcc
    s_waitcnt lgkmcnt(0)
    v_cmp_lt_u32 vcc, 30, v2
    v_mul_f32 v24, v22, v17
    v_mul_f32 v25, v22, v18
    v_fma_f32 v24, -v23, v18, v24
    v_fmac_f32 v25, v23, v17
    v_add_f32 v24, v24, v188
    v_add_f32 v25, v25, v189
    v_cndmask_b32 v17, v17, v24, vcc
    v_cndmask_b32 v18, v18, v25, vcc
    v_lshlrev_b32 v8, 18, v2
    v_lshlrev_b32 v9, 1, v3
    v_add_u32 v8, v8, v9
    v_mul_f32 v24, v11, v17
    v_mul_f32 v25, v11, v18
    v_fma_f32 v24, -v12, v18, v24
    v_fmac_f32 v25, v12, v17
    v_mov_b32 v17, v24
    v_mov_b32 v18, v25
    v_add_f32 v32, v32, v24
    v_add_f32 v96, v96, v25
    v_cvt_pk_bf16_f32 v26, v32, -v96
    s_mov_b32 s40, 0
    buffer_store_short v26, v8, s[32:35], s40 offen
    buffer_store_short_d16_hi v26, v8, s[32:35], s40 offen offset:2048
    v_mul_f32 v24, v11, v17
    v_mul_f32 v25, v11, v18
    v_fma_f32 v24, -v12, v18, v24
    v_fmac_f32 v25, v12, v17
    v_mov_b32 v17, v24
    v_mov_b32 v18, v25
    v_add_f32 v33, v33, v24
    v_add_f32 v97, v97, v25
    v_cvt_pk_bf16_f32 v26, v33, -v97
    s_mov_b32 s40, 4096
    buffer_store_short v26, v8, s[32:35], s40 offen
    buffer_store_short_d16_hi v26, v8, s[32:35], s40 offen offset:2048
    v_mul_f32 v24, v11, v17
    v_mul_f32 v25, v11, v18
    v_fma_f32 v24, -v12, v18, v24
    v_fmac_f32 v25, v12, v17
    v_mov_b32 v17, v24
    v_mov_b32 v18, v25
    v_add_f32 v34, v34, v24
    v_add_f32 v98, v98, v25
    v_cvt_pk_bf16_f32 v26, v34, -v98
    s_mov_b32 s40, 8192
    buffer_store_short v26, v8, s[32:35], s40 offen
    buffer_store_short_d16_hi v26, v8, s[32:35], s40 offen offset:2048
    v_mul_f32 v24, v11, v17
    v_mul_f32 v25, v11, v18
    v_fma_f32 v24, -v12, v18, v24
    v_fmac_f32 v25, v12, v17
    v_mov_b32 v17, v24
    v_mov_b32 v18, v25
    v_add_f32 v35, v35, v24
    v_add_f32 v99, v99, v25
    v_cvt_pk_bf16_f32 v26, v35, -v99
    s_mov_b32 s40, 12288
    buffer_store_short v26, v8, s[32:35], s40 offen
    buffer_store_short_d16_hi v26, v8, s[32:35], s40 offen offset:2048
    v_mul_f32 v24, v11, v17
    v_mul_f32 v25, v11, v18
    v_fma_f32 v24, -v12, v18, v24
    v_fmac_f32 v25, v12, v17
    v_mov_b32 v17, v24
    v_mov_b32 v18, v25
    v_add_f32 v36, v36, v24
    v_add_f32 v100, v100, v25
    v_cvt_pk_bf16_f32 v26, v36, -v100
    s_mov_b32 s40, 16384
    buffer_store_short v26, v8, s[32:35], s40 offen
    buffer_store_short_d16_hi v26, v8, s[32:35], s40 offen offset:2048
    v_mul_f32 v24, v11, v17
    v_mul_f32 v25, v11, v18
    v_fma_f32 v24, -v12, v18, v24
    v_fmac_f32 v25, v12, v17
    v_mov_b32 v17, v24
    v_mov_b32 v18, v25
    v_add_f32 v37, v37, v24
    v_add_f32 v101, v101, v25
    v_cvt_pk_bf16_f32 v26, v37, -v101
    s_mov_b32 s40, 20480
    buffer_store_short v26, v8, s[32:35], s40 offen
    buffer_store_short_d16_hi v26, v8, s[32:35], s40 offen offset:2048
    v_mul_f32 v24, v11, v17
    v_mul_f32 v25, v11, v18
    v_fma_f32 v24, -v12, v18, v24
    v_fmac_f32 v25, v12, v17
    v_mov_b32 v17, v24
    v_mov_b32 v18, v25
    v_add_f32 v38, v38, v24
    v_add_f32 v102, v102, v25
    v_cvt_pk_bf16_f32 v26, v38, -v102
    s_mov_b32 s40, 24576
    buffer_store_short v26, v8, s[32:35], s40 offen
    buffer_store_short_d16_hi v26, v8, s[32:35], s40 offen offset:2048
    v_mul_f32 v24, v11, v17
    v_mul_f32 v25, v11, v18
    v_fma_f32 v24, -v12, v18, v24
    v_fmac_f32 v25, v12, v17
    v_mov_b32 v17, v24
    v_mov_b32 v18, v25
    v_add_f32 v39, v39, v24
    v_add_f32 v103, v103, v25
    v_cvt_pk_bf16_f32 v26, v39, -v103
    s_mov_b32 s40, 28672
    buffer_store_short v26, v8, s[32:35], s40 offen
    buffer_store_short_d16_hi v26, v8, s[32:35], s40 offen offset:2048
    v_mul_f32 v24, v11, v17
    v_mul_f32 v25, v11, v18
    v_fma_f32 v24, -v12, v18, v24
    v_fmac_f32 v25, v12, v17
    v_mov_b32 v17, v24
    v_mov_b32 v18, v25
    v_add_f32 v40, v40, v24
    v_add_f32 v104, v104, v25
    v_cvt_pk_bf16_f32 v26, v40, -v104
    s_mov_b32 s40, 32768
    buffer_store_short v26, v8, s[32:35], s40 offen
    buffer_store_short_d16_hi v26, v8, s[32:35], s40 offen offset:2048
    v_mul_f32 v24, v11, v17
    v_mul_f32 v25, v11, v18
    v_fma_f32 v24, -v12, v18, v24
    v_fmac_f32 v25, v12, v17
    v_mov_b32 v17, v24
    v_mov_b32 v18, v25
    v_add_f32 v41, v41, v24
    v_add_f32 v105, v105, v25
    v_cvt_pk_bf16_f32 v26, v41, -v105
    s_mov_b32 s40, 36864
    buffer_store_short v26, v8, s[32:35], s40 offen
    buffer_store_short_d16_hi v26, v8, s[32:35], s40 offen offset:2048
    v_mul_f32 v24, v11, v17
    v_mul_f32 v25, v11, v18
    v_fma_f32 v24, -v12, v18, v24
    v_fmac_f32 v25, v12, v17
    v_mov_b32 v17, v24
    v_mov_b32 v18, v25
    v_add_f32 v42, v42, v24
    v_add_f32 v106, v106, v25
    v_cvt_pk_bf16_f32 v26, v42, -v106
    s_mov_b32 s40, 40960
    buffer_store_short v26, v8, s[32:35], s40 offen
    buffer_store_short_d16_hi v26, v8, s[32:35], s40 offen offset:2048
    v_mul_f32 v24, v11, v17
    v_mul_f32 v25, v11, v18
    v_fma_f32 v24, -v12, v18, v24
    v_fmac_f32 v25, v12, v17
    v_mov_b32 v17, v24
    v_mov_b32 v18, v25
    v_add_f32 v43, v43, v24
    v_add_f32 v107, v107, v25
    v_cvt_pk_bf16_f32 v26, v43, -v107
    s_mov_b32 s40, 45056
    buffer_store_short v26, v8, s[32:35], s40 offen
    buffer_store_short_d16_hi v26, v8, s[32:35], s40 offen offset:2048
    v_mul_f32 v24, v11, v17
    v_mul_f32 v25, v11, v18
    v_fma_f32 v24, -v12, v18, v24
    v_fmac_f32 v25, v12, v17
    v_mov_b32 v17, v24
    v_mov_b32 v18, v25
    v_add_f32 v44, v44, v24
    v_add_f32 v108, v108, v25
    v_cvt_pk_bf16_f32 v26, v44, -v108
    s_mov_b32 s40, 49152
    buffer_store_short v26, v8, s[32:35], s40 offen
    buffer_store_short_d16_hi v26, v8, s[32:35], s40 offen offset:2048
    v_mul_f32 v24, v11, v17
    v_mul_f32 v25, v11, v18
    v_fma_f32 v24, -v12, v18, v24
    v_fmac_f32 v25, v12, v17
    v_mov_b32 v17, v24
    v_mov_b32 v18, v25
    v_add_f32 v45, v45, v24
    v_add_f32 v109, v109, v25
    v_cvt_pk_bf16_f32 v26, v45, -v109
    s_mov_b32 s40, 53248
    buffer_store_short v26, v8, s[32:35], s40 offen
    buffer_store_short_d16_hi v26, v8, s[32:35], s40 offen offset:2048
    v_mul_f32 v24, v11, v17
    v_mul_f32 v25, v11, v18
    v_fma_f32 v24, -v12, v18, v24
    v_fmac_f32 v25, v12, v17
    v_mov_b32 v17, v24
    v_mov_b32 v18, v25
    v_add_f32 v46, v46, v24
    v_add_f32 v110, v110, v25
    v_cvt_pk_bf16_f32 v26, v46, -v110
    s_mov_b32 s40, 57344
    buffer_store_short v26, v8, s[32:35], s40 offen
    buffer_store_short_d16_hi v26, v8, s[32:35], s40 offen offset:2048
    v_mul_f32 v24, v11, v17
    v_mul_f32 v25, v11, v18
    v_fma_f32 v24, -v12, v18, v24
    v_fmac_f32 v25, v12, v17
    v_mov_b32 v17, v24
    v_mov_b32 v18, v25
    v_add_f32 v47, v47, v24
    v_add_f32 v111, v111, v25
    v_cvt_pk_bf16_f32 v26, v47, -v111
    s_mov_b32 s40, 61440
    buffer_store_short v26, v8, s[32:35], s40 offen
    buffer_store_short_d16_hi v26, v8, s[32:35], s40 offen offset:2048
    v_mul_f32 v24, v11, v17
    v_mul_f32 v25, v11, v18
    v_fma_f32 v24, -v12, v18, v24
    v_fmac_f32 v25, v12, v17
    v_mov_b32 v17, v24
    v_mov_b32 v18, v25
    v_add_f32 v48, v48, v24
    v_add_f32 v112, v112, v25
    v_cvt_pk_bf16_f32 v26, v48, -v112
    s_mov_b32 s40, 65536
    buffer_store_short v26, v8, s[32:35], s40 offen
    buffer_store_short_d16_hi v26, v8, s[32:35], s40 offen offset:2048
    v_mul_f32 v24, v11, v17
    v_mul_f32 v25, v11, v18
    v_fma_f32 v24, -v12, v18, v24
    v_fmac_f32 v25, v12, v17
    v_mov_b32 v17, v24
    v_mov_b32 v18, v25
    v_add_f32 v49, v49, v24
    v_add_f32 v113, v113, v25
    v_cvt_pk_bf16_f32 v26, v49, -v113
    s_mov_b32 s40, 69632
    buffer_store_short v26, v8, s[32:35], s40 offen
    buffer_store_short_d16_hi v26, v8, s[32:35], s40 offen offset:2048
    v_mul_f32 v24, v11, v17
    v_mul_f32 v25, v11, v18
    v_fma_f32 v24, -v12, v18, v24
    v_fmac_f32 v25, v12, v17
    v_mov_b32 v17, v24
    v_mov_b32 v18, v25
    v_add_f32 v50, v50, v24
    v_add_f32 v114, v114, v25
    v_cvt_pk_bf16_f32 v26, v50, -v114
    s_mov_b32 s40, 73728
    buffer_store_short v26, v8, s[32:35], s40 offen
    buffer_store_short_d16_hi v26, v8, s[32:35], s40 offen offset:2048
    v_mul_f32 v24, v11, v17
    v_mul_f32 v25, v11, v18
    v_fma_f32 v24, -v12, v18, v24
    v_fmac_f32 v25, v12, v17
    v_mov_b32 v17, v24
    v_mov_b32 v18, v25
    v_add_f32 v51, v51, v24
    v_add_f32 v115, v115, v25
    v_cvt_pk_bf16_f32 v26, v51, -v115
    s_mov_b32 s40, 77824
    buffer_store_short v26, v8, s[32:35], s40 offen
    buffer_store_short_d16_hi v26, v8, s[32:35], s40 offen offset:2048
    v_mul_f32 v24, v11, v17
    v_mul_f32 v25, v11, v18
    v_fma_f32 v24, -v12, v18, v24
    v_fmac_f32 v25, v12, v17
    v_mov_b32 v17, v24
    v_mov_b32 v18, v25
    v_add_f32 v52, v52, v24
    v_add_f32 v116, v116, v25
    v_cvt_pk_bf16_f32 v26, v52, -v116
    s_mov_b32 s40, 81920
    buffer_store_short v26, v8, s[32:35], s40 offen
    buffer_store_short_d16_hi v26, v8, s[32:35], s40 offen offset:2048
    v_mul_f32 v24, v11, v17
    v_mul_f32 v25, v11, v18
    v_fma_f32 v24, -v12, v18, v24
    v_fmac_f32 v25, v12, v17
    v_mov_b32 v17, v24
    v_mov_b32 v18, v25
    v_add_f32 v53, v53, v24
    v_add_f32 v117, v117, v25
    v_cvt_pk_bf16_f32 v26, v53, -v117
    s_mov_b32 s40, 86016
    buffer_store_short v26, v8, s[32:35], s40 offen
    buffer_store_short_d16_hi v26, v8, s[32:35], s40 offen offset:2048
    v_mul_f32 v24, v11, v17
    v_mul_f32 v25, v11, v18
    v_fma_f32 v24, -v12, v18, v24
    v_fmac_f32 v25, v12, v17
    v_mov_b32 v17, v24
    v_mov_b32 v18, v25
    v_add_f32 v54, v54, v24
    v_add_f32 v118, v118, v25
    v_cvt_pk_bf16_f32 v26, v54, -v118
    s_mov_b32 s40, 90112
    buffer_store_short v26, v8, s[32:35], s40 offen
    buffer_store_short_d16_hi v26, v8, s[32:35], s40 offen offset:2048
    v_mul_f32 v24, v11, v17
    v_mul_f32 v25, v11, v18
    v_fma_f32 v24, -v12, v18, v24
    v_fmac_f32 v25, v12, v17
    v_mov_b32 v17, v24
    v_mov_b32 v18, v25
    v_add_f32 v55, v55, v24
    v_add_f32 v119, v119, v25
    v_cvt_pk_bf16_f32 v26, v55, -v119
    s_mov_b32 s40, 94208
    buffer_store_short v26, v8, s[32:35], s40 offen
    buffer_store_short_d16_hi v26, v8, s[32:35], s40 offen offset:2048
    v_mul_f32 v24, v11, v17
    v_mul_f32 v25, v11, v18
    v_fma_f32 v24, -v12, v18, v24
    v_fmac_f32 v25, v12, v17
    v_mov_b32 v17, v24
    v_mov_b32 v18, v25
    v_add_f32 v56, v56, v24
    v_add_f32 v120, v120, v25
    v_cvt_pk_bf16_f32 v26, v56, -v120
    s_mov_b32 s40, 98304
    buffer_store_short v26, v8, s[32:35], s40 offen
    buffer_store_short_d16_hi v26, v8, s[32:35], s40 offen offset:2048
    v_mul_f32 v24, v11, v17
    v_mul_f32 v25, v11, v18
    v_fma_f32 v24, -v12, v18, v24
    v_fmac_f32 v25, v12, v17
    v_mov_b32 v17, v24
    v_mov_b32 v18, v25
    v_add_f32 v57, v57, v24
    v_add_f32 v121, v121, v25
    v_cvt_pk_bf16_f32 v26, v57, -v121
    s_mov_b32 s40, 102400
    buffer_store_short v26, v8, s[32:35], s40 offen
    buffer_store_short_d16_hi v26, v8, s[32:35], s40 offen offset:2048
    v_mul_f32 v24, v11, v17
    v_mul_f32 v25, v11, v18
    v_fma_f32 v24, -v12, v18, v24
    v_fmac_f32 v25, v12, v17
    v_mov_b32 v17, v24
    v_mov_b32 v18, v25
    v_add_f32 v58, v58, v24
    v_add_f32 v122, v122, v25
    v_cvt_pk_bf16_f32 v26, v58, -v122
    s_mov_b32 s40, 106496
    buffer_store_short v26, v8, s[32:35], s40 offen
    buffer_store_short_d16_hi v26, v8, s[32:35], s40 offen offset:2048
    v_mul_f32 v24, v11, v17
    v_mul_f32 v25, v11, v18
    v_fma_f32 v24, -v12, v18, v24
    v_fmac_f32 v25, v12, v17
    v_mov_b32 v17, v24
    v_mov_b32 v18, v25
    v_add_f32 v59, v59, v24
    v_add_f32 v123, v123, v25
    v_cvt_pk_bf16_f32 v26, v59, -v123
    s_mov_b32 s40, 110592
    buffer_store_short v26, v8, s[32:35], s40 offen
    buffer_store_short_d16_hi v26, v8, s[32:35], s40 offen offset:2048
    v_mul_f32 v24, v11, v17
    v_mul_f32 v25, v11, v18
    v_fma_f32 v24, -v12, v18, v24
    v_fmac_f32 v25, v12, v17
    v_mov_b32 v17, v24
    v_mov_b32 v18, v25
    v_add_f32 v60, v60, v24
    v_add_f32 v124, v124, v25
    v_cvt_pk_bf16_f32 v26, v60, -v124
    s_mov_b32 s40, 114688
    buffer_store_short v26, v8, s[32:35], s40 offen
    buffer_store_short_d16_hi v26, v8, s[32:35], s40 offen offset:2048
    v_mul_f32 v24, v11, v17
    v_mul_f32 v25, v11, v18
    v_fma_f32 v24, -v12, v18, v24
    v_fmac_f32 v25, v12, v17
    v_mov_b32 v17, v24
    v_mov_b32 v18, v25
    v_add_f32 v61, v61, v24
    v_add_f32 v125, v125, v25
    v_cvt_pk_bf16_f32 v26, v61, -v125
    s_mov_b32 s40, 118784
    buffer_store_short v26, v8, s[32:35], s40 offen
    buffer_store_short_d16_hi v26, v8, s[32:35], s40 offen offset:2048
    v_mul_f32 v24, v11, v17
    v_mul_f32 v25, v11, v18
    v_fma_f32 v24, -v12, v18, v24
    v_fmac_f32 v25, v12, v17
    v_mov_b32 v17, v24
    v_mov_b32 v18, v25
    v_add_f32 v62, v62, v24
    v_add_f32 v126, v126, v25
    v_cvt_pk_bf16_f32 v26, v62, -v126
    s_mov_b32 s40, 122880
    buffer_store_short v26, v8, s[32:35], s40 offen
    buffer_store_short_d16_hi v26, v8, s[32:35], s40 offen offset:2048
    v_mul_f32 v24, v11, v17
    v_mul_f32 v25, v11, v18
    v_fma_f32 v24, -v12, v18, v24
    v_fmac_f32 v25, v12, v17
    v_mov_b32 v17, v24
    v_mov_b32 v18, v25
    v_add_f32 v63, v63, v24
    v_add_f32 v127, v127, v25
    v_cvt_pk_bf16_f32 v26, v63, -v127
    s_mov_b32 s40, 126976
    buffer_store_short v26, v8, s[32:35], s40 offen
    buffer_store_short_d16_hi v26, v8, s[32:35], s40 offen offset:2048
    v_mul_f32 v24, v11, v17
    v_mul_f32 v25, v11, v18
    v_fma_f32 v24, -v12, v18, v24
    v_fmac_f32 v25, v12, v17
    v_mov_b32 v17, v24
    v_mov_b32 v18, v25
    v_add_f32 v64, v64, v24
    v_add_f32 v128, v128, v25
    v_cvt_pk_bf16_f32 v26, v64, -v128
    s_mov_b32 s40, 131072
    buffer_store_short v26, v8, s[32:35], s40 offen
    buffer_store_short_d16_hi v26, v8, s[32:35], s40 offen offset:2048
    v_mul_f32 v24, v11, v17
    v_mul_f32 v25, v11, v18
    v_fma_f32 v24, -v12, v18, v24
    v_fmac_f32 v25, v12, v17
    v_mov_b32 v17, v24
    v_mov_b32 v18, v25
    v_add_f32 v65, v65, v24
    v_add_f32 v129, v129, v25
    v_cvt_pk_bf16_f32 v26, v65, -v129
    s_mov_b32 s40, 135168
    buffer_store_short v26, v8, s[32:35], s40 offen
    buffer_store_short_d16_hi v26, v8, s[32:35], s40 offen offset:2048
    v_mul_f32 v24, v11, v17
    v_mul_f32 v25, v11, v18
    v_fma_f32 v24, -v12, v18, v24
    v_fmac_f32 v25, v12, v17
    v_mov_b32 v17, v24
    v_mov_b32 v18, v25
    v_add_f32 v66, v66, v24
    v_add_f32 v130, v130, v25
    v_cvt_pk_bf16_f32 v26, v66, -v130
    s_mov_b32 s40, 139264
    buffer_store_short v26, v8, s[32:35], s40 offen
    buffer_store_short_d16_hi v26, v8, s[32:35], s40 offen offset:2048
    v_mul_f32 v24, v11, v17
    v_mul_f32 v25, v11, v18
    v_fma_f32 v24, -v12, v18, v24
    v_fmac_f32 v25, v12, v17
    v_mov_b32 v17, v24
    v_mov_b32 v18, v25
    v_add_f32 v67, v67, v24
    v_add_f32 v131, v131, v25
    v_cvt_pk_bf16_f32 v26, v67, -v131
    s_mov_b32 s40, 143360
    buffer_store_short v26, v8, s[32:35], s40 offen
    buffer_store_short_d16_hi v26, v8, s[32:35], s40 offen offset:2048
    v_mul_f32 v24, v11, v17
    v_mul_f32 v25, v11, v18
    v_fma_f32 v24, -v12, v18, v24
    v_fmac_f32 v25, v12, v17
    v_mov_b32 v17, v24
    v_mov_b32 v18, v25
    v_add_f32 v68, v68, v24
    v_add_f32 v132, v132, v25
    v_cvt_pk_bf16_f32 v26, v68, -v132
    s_mov_b32 s40, 147456
    buffer_store_short v26, v8, s[32:35], s40 offen
    buffer_store_short_d16_hi v26, v8, s[32:35], s40 offen offset:2048
    v_mul_f32 v24, v11, v17
    v_mul_f32 v25, v11, v18
    v_fma_f32 v24, -v12, v18, v24
    v_fmac_f32 v25, v12, v17
    v_mov_b32 v17, v24
    v_mov_b32 v18, v25
    v_add_f32 v69, v69, v24
    v_add_f32 v133, v133, v25
    v_cvt_pk_bf16_f32 v26, v69, -v133
    s_mov_b32 s40, 151552
    buffer_store_short v26, v8, s[32:35], s40 offen
    buffer_store_short_d16_hi v26, v8, s[32:35], s40 offen offset:2048
    v_mul_f32 v24, v11, v17
    v_mul_f32 v25, v11, v18
    v_fma_f32 v24, -v12, v18, v24
    v_fmac_f32 v25, v12, v17
    v_mov_b32 v17, v24
    v_mov_b32 v18, v25
    v_add_f32 v70, v70, v24
    v_add_f32 v134, v134, v25
    v_cvt_pk_bf16_f32 v26, v70, -v134
    s_mov_b32 s40, 155648
    buffer_store_short v26, v8, s[32:35], s40 offen
    buffer_store_short_d16_hi v26, v8, s[32:35], s40 offen offset:2048
    v_mul_f32 v24, v11, v17
    v_mul_f32 v25, v11, v18
    v_fma_f32 v24, -v12, v18, v24
    v_fmac_f32 v25, v12, v17
    v_mov_b32 v17, v24
    v_mov_b32 v18, v25
    v_add_f32 v71, v71, v24
    v_add_f32 v135, v135, v25
    v_cvt_pk_bf16_f32 v26, v71, -v135
    s_mov_b32 s40, 159744
    buffer_store_short v26, v8, s[32:35], s40 offen
    buffer_store_short_d16_hi v26, v8, s[32:35], s40 offen offset:2048
    v_mul_f32 v24, v11, v17
    v_mul_f32 v25, v11, v18
    v_fma_f32 v24, -v12, v18, v24
    v_fmac_f32 v25, v12, v17
    v_mov_b32 v17, v24
    v_mov_b32 v18, v25
    v_add_f32 v72, v72, v24
    v_add_f32 v136, v136, v25
    v_cvt_pk_bf16_f32 v26, v72, -v136
    s_mov_b32 s40, 163840
    buffer_store_short v26, v8, s[32:35], s40 offen
    buffer_store_short_d16_hi v26, v8, s[32:35], s40 offen offset:2048
    v_mul_f32 v24, v11, v17
    v_mul_f32 v25, v11, v18
    v_fma_f32 v24, -v12, v18, v24
    v_fmac_f32 v25, v12, v17
    v_mov_b32 v17, v24
    v_mov_b32 v18, v25
    v_add_f32 v73, v73, v24
    v_add_f32 v137, v137, v25
    v_cvt_pk_bf16_f32 v26, v73, -v137
    s_mov_b32 s40, 167936
    buffer_store_short v26, v8, s[32:35], s40 offen
    buffer_store_short_d16_hi v26, v8, s[32:35], s40 offen offset:2048
    v_mul_f32 v24, v11, v17
    v_mul_f32 v25, v11, v18
    v_fma_f32 v24, -v12, v18, v24
    v_fmac_f32 v25, v12, v17
    v_mov_b32 v17, v24
    v_mov_b32 v18, v25
    v_add_f32 v74, v74, v24
    v_add_f32 v138, v138, v25
    v_cvt_pk_bf16_f32 v26, v74, -v138
    s_mov_b32 s40, 172032
    buffer_store_short v26, v8, s[32:35], s40 offen
    buffer_store_short_d16_hi v26, v8, s[32:35], s40 offen offset:2048
    v_mul_f32 v24, v11, v17
    v_mul_f32 v25, v11, v18
    v_fma_f32 v24, -v12, v18, v24
    v_fmac_f32 v25, v12, v17
    v_mov_b32 v17, v24
    v_mov_b32 v18, v25
    v_add_f32 v75, v75, v24
    v_add_f32 v139, v139, v25
    v_cvt_pk_bf16_f32 v26, v75, -v139
    s_mov_b32 s40, 176128
    buffer_store_short v26, v8, s[32:35], s40 offen
    buffer_store_short_d16_hi v26, v8, s[32:35], s40 offen offset:2048
    v_mul_f32 v24, v11, v17
    v_mul_f32 v25, v11, v18
    v_fma_f32 v24, -v12, v18, v24
    v_fmac_f32 v25, v12, v17
    v_mov_b32 v17, v24
    v_mov_b32 v18, v25
    v_add_f32 v76, v76, v24
    v_add_f32 v140, v140, v25
    v_cvt_pk_bf16_f32 v26, v76, -v140
    s_mov_b32 s40, 180224
    buffer_store_short v26, v8, s[32:35], s40 offen
    buffer_store_short_d16_hi v26, v8, s[32:35], s40 offen offset:2048
    v_mul_f32 v24, v11, v17
    v_mul_f32 v25, v11, v18
    v_fma_f32 v24, -v12, v18, v24
    v_fmac_f32 v25, v12, v17
    v_mov_b32 v17, v24
    v_mov_b32 v18, v25
    v_add_f32 v77, v77, v24
    v_add_f32 v141, v141, v25
    v_cvt_pk_bf16_f32 v26, v77, -v141
    s_mov_b32 s40, 184320
    buffer_store_short v26, v8, s[32:35], s40 offen
    buffer_store_short_d16_hi v26, v8, s[32:35], s40 offen offset:2048
    v_mul_f32 v24, v11, v17
    v_mul_f32 v25, v11, v18
    v_fma_f32 v24, -v12, v18, v24
    v_fmac_f32 v25, v12, v17
    v_mov_b32 v17, v24
    v_mov_b32 v18, v25
    v_add_f32 v78, v78, v24
    v_add_f32 v142, v142, v25
    v_cvt_pk_bf16_f32 v26, v78, -v142
    s_mov_b32 s40, 188416
    buffer_store_short v26, v8, s[32:35], s40 offen
    buffer_store_short_d16_hi v26, v8, s[32:35], s40 offen offset:2048
    v_mul_f32 v24, v11, v17
    v_mul_f32 v25, v11, v18
    v_fma_f32 v24, -v12, v18, v24
    v_fmac_f32 v25, v12, v17
    v_mov_b32 v17, v24
    v_mov_b32 v18, v25
    v_add_f32 v79, v79, v24
    v_add_f32 v143, v143, v25
    v_cvt_pk_bf16_f32 v26, v79, -v143
    s_mov_b32 s40, 192512
    buffer_store_short v26, v8, s[32:35], s40 offen
    buffer_store_short_d16_hi v26, v8, s[32:35], s40 offen offset:2048
    v_mul_f32 v24, v11, v17
    v_mul_f32 v25, v11, v18
    v_fma_f32 v24, -v12, v18, v24
    v_fmac_f32 v25, v12, v17
    v_mov_b32 v17, v24
    v_mov_b32 v18, v25
    v_add_f32 v80, v80, v24
    v_add_f32 v144, v144, v25
    v_cvt_pk_bf16_f32 v26, v80, -v144
    s_mov_b32 s40, 196608
    buffer_store_short v26, v8, s[32:35], s40 offen
    buffer_store_short_d16_hi v26, v8, s[32:35], s40 offen offset:2048
    v_mul_f32 v24, v11, v17
    v_mul_f32 v25, v11, v18
    v_fma_f32 v24, -v12, v18, v24
    v_fmac_f32 v25, v12, v17
    v_mov_b32 v17, v24
    v_mov_b32 v18, v25
    v_add_f32 v81, v81, v24
    v_add_f32 v145, v145, v25
    v_cvt_pk_bf16_f32 v26, v81, -v145
    s_mov_b32 s40, 200704
    buffer_store_short v26, v8, s[32:35], s40 offen
    buffer_store_short_d16_hi v26, v8, s[32:35], s40 offen offset:2048
    v_mul_f32 v24, v11, v17
    v_mul_f32 v25, v11, v18
    v_fma_f32 v24, -v12, v18, v24
    v_fmac_f32 v25, v12, v17
    v_mov_b32 v17, v24
    v_mov_b32 v18, v25
    v_add_f32 v82, v82, v24
    v_add_f32 v146, v146, v25
    v_cvt_pk_bf16_f32 v26, v82, -v146
    s_mov_b32 s40, 204800
    buffer_store_short v26, v8, s[32:35], s40 offen
    buffer_store_short_d16_hi v26, v8, s[32:35], s40 offen offset:2048
    v_mul_f32 v24, v11, v17
    v_mul_f32 v25, v11, v18
    v_fma_f32 v24, -v12, v18, v24
    v_fmac_f32 v25, v12, v17
    v_mov_b32 v17, v24
    v_mov_b32 v18, v25
    v_add_f32 v83, v83, v24
    v_add_f32 v147, v147, v25
    v_cvt_pk_bf16_f32 v26, v83, -v147
    s_mov_b32 s40, 208896
    buffer_store_short v26, v8, s[32:35], s40 offen
    buffer_store_short_d16_hi v26, v8, s[32:35], s40 offen offset:2048
    v_mul_f32 v24, v11, v17
    v_mul_f32 v25, v11, v18
    v_fma_f32 v24, -v12, v18, v24
    v_fmac_f32 v25, v12, v17
    v_mov_b32 v17, v24
    v_mov_b32 v18, v25
    v_add_f32 v84, v84, v24
    v_add_f32 v148, v148, v25
    v_cvt_pk_bf16_f32 v26, v84, -v148
    s_mov_b32 s40, 212992
    buffer_store_short v26, v8, s[32:35], s40 offen
    buffer_store_short_d16_hi v26, v8, s[32:35], s40 offen offset:2048
    v_mul_f32 v24, v11, v17
    v_mul_f32 v25, v11, v18
    v_fma_f32 v24, -v12, v18, v24
    v_fmac_f32 v25, v12, v17
    v_mov_b32 v17, v24
    v_mov_b32 v18, v25
    v_add_f32 v85, v85, v24
    v_add_f32 v149, v149, v25
    v_cvt_pk_bf16_f32 v26, v85, -v149
    s_mov_b32 s40, 217088
    buffer_store_short v26, v8, s[32:35], s40 offen
    buffer_store_short_d16_hi v26, v8, s[32:35], s40 offen offset:2048
    v_mul_f32 v24, v11, v17
    v_mul_f32 v25, v11, v18
    v_fma_f32 v24, -v12, v18, v24
    v_fmac_f32 v25, v12, v17
    v_mov_b32 v17, v24
    v_mov_b32 v18, v25
    v_add_f32 v86, v86, v24
    v_add_f32 v150, v150, v25
    v_cvt_pk_bf16_f32 v26, v86, -v150
    s_mov_b32 s40, 221184
    buffer_store_short v26, v8, s[32:35], s40 offen
    buffer_store_short_d16_hi v26, v8, s[32:35], s40 offen offset:2048
    v_mul_f32 v24, v11, v17
    v_mul_f32 v25, v11, v18
    v_fma_f32 v24, -v12, v18, v24
    v_fmac_f32 v25, v12, v17
    v_mov_b32 v17, v24
    v_mov_b32 v18, v25
    v_add_f32 v87, v87, v24
    v_add_f32 v151, v151, v25
    v_cvt_pk_bf16_f32 v26, v87, -v151
    s_mov_b32 s40, 225280
    buffer_store_short v26, v8, s[32:35], s40 offen
    buffer_store_short_d16_hi v26, v8, s[32:35], s40 offen offset:2048
    v_mul_f32 v24, v11, v17
    v_mul_f32 v25, v11, v18
    v_fma_f32 v24, -v12, v18, v24
    v_fmac_f32 v25, v12, v17
    v_mov_b32 v17, v24
    v_mov_b32 v18, v25
    v_add_f32 v88, v88, v24
    v_add_f32 v152, v152, v25
    v_cvt_pk_bf16_f32 v26, v88, -v152
    s_mov_b32 s40, 229376
    buffer_store_short v26, v8, s[32:35], s40 offen
    buffer_store_short_d16_hi v26, v8, s[32:35], s40 offen offset:2048
    v_mul_f32 v24, v11, v17
    v_mul_f32 v25, v11, v18
    v_fma_f32 v24, -v12, v18, v24
    v_fmac_f32 v25, v12, v17
    v_mov_b32 v17, v24
    v_mov_b32 v18, v25
    v_add_f32 v89, v89, v24
    v_add_f32 v153, v153, v25
    v_cvt_pk_bf16_f32 v26, v89, -v153
    s_mov_b32 s40, 233472
    buffer_store_short v26, v8, s[32:35], s40 offen
    buffer_store_short_d16_hi v26, v8, s[32:35], s40 offen offset:2048
    v_mul_f32 v24, v11, v17
    v_mul_f32 v25, v11, v18
    v_fma_f32 v24, -v12, v18, v24
    v_fmac_f32 v25, v12, v17
    v_mov_b32 v17, v24
    v_mov_b32 v18, v25
    v_add_f32 v90, v90, v24
    v_add_f32 v154, v154, v25
    v_cvt_pk_bf16_f32 v26, v90, -v154
    s_mov_b32 s40, 237568
    buffer_store_short v26, v8, s[32:35], s40 offen
    buffer_store_short_d16_hi v26, v8, s[32:35], s40 offen offset:2048
    v_mul_f32 v24, v11, v17
    v_mul_f32 v25, v11, v18
    v_fma_f32 v24, -v12, v18, v24
    v_fmac_f32 v25, v12, v17
    v_mov_b32 v17, v24
    v_mov_b32 v18, v25
    v_add_f32 v91, v91, v24
    v_add_f32 v155, v155, v25
    v_cvt_pk_bf16_f32 v26, v91, -v155
    s_mov_b32 s40, 241664
    buffer_store_short v26, v8, s[32:35], s40 offen
    buffer_store_short_d16_hi v26, v8, s[32:35], s40 offen offset:2048
    v_mul_f32 v24, v11, v17
    v_mul_f32 v25, v11, v18
    v_fma_f32 v24, -v12, v18, v24
    v_fmac_f32 v25, v12, v17
    v_mov_b32 v17, v24
    v_mov_b32 v18, v25
    v_add_f32 v92, v92, v24
    v_add_f32 v156, v156, v25
    v_cvt_pk_bf16_f32 v26, v92, -v156
    s_mov_b32 s40, 245760
    buffer_store_short v26, v8, s[32:35], s40 offen
    buffer_store_short_d16_hi v26, v8, s[32:35], s40 offen offset:2048
    v_mul_f32 v24, v11, v17
    v_mul_f32 v25, v11, v18
    v_fma_f32 v24, -v12, v18, v24
    v_fmac_f32 v25, v12, v17
    v_mov_b32 v17, v24
    v_mov_b32 v18, v25
    v_add_f32 v93, v93, v24
    v_add_f32 v157, v157, v25
    v_cvt_pk_bf16_f32 v26, v93, -v157
    s_mov_b32 s40, 249856
    buffer_store_short v26, v8, s[32:35], s40 offen
    buffer_store_short_d16_hi v26, v8, s[32:35], s40 offen offset:2048
    v_mul_f32 v24, v11, v17
    v_mul_f32 v25, v11, v18
    v_fma_f32 v24, -v12, v18, v24
    v_fmac_f32 v25, v12, v17
    v_mov_b32 v17, v24
    v_mov_b32 v18, v25
    v_add_f32 v94, v94, v24
    v_add_f32 v158, v158, v25
    v_cvt_pk_bf16_f32 v26, v94, -v158
    s_mov_b32 s40, 253952
    buffer_store_short v26, v8, s[32:35], s40 offen
    buffer_store_short_d16_hi v26, v8, s[32:35], s40 offen offset:2048
    v_mul_f32 v24, v11, v17
    v_mul_f32 v25, v11, v18
    v_fma_f32 v24, -v12, v18, v24
    v_fmac_f32 v25, v12, v17
    v_mov_b32 v17, v24
    v_mov_b32 v18, v25
    v_add_f32 v95, v95, v24
    v_add_f32 v159, v159, v25
    v_cvt_pk_bf16_f32 v26, v95, -v159
    s_mov_b32 s40, 258048
    buffer_store_short v26, v8, s[32:35], s40 offen
    buffer_store_short_d16_hi v26, v8, s[32:35], s40 offen offset:2048
scan_kernel_end:
    s_endpgm
.section .rodata,"a"
.p2align 6
.amdhsa_kernel scan_kernel
  .amdhsa_next_free_vgpr 224
  .amdhsa_next_free_sgpr 48
  .amdhsa_accum_offset 224
  .amdhsa_group_segment_fixed_size 0
  .amdhsa_kernarg_size 128
  .amdhsa_user_sgpr_count 2
  .amdhsa_user_sgpr_kernarg_segment_ptr 1
  .amdhsa_system_sgpr_workgroup_id_x 1
.end_amdhsa_kernel

.text
.globl gemm2_kernel
.p2align 8
.type gemm2_kernel,@function
gemm2_kernel:
    s_cmp_ge_u32 s2, 256
    s_cbranch_scc1 gemm2_kernel_end
    s_load_dwordx2 s[60:61], s[0:1], 120
    s_load_dwordx2 s[62:63], s[0:1], 40
    s_load_dwordx2 s[64:65], s[0:1], 48
    s_load_dwordx2 s[66:67], s[0:1], 96
    s_load_dwordx2 s[68:69], s[0:1], 0
    s_load_dwordx2 s[70:71], s[0:1], 64
    s_load_dwordx2 s[72:73], s[0:1], 104
    v_and_b32 v1, 63, v0
    v_lshrrev_b32 v2, 6, v0
    s_nop 0
    v_readfirstlane_b32 s40, v2
    s_nop 3
    s_lshl_b32 s52, s40, 10
    s_and_b32 s56, s2, 15
    s_lshr_b32 s57, s2, 4
    s_lshl_b32 s44, s56, 17
    s_lshl_b32 s45, s57, 19
    s_lshl_b32 s46, s56, 7
    s_mul_i32 s47, s57, 917504
    s_and_b32 s41, s40, 1
    s_lshl_b32 s41, s41, 1
    s_lshr_b32 s42, s40, 1
    s_lshl_b32 s42, s42, 1
    s_waitcnt lgkmcnt(0)
    s_mov_b32 s4, s62
    s_mov_b32 s5, s63
    s_mov_b32 s6, 2097152
    s_mov_b32 s7, 0x20000
    s_mov_b32 s8, s64
    s_mov_b32 s9, s65
    s_mov_b32 s10, 2097152
    s_mov_b32 s11, 0x20000
    s_add_u32 s12, s60, 50331648
    s_addc_u32 s13, s61, 0
    s_mov_b32 s14, 8388608
    s_mov_b32 s15, 0x20000
    s_mov_b32 s16, s66
    s_mov_b32 s17, s67
    s_mov_b32 s18, 7340032
    s_mov_b32 s19, 0x20000
    s_add_u32 s20, s60, 33554432
    s_addc_u32 s21, s61, 0
    s_mov_b32 s22, 14680064
    s_mov_b32 s23, 0x20000
    s_mov_b32 s24, s68
    s_mov_b32 s25, s69
    s_mov_b32 s26, 4194304
    s_mov_b32 s27, 0x20000
    s_mov_b32 s28, s60
    s_mov_b32 s29, s61
    s_mov_b32 s30, 4194304
    s_mov_b32 s31, 0x20000
    s_mov_b32 s32, s70
    s_mov_b32 s33, s71
    s_mov_b32 s34, 2048
    s_mov_b32 s35, 0x20000
    s_mov_b32 s36, s72
    s_mov_b32 s37, s73
    s_mov_b32 s38, 8388608
    s_mov_b32 s39, 0x20000
    s_lshl_b32 s96, s40, 6
    s_add_u32 s96, s96, 0
    v_add_u32 v2, s96, v1
    v_lshrrev_b32 v3, 3, v2
    v_xor_b32 v4, v3, v2
    v_and_b32 v4, 7, v4
    v_lshlrev_b32 v4, 4, v4
    s_mov_b32 s96, 2048
    v_mul_lo_u32 v3, v3, s96
    v_add_u32 v5, v3, v4
    s_lshl_b32 s96, s40, 6
    s_add_u32 s96, s96, 0
    v_add_u32 v2, s96, v1
    v_lshrrev_b32 v3, 3, v2
    v_xor_b32 v4, v3, v2
    v_and_b32 v4, 7, v4
    v_lshlrev_b32 v4, 4, v4
    s_mov_b32 s96, 4096
    v_mul_lo_u32 v3, v3, s96
    v_add_u32 v6, v3, v4
    s_lshl_b32 s96, s40, 6
    s_add_u32 s96, s96, 512
    v_add_u32 v2, s96, v1
    v_lshrrev_b32 v3, 3, v2
    v_xor_b32 v4, v3, v2
    v_and_b32 v4, 7, v4
    v_lshlrev_b32 v4, 4, v4
    s_mov_b32 s96, 4096
    v_mul_lo_u32 v3, v3, s96
    v_add_u32 v7, v3, v4
    s_lshl_b32 s96, s40, 6
    s_add_u32 s96, s96, 0
    v_add_u32 v2, s96, v1
    s_mov_b32 s96, 536870912
    v_mul_hi_u32 v3, v2, s96
    s_mov_b32 s96, 8
    v_mul_lo_u32 v4, v3, s96
    v_sub_u32 v4, v2, v4
    v_and_b32 v2, 2, v3
    v_lshrrev_b32 v8, 1, v3
    v_and_b32 v8, 4, v8
    v_or_b32 v2, v2, v8
    v_xor_b32 v4, v4, v2
    v_lshlrev_b32 v4, 4, v4
    s_mov_b32 s96, 2048
    v_mul_lo_u32 v3, v3, s96
    v_add_u32 v8, v3, v4
    s_lshl_b32 s96, s40, 6
    s_add_u32 s96, s96, 0
    v_add_u32 v2, s96, v1
    v_lshrrev_b32 v3, 3, v2
    v_xor_b32 v4, v3, v2
    v_and_b32 v4, 7, v4
    v_lshlrev_b32 v4, 4, v4
    s_mov_b32 s96, 7168
    v_mul_lo_u32 v3, v3, s96
    v_add_u32 v9, v3, v4
    s_lshl_b32 s96, s40, 6
    s_add_u32 s96, s96, 512
    v_add_u32 v2, s96, v1
    v_lshrrev_b32 v3, 3, v2
    v_xor_b32 v4, v3, v2
    v_and_b32 v4, 7, v4
    v_lshlrev_b32 v4, 4, v4
    s_mov_b32 s96, 7168
    v_mul_lo_u32 v3, v3, s96
    v_add_u32 v10, v3, v4
    s_lshl_b32 s58, s41, 11
    s_lshl_b32 s59, s42, 11
    v_lshrrev_b32 v2, 4, v1
    v_add_u32 v2, 0, v2
    v_xor_b32 v2, v2, v1
    v_and_b32 v2, 7, v2
    v_lshlrev_b32 v2, 4, v2
    v_and_b32 v3, 15, v1
    v_lshlrev_b32 v3, 7, v3
    v_add3_u32 v11, v2, v3, 0
    v_add_u32 v11, s58, v11
    v_lshrrev_b32 v2, 4, v1
    v_add_u32 v2, 4, v2
    v_xor_b32 v2, v2, v1
    v_and_b32 v2, 7, v2
    v_lshlrev_b32 v2, 4, v2
    v_and_b32 v3, 15, v1
    v_lshlrev_b32 v3, 7, v3
    v_add3_u32 v12, v2, v3, 0
    v_add_u32 v12, s58, v12
    v_lshrrev_b32 v2, 4, v1
    v_add_u32 v2, 0, v2
    v_xor_b32 v2, v2, v1
    v_and_b32 v2, 7, v2
    v_lshlrev_b32 v2, 4, v2
    v_and_b32 v3, 15, v1
    v_lshlrev_b32 v3, 7, v3
    v_add_u32 v13, v2, v3
    v_add_u32 v13, 8192, v13
    v_add_u32 v13, s59, v13
    v_lshrrev_b32 v2, 4, v1
    v_add_u32 v2, 4, v2
    v_xor_b32 v2, v2, v1
    v_and_b32 v2, 7, v2
    v_lshlrev_b32 v2, 4, v2
    v_and_b32 v3, 15, v1
    v_lshlrev_b32 v3, 7, v3
    v_add_u32 v14, v2, v3
    v_add_u32 v14, 8192, v14
    v_add_u32 v14, s59, v14
    v_lshrrev_b32 v2, 4, v1
    v_lshlrev_b32 v2, 3, v2
    v_bfe_u32 v3, v1, 2, 2
    v_add3_u32 v2, v2, v3, 0
    v_and_b32 v3, 2, v2
    v_lshrrev_b32 v4, 1, v2
    v_and_b32 v4, 4, v4
    v_or_b32 v3, v3, v4
    s_add_u32 s96, s41, 0
    s_lshl_b32 s96, s96, 1
    v_bfe_u32 v4, v1, 1, 1
    v_add_u32 v4, s96, v4
    v_xor_b32 v4, v4, v3
    v_lshlrev_b32 v4, 4, v4
    v_mul_u32_u24 v2, 128, v2
    v_and_b32 v3, 1, v1
    v_lshlrev_b32 v3, 3, v3
    v_add3_u32 v15, v2, v3, v4
    v_add_u32 v15, 0, v15
    v_lshrrev_b32 v2, 4, v1
    v_lshlrev_b32 v2, 3, v2
    v_bfe_u32 v3, v1, 2, 2
    v_add3_u32 v2, v2, v3, 0
    v_and_b32 v3, 2, v2
    v_lshrrev_b32 v4, 1, v2
    v_and_b32 v4, 4, v4
    v_or_b32 v3, v3, v4
    s_add_u32 s96, s41, 1
    s_lshl_b32 s96, s96, 1
    v_bfe_u32 v4, v1, 1, 1
    v_add_u32 v4, s96, v4
    v_xor_b32 v4, v4, v3
    v_lshlrev_b32 v4, 4, v4
    v_mul_u32_u24 v2, 128, v2
    v_and_b32 v3, 1, v1
    v_lshlrev_b32 v3, 3, v3
    v_add3_u32 v16, v2, v3, v4
    v_add_u32 v16, 0, v16
    v_lshrrev_b32 v2, 4, v1
    v_lshlrev_b32 v2, 3, v2
    v_bfe_u32 v3, v1, 2, 2
    v_add3_u32 v2, v2, v3, 4
    v_and_b32 v3, 2, v2
    v_lshrrev_b32 v4, 1, v2
    v_and_b32 v4, 4, v4
    v_or_b32 v3, v3, v4
    s_add_u32 s96, s41, 0
    s_lshl_b32 s96, s96, 1
    v_bfe_u32 v4, v1, 1, 1
    v_add_u32 v4, s96, v4
    v_xor_b32 v4, v4, v3
    v_lshlrev_b32 v4, 4, v4
    v_mul_u32_u24 v2, 128, v2
    v_and_b32 v3, 1, v1
    v_lshlrev_b32 v3, 3, v3
    v_add3_u32 v17, v2, v3, v4
    v_add_u32 v17, 0, v17
    v_lshrrev_b32 v2, 4, v1
    v_lshlrev_b32 v2, 3, v2
    v_bfe_u32 v3, v1, 2, 2
    v_add3_u32 v2, v2, v3, 4
    v_and_b32 v3, 2, v2
    v_lshrrev_b32 v4, 1, v2
    v_and_b32 v4, 4, v4
    v_or_b32 v3, v3, v4
    s_add_u32 s96, s41, 1
    s_lshl_b32 s96, s96, 1
    v_bfe_u32 v4, v1, 1, 1
    v_add_u32 v4, s96, v4
    v_xor_b32 v4, v4, v3
    v_lshlrev_b32 v4, 4, v4
    v_mul_u32_u24 v2, 128, v2
    v_and_b32 v3, 1, v1
    v_lshlrev_b32 v3, 3, v3
    v_add3_u32 v18, v2, v3, v4
    v_add_u32 v18, 0, v18
    v_add_u32 v19, 49152, v11
    v_add_u32 v20, 49152, v12
    v_add_u32 v21, 49152, v13
    v_add_u32 v22, 49152, v14
    v_add_u32 v23, 49152, v15
    v_add_u32 v24, 49152, v16
    v_add_u32 v25, 49152, v17
    v_add_u32 v26, 49152, v18
    v_accvgpr_write_b32 a0, 0
    v_accvgpr_write_b32 a1, 0
    v_accvgpr_write_b32 a2, 0
    v_accvgpr_write_b32 a3, 0
    v_accvgpr_write_b32 a4, 0
    v_accvgpr_write_b32 a5, 0
    v_accvgpr_write_b32 a6, 0
    v_accvgpr_write_b32 a7, 0
    v_accvgpr_write_b32 a8, 0
    v_accvgpr_write_b32 a9, 0
    v_accvgpr_write_b32 a10, 0
    v_accvgpr_write_b32 a11, 0
    v_accvgpr_write_b32 a12, 0
    v_accvgpr_write_b32 a13, 0
    v_accvgpr_write_b32 a14, 0
    v_accvgpr_write_b32 a15, 0
    v_accvgpr_write_b32 a16, 0
    v_accvgpr_write_b32 a17, 0
    v_accvgpr_write_b32 a18, 0
    v_accvgpr_write_b32 a19, 0
    v_accvgpr_write_b32 a20, 0
    v_accvgpr_write_b32 a21, 0
    v_accvgpr_write_b32 a22, 0
    v_accvgpr_write_b32 a23, 0
    v_accvgpr_write_b32 a24, 0
    v_accvgpr_write_b32 a25, 0
    v_accvgpr_write_b32 a26, 0
    v_accvgpr_write_b32 a27, 0
    v_accvgpr_write_b32 a28, 0
    v_accvgpr_write_b32 a29, 0
    v_accvgpr_write_b32 a30, 0
    v_accvgpr_write_b32 a31, 0
    s_mov_b32 s50, 24576
    s_sub_u32 s51, 0, s50
    s_add_u32 m0, s52, 0
    s_nop 0
    buffer_load_dwordx4 v5, s[4:7], s44 offen lds
    s_add_u32 m0, s52, 8192
    s_nop 0
    buffer_load_dwordx4 v6, s[12:15], s45 offen lds
    s_add_u32 m0, s52, 16384
    s_nop 0
    buffer_load_dwordx4 v7, s[12:15], s45 offen lds
    s_add_u32 s44, s44, 128
    s_add_u32 s45, s45, 128
    s_add_u32 m0, s52, 24576
    s_nop 0
    buffer_load_dwordx4 v5, s[4:7], s44 offen lds
    s_add_u32 m0, s52, 32768
    s_nop 0
    buffer_load_dwordx4 v6, s[12:15], s45 offen lds
    s_add_u32 m0, s52, 40960
    s_nop 0
    buffer_load_dwordx4 v7, s[12:15], s45 offen lds
    s_add_u32 s44, s44, 128
    s_add_u32 s45, s45, 128
    s_add_u32 m0, s52, 49152
    s_nop 0
    buffer_load_dwordx4 v5, s[4:7], s44 offen lds
    s_add_u32 m0, s52, 57344
    s_nop 0
    buffer_load_dwordx4 v6, s[12:15], s45 offen lds
    s_add_u32 m0, s52, 65536
    s_nop 0
    buffer_load_dwordx4 v7, s[12:15], s45 offen lds
    s_mov_b32 s59, 0
L_gemm2_kernel_loop_1:
    s_waitcnt vmcnt(6)
    s_barrier
    s_add_u32 s44, s44, 128
    s_add_u32 s45, s45, 128
    s_add_u32 m0, s52, 73728
    s_nop 0
    buffer_load_dwordx4 v5, s[4:7], s44 offen lds
    s_add_u32 m0, s52, 81920
    s_nop 0
    buffer_load_dwordx4 v6, s[12:15], s45 offen lds
    s_add_u32 m0, s52, 90112
    s_nop 0
    buffer_load_dwordx4 v7, s[12:15], s45 offen lds
    ds_read_b128 v[28:31], v11 offset:0
    ds_read_b128 v[32:35], v11 offset:2048
    ds_read_b128 v[36:39], v13 offset:0
    ds_read_b128 v[40:43], v13 offset:2048
    ds_read_b128 v[44:47], v12 offset:0
    ds_read_b128 v[48:51], v12 offset:2048
    ds_read_b128 v[52:55], v14 offset:0
    ds_read_b128 v[56:59], v14 offset:2048
    s_waitcnt lgkmcnt(4)
    v_mfma_f32_16x16x32_bf16 a[0:3], v[28:31], v[36:39], a[0:3]
    v_mfma_f32_16x16x32_bf16 a[4:7], v[28:31], v[40:43], a[4:7]
    v_mfma_f32_16x16x32_bf16 a[8:11], v[32:35], v[36:39], a[8:11]
    v_mfma_f32_16x16x32_bf16 a[12:15], v[32:35], v[40:43], a[12:15]
    s_waitcnt lgkmcnt(0)
    v_mfma_f32_16x16x32_bf16 a[0:3], v[44:47], v[52:55], a[0:3]
    v_mfma_f32_16x16x32_bf16 a[4:7], v[44:47], v[56:59], a[4:7]
    v_mfma_f32_16x16x32_bf16 a[8:11], v[48:51], v[52:55], a[8:11]
    v_mfma_f32_16x16x32_bf16 a[12:15], v[48:51], v[56:59], a[12:15]
    s_waitcnt vmcnt(6)
    s_barrier
    s_add_u32 s44, s44, 128
    s_add_u32 s45, s45, 128
    s_add_u32 m0, s52, 0
    s_nop 0
    buffer_load_dwordx4 v5, s[4:7], s44 offen lds
    s_add_u32 m0, s52, 8192
    s_nop 0
    buffer_load_dwordx4 v6, s[12:15], s45 offen lds
    s_add_u32 m0, s52, 16384
    s_nop 0
    buffer_load_dwordx4 v7, s[12:15], s45 offen lds
    ds_read_b128 v[28:31], v11 offset:24576
    ds_read_b128 v[32:35], v11 offset:26624
    ds_read_b128 v[36:39], v13 offset:24576
    ds_read_b128 v[40:43], v13 offset:26624
    ds_read_b128 v[44:47], v12 offset:24576
    ds_read_b128 v[48:51], v12 offset:26624
    ds_read_b128 v[52:55], v14 offset:24576
    ds_read_b128 v[56:59], v14 offset:26624
    s_waitcnt lgkmcnt(4)
    v_mfma_f32_16x16x32_bf16 a[0:3], v[28:31], v[36:39], a[0:3]
    v_mfma_f32_16x16x32_bf16 a[4:7], v[28:31], v[40:43], a[4:7]
    v_mfma_f32_16x16x32_bf16 a[8:11], v[32:35], v[36:39], a[8:11]
    v_mfma_f32_16x16x32_bf16 a[12:15], v[32:35], v[40:43], a[12:15]
    s_waitcnt lgkmcnt(0)
    v_mfma_f32_16x16x32_bf16 a[0:3], v[44:47], v[52:55], a[0:3]
    v_mfma_f32_16x16x32_bf16 a[4:7], v[44:47], v[56:59], a[4:7]
    v_mfma_f32_16x16x32_bf16 a[8:11], v[48:51], v[52:55], a[8:11]
    v_mfma_f32_16x16x32_bf16 a[12:15], v[48:51], v[56:59], a[12:15]
    s_waitcnt vmcnt(6)
    s_barrier
    s_add_u32 s44, s44, 128
    s_add_u32 s45, s45, 128
    s_add_u32 m0, s52, 24576
    s_nop 0
    buffer_load_dwordx4 v5, s[4:7], s44 offen lds
    s_add_u32 m0, s52, 32768
    s_nop 0
    buffer_load_dwordx4 v6, s[12:15], s45 offen lds
    s_add_u32 m0, s52, 40960
    s_nop 0
    buffer_load_dwordx4 v7, s[12:15], s45 offen lds
    ds_read_b128 v[28:31], v19 offset:0
    ds_read_b128 v[32:35], v19 offset:2048
    ds_read_b128 v[36:39], v21 offset:0
    ds_read_b128 v[40:43], v21 offset:2048
    ds_read_b128 v[44:47], v20 offset:0
    ds_read_b128 v[48:51], v20 offset:2048
    ds_read_b128 v[52:55], v22 offset:0
    ds_read_b128 v[56:59], v22 offset:2048
    s_waitcnt lgkmcnt(4)
    v_mfma_f32_16x16x32_bf16 a[0:3], v[28:31], v[36:39], a[0:3]
    v_mfma_f32_16x16x32_bf16 a[4:7], v[28:31], v[40:43], a[4:7]
    v_mfma_f32_16x16x32_bf16 a[8:11], v[32:35], v[36:39], a[8:11]
    v_mfma_f32_16x16x32_bf16 a[12:15], v[32:35], v[40:43], a[12:15]
    s_waitcnt lgkmcnt(0)
    v_mfma_f32_16x16x32_bf16 a[0:3], v[44:47], v[52:55], a[0:3]
    v_mfma_f32_16x16x32_bf16 a[4:7], v[44:47], v[56:59], a[4:7]
    v_mfma_f32_16x16x32_bf16 a[8:11], v[48:51], v[52:55], a[8:11]
    v_mfma_f32_16x16x32_bf16 a[12:15], v[48:51], v[56:59], a[12:15]
    s_waitcnt vmcnt(6)
    s_barrier
    s_add_u32 s44, s44, 128
    s_add_u32 s45, s45, 128
    s_add_u32 m0, s52, 49152
    s_nop 0
    buffer_load_dwordx4 v5, s[4:7], s44 offen lds
    s_add_u32 m0, s52, 57344
    s_nop 0
    buffer_load_dwordx4 v6, s[12:15], s45 offen lds
    s_add_u32 m0, s52, 65536
    s_nop 0
    buffer_load_dwordx4 v7, s[12:15], s45 offen lds
    ds_read_b128 v[28:31], v19 offset:24576
    ds_read_b128 v[32:35], v19 offset:26624
    ds_read_b128 v[36:39], v21 offset:24576
    ds_read_b128 v[40:43], v21 offset:26624
    ds_read_b128 v[44:47], v20 offset:24576
    ds_read_b128 v[48:51], v20 offset:26624
    ds_read_b128 v[52:55], v22 offset:24576
    ds_read_b128 v[56:59], v22 offset:26624
    s_waitcnt lgkmcnt(4)
    v_mfma_f32_16x16x32_bf16 a[0:3], v[28:31], v[36:39], a[0:3]
    v_mfma_f32_16x16x32_bf16 a[4:7], v[28:31], v[40:43], a[4:7]
    v_mfma_f32_16x16x32_bf16 a[8:11], v[32:35], v[36:39], a[8:11]
    v_mfma_f32_16x16x32_bf16 a[12:15], v[32:35], v[40:43], a[12:15]
    s_waitcnt lgkmcnt(0)
    v_mfma_f32_16x16x32_bf16 a[0:3], v[44:47], v[52:55], a[0:3]
    v_mfma_f32_16x16x32_bf16 a[4:7], v[44:47], v[56:59], a[4:7]
    v_mfma_f32_16x16x32_bf16 a[8:11], v[48:51], v[52:55], a[8:11]
    v_mfma_f32_16x16x32_bf16 a[12:15], v[48:51], v[56:59], a[12:15]
    s_add_u32 s59, s59, 1
    s_cmp_lt_u32 s59, 3
    s_cbranch_scc1 L_gemm2_kernel_loop_1
    s_waitcnt vmcnt(6)
    s_barrier
    s_add_u32 s44, s44, 128
    s_add_u32 s45, s45, 128
    s_add_u32 m0, s52, 73728
    s_nop 0
    buffer_load_dwordx4 v5, s[4:7], s44 offen lds
    s_add_u32 m0, s52, 81920
    s_nop 0
    buffer_load_dwordx4 v6, s[12:15], s45 offen lds
    s_add_u32 m0, s52, 90112
    s_nop 0
    buffer_load_dwordx4 v7, s[12:15], s45 offen lds
    ds_read_b128 v[28:31], v11 offset:0
    ds_read_b128 v[32:35], v11 offset:2048
    ds_read_b128 v[36:39], v13 offset:0
    ds_read_b128 v[40:43], v13 offset:2048
    ds_read_b128 v[44:47], v12 offset:0
    ds_read_b128 v[48:51], v12 offset:2048
    ds_read_b128 v[52:55], v14 offset:0
    ds_read_b128 v[56:59], v14 offset:2048
    s_waitcnt lgkmcnt(4)
    v_mfma_f32_16x16x32_bf16 a[0:3], v[28:31], v[36:39], a[0:3]
    v_mfma_f32_16x16x32_bf16 a[4:7], v[28:31], v[40:43], a[4:7]
    v_mfma_f32_16x16x32_bf16 a[8:11], v[32:35], v[36:39], a[8:11]
    v_mfma_f32_16x16x32_bf16 a[12:15], v[32:35], v[40:43], a[12:15]
    s_waitcnt lgkmcnt(0)
    v_mfma_f32_16x16x32_bf16 a[0:3], v[44:47], v[52:55], a[0:3]
    v_mfma_f32_16x16x32_bf16 a[4:7], v[44:47], v[56:59], a[4:7]
    v_mfma_f32_16x16x32_bf16 a[8:11], v[48:51], v[52:55], a[8:11]
    v_mfma_f32_16x16x32_bf16 a[12:15], v[48:51], v[56:59], a[12:15]
    s_waitcnt vmcnt(6)
    s_barrier
    ds_read_b128 v[28:31], v11 offset:24576
    ds_read_b128 v[32:35], v11 offset:26624
    ds_read_b128 v[36:39], v13 offset:24576
    ds_read_b128 v[40:43], v13 offset:26624
    ds_read_b128 v[44:47], v12 offset:24576
    ds_read_b128 v[48:51], v12 offset:26624
    ds_read_b128 v[52:55], v14 offset:24576
    ds_read_b128 v[56:59], v14 offset:26624
    s_waitcnt lgkmcnt(4)
    v_mfma_f32_16x16x32_bf16 a[0:3], v[28:31], v[36:39], a[0:3]
    v_mfma_f32_16x16x32_bf16 a[4:7], v[28:31], v[40:43], a[4:7]
    v_mfma_f32_16x16x32_bf16 a[8:11], v[32:35], v[36:39], a[8:11]
    v_mfma_f32_16x16x32_bf16 a[12:15], v[32:35], v[40:43], a[12:15]
    s_waitcnt lgkmcnt(0)
    v_mfma_f32_16x16x32_bf16 a[0:3], v[44:47], v[52:55], a[0:3]
    v_mfma_f32_16x16x32_bf16 a[4:7], v[44:47], v[56:59], a[4:7]
    v_mfma_f32_16x16x32_bf16 a[8:11], v[48:51], v[52:55], a[8:11]
    v_mfma_f32_16x16x32_bf16 a[12:15], v[48:51], v[56:59], a[12:15]
    s_waitcnt vmcnt(3)
    s_barrier
    ds_read_b128 v[28:31], v19 offset:0
    ds_read_b128 v[32:35], v19 offset:2048
    ds_read_b128 v[36:39], v21 offset:0
    ds_read_b128 v[40:43], v21 offset:2048
    ds_read_b128 v[44:47], v20 offset:0
    ds_read_b128 v[48:51], v20 offset:2048
    ds_read_b128 v[52:55], v22 offset:0
    ds_read_b128 v[56:59], v22 offset:2048
    s_waitcnt lgkmcnt(4)
    v_mfma_f32_16x16x32_bf16 a[0:3], v[28:31], v[36:39], a[0:3]
    v_mfma_f32_16x16x32_bf16 a[4:7], v[28:31], v[40:43], a[4:7]
    v_mfma_f32_16x16x32_bf16 a[8:11], v[32:35], v[36:39], a[8:11]
    v_mfma_f32_16x16x32_bf16 a[12:15], v[32:35], v[40:43], a[12:15]
    s_waitcnt lgkmcnt(0)
    v_mfma_f32_16x16x32_bf16 a[0:3], v[44:47], v[52:55], a[0:3]
    v_mfma_f32_16x16x32_bf16 a[4:7], v[44:47], v[56:59], a[4:7]
    v_mfma_f32_16x16x32_bf16 a[8:11], v[48:51], v[52:55], a[8:11]
    v_mfma_f32_16x16x32_bf16 a[12:15], v[48:51], v[56:59], a[12:15]
    s_waitcnt vmcnt(0)
    s_barrier
    ds_read_b128 v[28:31], v19 offset:24576
    ds_read_b128 v[32:35], v19 offset:26624
    ds_read_b128 v[36:39], v21 offset:24576
    ds_read_b128 v[40:43], v21 offset:26624
    ds_read_b128 v[44:47], v20 offset:24576
    ds_read_b128 v[48:51], v20 offset:26624
    ds_read_b128 v[52:55], v22 offset:24576
    ds_read_b128 v[56:59], v22 offset:26624
    s_waitcnt lgkmcnt(4)
    v_mfma_f32_16x16x32_bf16 a[0:3], v[28:31], v[36:39], a[0:3]
    v_mfma_f32_16x16x32_bf16 a[4:7], v[28:31], v[40:43], a[4:7]
    v_mfma_f32_16x16x32_bf16 a[8:11], v[32:35], v[36:39], a[8:11]
    v_mfma_f32_16x16x32_bf16 a[12:15], v[32:35], v[40:43], a[12:15]
    s_waitcnt lgkmcnt(0)
    v_mfma_f32_16x16x32_bf16 a[0:3], v[44:47], v[52:55], a[0:3]
    v_mfma_f32_16x16x32_bf16 a[4:7], v[44:47], v[56:59], a[4:7]
    v_mfma_f32_16x16x32_bf16 a[8:11], v[48:51], v[52:55], a[8:11]
    v_mfma_f32_16x16x32_bf16 a[12:15], v[48:51], v[56:59], a[12:15]
    s_barrier
    s_add_u32 s45, s45, 128
    s_lshl_b32 s44, s56, 17
    s_add_u32 m0, s52, 0
    s_nop 0
    buffer_load_dwordx4 v5, s[8:11], s44 offen lds
    s_add_u32 m0, s52, 8192
    s_nop 0
    buffer_load_dwordx4 v6, s[12:15], s45 offen lds
    s_add_u32 m0, s52, 16384
    s_nop 0
    buffer_load_dwordx4 v7, s[12:15], s45 offen lds
    s_add_u32 s44, s44, 128
    s_add_u32 s45, s45, 128
    s_add_u32 m0, s52, 24576
    s_nop 0
    buffer_load_dwordx4 v5, s[8:11], s44 offen lds
    s_add_u32 m0, s52, 32768
    s_nop 0
    buffer_load_dwordx4 v6, s[12:15], s45 offen lds
    s_add_u32 m0, s52, 40960
    s_nop 0
    buffer_load_dwordx4 v7, s[12:15], s45 offen lds
    s_add_u32 s44, s44, 128
    s_add_u32 s45, s45, 128
    s_add_u32 m0, s52, 49152
    s_nop 0
    buffer_load_dwordx4 v5, s[8:11], s44 offen lds
    s_add_u32 m0, s52, 57344
    s_nop 0
    buffer_load_dwordx4 v6, s[12:15], s45 offen lds
    s_add_u32 m0, s52, 65536
    s_nop 0
    buffer_load_dwordx4 v7, s[12:15], s45 offen lds
    s_mov_b32 s59, 0
L_gemm2_kernel_loop_2:
    s_waitcnt vmcnt(6)
    s_barrier
    s_add_u32 s44, s44, 128
    s_add_u32 s45, s45, 128
    s_add_u32 m0, s52, 73728
    s_nop 0
    buffer_load_dwordx4 v5, s[8:11], s44 offen lds
    s_add_u32 m0, s52, 81920
    s_nop 0
    buffer_load_dwordx4 v6, s[12:15], s45 offen lds
    s_add_u32 m0, s52, 90112
    s_nop 0
    buffer_load_dwordx4 v7, s[12:15], s45 offen lds
    ds_read_b128 v[28:31], v11 offset:0
    ds_read_b128 v[32:35], v11 offset:2048
    ds_read_b128 v[36:39], v13 offset:0
    ds_read_b128 v[40:43], v13 offset:2048
    ds_read_b128 v[44:47], v12 offset:0
    ds_read_b128 v[48:51], v12 offset:2048
    ds_read_b128 v[52:55], v14 offset:0
    ds_read_b128 v[56:59], v14 offset:2048
    s_waitcnt lgkmcnt(4)
    v_mfma_f32_16x16x32_bf16 a[0:3], v[28:31], v[36:39], a[0:3]
    v_mfma_f32_16x16x32_bf16 a[4:7], v[28:31], v[40:43], a[4:7]
    v_mfma_f32_16x16x32_bf16 a[8:11], v[32:35], v[36:39], a[8:11]
    v_mfma_f32_16x16x32_bf16 a[12:15], v[32:35], v[40:43], a[12:15]
    s_waitcnt lgkmcnt(0)
    v_mfma_f32_16x16x32_bf16 a[0:3], v[44:47], v[52:55], a[0:3]
    v_mfma_f32_16x16x32_bf16 a[4:7], v[44:47], v[56:59], a[4:7]
    v_mfma_f32_16x16x32_bf16 a[8:11], v[48:51], v[52:55], a[8:11]
    v_mfma_f32_16x16x32_bf16 a[12:15], v[48:51], v[56:59], a[12:15]
    s_waitcnt vmcnt(6)
    s_barrier
    s_add_u32 s44, s44, 128
    s_add_u32 s45, s45, 128
    s_add_u32 m0, s52, 0
    s_nop 0
    buffer_load_dwordx4 v5, s[8:11], s44 offen lds
    s_add_u32 m0, s52, 8192
    s_nop 0
    buffer_load_dwordx4 v6, s[12:15], s45 offen lds
    s_add_u32 m0, s52, 16384
    s_nop 0
    buffer_load_dwordx4 v7, s[12:15], s45 offen lds
    ds_read_b128 v[28:31], v11 offset:24576
    ds_read_b128 v[32:35], v11 offset:26624
    ds_read_b128 v[36:39], v13 offset:24576
    ds_read_b128 v[40:43], v13 offset:26624
    ds_read_b128 v[44:47], v12 offset:24576
    ds_read_b128 v[48:51], v12 offset:26624
    ds_read_b128 v[52:55], v14 offset:24576
    ds_read_b128 v[56:59], v14 offset:26624
    s_waitcnt lgkmcnt(4)
    v_mfma_f32_16x16x32_bf16 a[0:3], v[28:31], v[36:39], a[0:3]
    v_mfma_f32_16x16x32_bf16 a[4:7], v[28:31], v[40:43], a[4:7]
    v_mfma_f32_16x16x32_bf16 a[8:11], v[32:35], v[36:39], a[8:11]
    v_mfma_f32_16x16x32_bf16 a[12:15], v[32:35], v[40:43], a[12:15]
    s_waitcnt lgkmcnt(0)
    v_mfma_f32_16x16x32_bf16 a[0:3], v[44:47], v[52:55], a[0:3]
    v_mfma_f32_16x16x32_bf16 a[4:7], v[44:47], v[56:59], a[4:7]
    v_mfma_f32_16x16x32_bf16 a[8:11], v[48:51], v[52:55], a[8:11]
    v_mfma_f32_16x16x32_bf16 a[12:15], v[48:51], v[56:59], a[12:15]
    s_waitcnt vmcnt(6)
    s_barrier
    s_add_u32 s44, s44, 128
    s_add_u32 s45, s45, 128
    s_add_u32 m0, s52, 24576
    s_nop 0
    buffer_load_dwordx4 v5, s[8:11], s44 offen lds
    s_add_u32 m0, s52, 32768
    s_nop 0
    buffer_load_dwordx4 v6, s[12:15], s45 offen lds
    s_add_u32 m0, s52, 40960
    s_nop 0
    buffer_load_dwordx4 v7, s[12:15], s45 offen lds
    ds_read_b128 v[28:31], v19 offset:0
    ds_read_b128 v[32:35], v19 offset:2048
    ds_read_b128 v[36:39], v21 offset:0
    ds_read_b128 v[40:43], v21 offset:2048
    ds_read_b128 v[44:47], v20 offset:0
    ds_read_b128 v[48:51], v20 offset:2048
    ds_read_b128 v[52:55], v22 offset:0
    ds_read_b128 v[56:59], v22 offset:2048
    s_waitcnt lgkmcnt(4)
    v_mfma_f32_16x16x32_bf16 a[0:3], v[28:31], v[36:39], a[0:3]
    v_mfma_f32_16x16x32_bf16 a[4:7], v[28:31], v[40:43], a[4:7]
    v_mfma_f32_16x16x32_bf16 a[8:11], v[32:35], v[36:39], a[8:11]
    v_mfma_f32_16x16x32_bf16 a[12:15], v[32:35], v[40:43], a[12:15]
    s_waitcnt lgkmcnt(0)
    v_mfma_f32_16x16x32_bf16 a[0:3], v[44:47], v[52:55], a[0:3]
    v_mfma_f32_16x16x32_bf16 a[4:7], v[44:47], v[56:59], a[4:7]
    v_mfma_f32_16x16x32_bf16 a[8:11], v[48:51], v[52:55], a[8:11]
    v_mfma_f32_16x16x32_bf16 a[12:15], v[48:51], v[56:59], a[12:15]
    s_waitcnt vmcnt(6)
    s_barrier
    s_add_u32 s44, s44, 128
    s_add_u32 s45, s45, 128
    s_add_u32 m0, s52, 49152
    s_nop 0
    buffer_load_dwordx4 v5, s[8:11], s44 offen lds
    s_add_u32 m0, s52, 57344
    s_nop 0
    buffer_load_dwordx4 v6, s[12:15], s45 offen lds
    s_add_u32 m0, s52, 65536
    s_nop 0
    buffer_load_dwordx4 v7, s[12:15], s45 offen lds
    ds_read_b128 v[28:31], v19 offset:24576
    ds_read_b128 v[32:35], v19 offset:26624
    ds_read_b128 v[36:39], v21 offset:24576
    ds_read_b128 v[40:43], v21 offset:26624
    ds_read_b128 v[44:47], v20 offset:24576
    ds_read_b128 v[48:51], v20 offset:26624
    ds_read_b128 v[52:55], v22 offset:24576
    ds_read_b128 v[56:59], v22 offset:26624
    s_waitcnt lgkmcnt(4)
    v_mfma_f32_16x16x32_bf16 a[0:3], v[28:31], v[36:39], a[0:3]
    v_mfma_f32_16x16x32_bf16 a[4:7], v[28:31], v[40:43], a[4:7]
    v_mfma_f32_16x16x32_bf16 a[8:11], v[32:35], v[36:39], a[8:11]
    v_mfma_f32_16x16x32_bf16 a[12:15], v[32:35], v[40:43], a[12:15]
    s_waitcnt lgkmcnt(0)
    v_mfma_f32_16x16x32_bf16 a[0:3], v[44:47], v[52:55], a[0:3]
    v_mfma_f32_16x16x32_bf16 a[4:7], v[44:47], v[56:59], a[4:7]
    v_mfma_f32_16x16x32_bf16 a[8:11], v[48:51], v[52:55], a[8:11]
    v_mfma_f32_16x16x32_bf16 a[12:15], v[48:51], v[56:59], a[12:15]
    s_add_u32 s59, s59, 1
    s_cmp_lt_u32 s59, 3
    s_cbranch_scc1 L_gemm2_kernel_loop_2
    s_waitcnt vmcnt(6)
    s_barrier
    s_add_u32 s44, s44, 128
    s_add_u32 s45, s45, 128
    s_add_u32 m0, s52, 73728
    s_nop 0
    buffer_load_dwordx4 v5, s[8:11], s44 offen lds
    s_add_u32 m0, s52, 81920
    s_nop 0
    buffer_load_dwordx4 v6, s[12:15], s45 offen lds
    s_add_u32 m0, s52, 90112
    s_nop 0
    buffer_load_dwordx4 v7, s[12:15], s45 offen lds
    ds_read_b128 v[28:31], v11 offset:0
    ds_read_b128 v[32:35], v11 offset:2048
    ds_read_b128 v[36:39], v13 offset:0
    ds_read_b128 v[40:43], v13 offset:2048
    ds_read_b128 v[44:47], v12 offset:0
    ds_read_b128 v[48:51], v12 offset:2048
    ds_read_b128 v[52:55], v14 offset:0
    ds_read_b128 v[56:59], v14 offset:2048
    s_waitcnt lgkmcnt(4)
    v_mfma_f32_16x16x32_bf16 a[0:3], v[28:31], v[36:39], a[0:3]
    v_mfma_f32_16x16x32_bf16 a[4:7], v[28:31], v[40:43], a[4:7]
    v_mfma_f32_16x16x32_bf16 a[8:11], v[32:35], v[36:39], a[8:11]
    v_mfma_f32_16x16x32_bf16 a[12:15], v[32:35], v[40:43], a[12:15]
    s_waitcnt lgkmcnt(0)
    v_mfma_f32_16x16x32_bf16 a[0:3], v[44:47], v[52:55], a[0:3]
    v_mfma_f32_16x16x32_bf16 a[4:7], v[44:47], v[56:59], a[4:7]
    v_mfma_f32_16x16x32_bf16 a[8:11], v[48:51], v[52:55], a[8:11]
    v_mfma_f32_16x16x32_bf16 a[12:15], v[48:51], v[56:59], a[12:15]
    s_waitcnt vmcnt(6)
    s_barrier
    ds_read_b128 v[28:31], v11 offset:24576
    ds_read_b128 v[32:35], v11 offset:26624
    ds_read_b128 v[36:39], v13 offset:24576
    ds_read_b128 v[40:43], v13 offset:26624
    ds_read_b128 v[44:47], v12 offset:24576
    ds_read_b128 v[48:51], v12 offset:26624
    ds_read_b128 v[52:55], v14 offset:24576
    ds_read_b128 v[56:59], v14 offset:26624
    s_waitcnt lgkmcnt(4)
    v_mfma_f32_16x16x32_bf16 a[0:3], v[28:31], v[36:39], a[0:3]
    v_mfma_f32_16x16x32_bf16 a[4:7], v[28:31], v[40:43], a[4:7]
    v_mfma_f32_16x16x32_bf16 a[8:11], v[32:35], v[36:39], a[8:11]
    v_mfma_f32_16x16x32_bf16 a[12:15], v[32:35], v[40:43], a[12:15]
    s_waitcnt lgkmcnt(0)
    v_mfma_f32_16x16x32_bf16 a[0:3], v[44:47], v[52:55], a[0:3]
    v_mfma_f32_16x16x32_bf16 a[4:7], v[44:47], v[56:59], a[4:7]
    v_mfma_f32_16x16x32_bf16 a[8:11], v[48:51], v[52:55], a[8:11]
    v_mfma_f32_16x16x32_bf16 a[12:15], v[48:51], v[56:59], a[12:15]
    s_waitcnt vmcnt(3)
    s_barrier
    ds_read_b128 v[28:31], v19 offset:0
    ds_read_b128 v[32:35], v19 offset:2048
    ds_read_b128 v[36:39], v21 offset:0
    ds_read_b128 v[40:43], v21 offset:2048
    ds_read_b128 v[44:47], v20 offset:0
    ds_read_b128 v[48:51], v20 offset:2048
    ds_read_b128 v[52:55], v22 offset:0
    ds_read_b128 v[56:59], v22 offset:2048
    s_waitcnt lgkmcnt(4)
    v_mfma_f32_16x16x32_bf16 a[0:3], v[28:31], v[36:39], a[0:3]
    v_mfma_f32_16x16x32_bf16 a[4:7], v[28:31], v[40:43], a[4:7]
    v_mfma_f32_16x16x32_bf16 a[8:11], v[32:35], v[36:39], a[8:11]
    v_mfma_f32_16x16x32_bf16 a[12:15], v[32:35], v[40:43], a[12:15]
    s_waitcnt lgkmcnt(0)
    v_mfma_f32_16x16x32_bf16 a[0:3], v[44:47], v[52:55], a[0:3]
    v_mfma_f32_16x16x32_bf16 a[4:7], v[44:47], v[56:59], a[4:7]
    v_mfma_f32_16x16x32_bf16 a[8:11], v[48:51], v[52:55], a[8:11]
    v_mfma_f32_16x16x32_bf16 a[12:15], v[48:51], v[56:59], a[12:15]
    s_waitcnt vmcnt(0)
    s_barrier
    ds_read_b128 v[28:31], v19 offset:24576
    ds_read_b128 v[32:35], v19 offset:26624
    ds_read_b128 v[36:39], v21 offset:24576
    ds_read_b128 v[40:43], v21 offset:26624
    ds_read_b128 v[44:47], v20 offset:24576
    ds_read_b128 v[48:51], v20 offset:26624
    ds_read_b128 v[52:55], v22 offset:24576
    ds_read_b128 v[56:59], v22 offset:26624
    s_waitcnt lgkmcnt(4)
    v_mfma_f32_16x16x32_bf16 a[0:3], v[28:31], v[36:39], a[0:3]
    v_mfma_f32_16x16x32_bf16 a[4:7], v[28:31], v[40:43], a[4:7]
    v_mfma_f32_16x16x32_bf16 a[8:11], v[32:35], v[36:39], a[8:11]
    v_mfma_f32_16x16x32_bf16 a[12:15], v[32:35], v[40:43], a[12:15]
    s_waitcnt lgkmcnt(0)
    v_mfma_f32_16x16x32_bf16 a[0:3], v[44:47], v[52:55], a[0:3]
    v_mfma_f32_16x16x32_bf16 a[4:7], v[44:47], v[56:59], a[4:7]
    v_mfma_f32_16x16x32_bf16 a[8:11], v[48:51], v[52:55], a[8:11]
    v_mfma_f32_16x16x32_bf16 a[12:15], v[48:51], v[56:59], a[12:15]
    s_barrier
    s_add_u32 m0, s52, 0
    s_nop 0
    buffer_load_dwordx4 v8, s[16:19], s46 offen lds
    s_add_u32 m0, s52, 8192
    s_nop 0
    buffer_load_dwordx4 v9, s[20:23], s47 offen lds
    s_add_u32 m0, s52, 16384
    s_nop 0
    buffer_load_dwordx4 v10, s[20:23], s47 offen lds
    s_add_u32 s46, s46, 131072
    s_add_u32 s47, s47, 128
    s_add_u32 m0, s52, 24576
    s_nop 0
    buffer_load_dwordx4 v8, s[16:19], s46 offen lds
    s_add_u32 m0, s52, 32768
    s_nop 0
    buffer_load_dwordx4 v9, s[20:23], s47 offen lds
    s_add_u32 m0, s52, 40960
    s_nop 0
    buffer_load_dwordx4 v10, s[20:23], s47 offen lds
    s_add_u32 s46, s46, 131072
    s_add_u32 s47, s47, 128
    s_add_u32 m0, s52, 49152
    s_nop 0
    buffer_load_dwordx4 v8, s[16:19], s46 offen lds
    s_add_u32 m0, s52, 57344
    s_nop 0
    buffer_load_dwordx4 v9, s[20:23], s47 offen lds
    s_add_u32 m0, s52, 65536
    s_nop 0
    buffer_load_dwordx4 v10, s[20:23], s47 offen lds
    s_mov_b32 s59, 0
L_gemm2_kernel_loop_3:
    s_waitcnt vmcnt(6)
    s_barrier
    s_add_u32 s46, s46, 131072
    s_add_u32 s47, s47, 128
    s_add_u32 m0, s52, 73728
    s_nop 0
    buffer_load_dwordx4 v8, s[16:19], s46 offen lds
    s_add_u32 m0, s52, 81920
    s_nop 0
    buffer_load_dwordx4 v9, s[20:23], s47 offen lds
    s_add_u32 m0, s52, 90112
    s_nop 0
    buffer_load_dwordx4 v10, s[20:23], s47 offen lds
    ds_read_b64_tr_b16 v[28:29], v15 offset:0
    ds_read_b64_tr_b16 v[30:31], v17 offset:0
    ds_read_b64_tr_b16 v[32:33], v16 offset:0
    ds_read_b64_tr_b16 v[34:35], v18 offset:0
    ds_read_b128 v[36:39], v13 offset:0
    ds_read_b128 v[40:43], v13 offset:2048
    ds_read_b64_tr_b16 v[44:45], v15 offset:4096
    ds_read_b64_tr_b16 v[46:47], v17 offset:4096
    ds_read_b64_tr_b16 v[48:49], v16 offset:4096
    ds_read_b64_tr_b16 v[50:51], v18 offset:4096
    ds_read_b128 v[52:55], v14 offset:0
    ds_read_b128 v[56:59], v14 offset:2048
    s_waitcnt lgkmcnt(6)
    v_mfma_f32_16x16x32_bf16 a[16:19], v[28:31], v[36:39], a[16:19]
    v_mfma_f32_16x16x32_bf16 a[20:23], v[28:31], v[40:43], a[20:23]
    v_mfma_f32_16x16x32_bf16 a[24:27], v[32:35], v[36:39], a[24:27]
    v_mfma_f32_16x16x32_bf16 a[28:31], v[32:35], v[40:43], a[28:31]
    s_waitcnt lgkmcnt(0)
    v_mfma_f32_16x16x32_bf16 a[16:19], v[44:47], v[52:55], a[16:19]
    v_mfma_f32_16x16x32_bf16 a[20:23], v[44:47], v[56:59], a[20:23]
    v_mfma_f32_16x16x32_bf16 a[24:27], v[48:51], v[52:55], a[24:27]
    v_mfma_f32_16x16x32_bf16 a[28:31], v[48:51], v[56:59], a[28:31]
    s_waitcnt vmcnt(6)
    s_barrier
    s_add_u32 s46, s46, 131072
    s_add_u32 s47, s47, 128
    s_add_u32 m0, s52, 0
    s_nop 0
    buffer_load_dwordx4 v8, s[16:19], s46 offen lds
    s_add_u32 m0, s52, 8192
    s_nop 0
    buffer_load_dwordx4 v9, s[20:23], s47 offen lds
    s_add_u32 m0, s52, 16384
    s_nop 0
    buffer_load_dwordx4 v10, s[20:23], s47 offen lds
    ds_read_b64_tr_b16 v[28:29], v15 offset:24576
    ds_read_b64_tr_b16 v[30:31], v17 offset:24576
    ds_read_b64_tr_b16 v[32:33], v16 offset:24576
    ds_read_b64_tr_b16 v[34:35], v18 offset:24576
    ds_read_b128 v[36:39], v13 offset:24576
    ds_read_b128 v[40:43], v13 offset:26624
    ds_read_b64_tr_b16 v[44:45], v15 offset:28672
    ds_read_b64_tr_b16 v[46:47], v17 offset:28672
    ds_read_b64_tr_b16 v[48:49], v16 offset:28672
    ds_read_b64_tr_b16 v[50:51], v18 offset:28672
    ds_read_b128 v[52:55], v14 offset:24576
    ds_read_b128 v[56:59], v14 offset:26624
    s_waitcnt lgkmcnt(6)
    v_mfma_f32_16x16x32_bf16 a[16:19], v[28:31], v[36:39], a[16:19]
    v_mfma_f32_16x16x32_bf16 a[20:23], v[28:31], v[40:43], a[20:23]
    v_mfma_f32_16x16x32_bf16 a[24:27], v[32:35], v[36:39], a[24:27]
    v_mfma_f32_16x16x32_bf16 a[28:31], v[32:35], v[40:43], a[28:31]
    s_waitcnt lgkmcnt(0)
    v_mfma_f32_16x16x32_bf16 a[16:19], v[44:47], v[52:55], a[16:19]
    v_mfma_f32_16x16x32_bf16 a[20:23], v[44:47], v[56:59], a[20:23]
    v_mfma_f32_16x16x32_bf16 a[24:27], v[48:51], v[52:55], a[24:27]
    v_mfma_f32_16x16x32_bf16 a[28:31], v[48:51], v[56:59], a[28:31]
    s_waitcnt vmcnt(6)
    s_barrier
    s_add_u32 s46, s46, 131072
    s_add_u32 s47, s47, 128
    s_add_u32 m0, s52, 24576
    s_nop 0
    buffer_load_dwordx4 v8, s[16:19], s46 offen lds
    s_add_u32 m0, s52, 32768
    s_nop 0
    buffer_load_dwordx4 v9, s[20:23], s47 offen lds
    s_add_u32 m0, s52, 40960
    s_nop 0
    buffer_load_dwordx4 v10, s[20:23], s47 offen lds
    ds_read_b64_tr_b16 v[28:29], v23 offset:0
    ds_read_b64_tr_b16 v[30:31], v25 offset:0
    ds_read_b64_tr_b16 v[32:33], v24 offset:0
    ds_read_b64_tr_b16 v[34:35], v26 offset:0
    ds_read_b128 v[36:39], v21 offset:0
    ds_read_b128 v[40:43], v21 offset:2048
    ds_read_b64_tr_b16 v[44:45], v23 offset:4096
    ds_read_b64_tr_b16 v[46:47], v25 offset:4096
    ds_read_b64_tr_b16 v[48:49], v24 offset:4096
    ds_read_b64_tr_b16 v[50:51], v26 offset:4096
    ds_read_b128 v[52:55], v22 offset:0
    ds_read_b128 v[56:59], v22 offset:2048
    s_waitcnt lgkmcnt(6)
    v_mfma_f32_16x16x32_bf16 a[16:19], v[28:31], v[36:39], a[16:19]
    v_mfma_f32_16x16x32_bf16 a[20:23], v[28:31], v[40:43], a[20:23]
    v_mfma_f32_16x16x32_bf16 a[24:27], v[32:35], v[36:39], a[24:27]
    v_mfma_f32_16x16x32_bf16 a[28:31], v[32:35], v[40:43], a[28:31]
    s_waitcnt lgkmcnt(0)
    v_mfma_f32_16x16x32_bf16 a[16:19], v[44:47], v[52:55], a[16:19]
    v_mfma_f32_16x16x32_bf16 a[20:23], v[44:47], v[56:59], a[20:23]
    v_mfma_f32_16x16x32_bf16 a[24:27], v[48:51], v[52:55], a[24:27]
    v_mfma_f32_16x16x32_bf16 a[28:31], v[48:51], v[56:59], a[28:31]
    s_waitcnt vmcnt(6)
    s_barrier
    s_add_u32 s46, s46, 131072
    s_add_u32 s47, s47, 128
    s_add_u32 m0, s52, 49152
    s_nop 0
    buffer_load_dwordx4 v8, s[16:19], s46 offen lds
    s_add_u32 m0, s52, 57344
    s_nop 0
    buffer_load_dwordx4 v9, s[20:23], s47 offen lds
    s_add_u32 m0, s52, 65536
    s_nop 0
    buffer_load_dwordx4 v10, s[20:23], s47 offen lds
    ds_read_b64_tr_b16 v[28:29], v23 offset:24576
    ds_read_b64_tr_b16 v[30:31], v25 offset:24576
    ds_read_b64_tr_b16 v[32:33], v24 offset:24576
    ds_read_b64_tr_b16 v[34:35], v26 offset:24576
    ds_read_b128 v[36:39], v21 offset:24576
    ds_read_b128 v[40:43], v21 offset:26624
    ds_read_b64_tr_b16 v[44:45], v23 offset:28672
    ds_read_b64_tr_b16 v[46:47], v25 offset:28672
    ds_read_b64_tr_b16 v[48:49], v24 offset:28672
    ds_read_b64_tr_b16 v[50:51], v26 offset:28672
    ds_read_b128 v[52:55], v22 offset:24576
    ds_read_b128 v[56:59], v22 offset:26624
    s_waitcnt lgkmcnt(6)
    v_mfma_f32_16x16x32_bf16 a[16:19], v[28:31], v[36:39], a[16:19]
    v_mfma_f32_16x16x32_bf16 a[20:23], v[28:31], v[40:43], a[20:23]
    v_mfma_f32_16x16x32_bf16 a[24:27], v[32:35], v[36:39], a[24:27]
    v_mfma_f32_16x16x32_bf16 a[28:31], v[32:35], v[40:43], a[28:31]
    s_waitcnt lgkmcnt(0)
    v_mfma_f32_16x16x32_bf16 a[16:19], v[44:47], v[52:55], a[16:19]
    v_mfma_f32_16x16x32_bf16 a[20:23], v[44:47], v[56:59], a[20:23]
    v_mfma_f32_16x16x32_bf16 a[24:27], v[48:51], v[52:55], a[24:27]
    v_mfma_f32_16x16x32_bf16 a[28:31], v[48:51], v[56:59], a[28:31]
    s_add_u32 s59, s59, 1
    s_cmp_lt_u32 s59, 13
    s_cbranch_scc1 L_gemm2_kernel_loop_3
    s_waitcnt vmcnt(6)
    s_barrier
    s_add_u32 s46, s46, 131072
    s_add_u32 s47, s47, 128
    s_add_u32 m0, s52, 73728
    s_nop 0
    buffer_load_dwordx4 v8, s[16:19], s46 offen lds
    s_add_u32 m0, s52, 81920
    s_nop 0
    buffer_load_dwordx4 v9, s[20:23], s47 offen lds
    s_add_u32 m0, s52, 90112
    s_nop 0
    buffer_load_dwordx4 v10, s[20:23], s47 offen lds
    ds_read_b64_tr_b16 v[28:29], v15 offset:0
    ds_read_b64_tr_b16 v[30:31], v17 offset:0
    ds_read_b64_tr_b16 v[32:33], v16 offset:0
    ds_read_b64_tr_b16 v[34:35], v18 offset:0
    ds_read_b128 v[36:39], v13 offset:0
    ds_read_b128 v[40:43], v13 offset:2048
    ds_read_b64_tr_b16 v[44:45], v15 offset:4096
    ds_read_b64_tr_b16 v[46:47], v17 offset:4096
    ds_read_b64_tr_b16 v[48:49], v16 offset:4096
    ds_read_b64_tr_b16 v[50:51], v18 offset:4096
    ds_read_b128 v[52:55], v14 offset:0
    ds_read_b128 v[56:59], v14 offset:2048
    s_waitcnt lgkmcnt(6)
    v_mfma_f32_16x16x32_bf16 a[16:19], v[28:31], v[36:39], a[16:19]
    v_mfma_f32_16x16x32_bf16 a[20:23], v[28:31], v[40:43], a[20:23]
    v_mfma_f32_16x16x32_bf16 a[24:27], v[32:35], v[36:39], a[24:27]
    v_mfma_f32_16x16x32_bf16 a[28:31], v[32:35], v[40:43], a[28:31]
    s_waitcnt lgkmcnt(0)
    v_mfma_f32_16x16x32_bf16 a[16:19], v[44:47], v[52:55], a[16:19]
    v_mfma_f32_16x16x32_bf16 a[20:23], v[44:47], v[56:59], a[20:23]
    v_mfma_f32_16x16x32_bf16 a[24:27], v[48:51], v[52:55], a[24:27]
    v_mfma_f32_16x16x32_bf16 a[28:31], v[48:51], v[56:59], a[28:31]
    s_waitcnt vmcnt(6)
    s_barrier
    ds_read_b64_tr_b16 v[28:29], v15 offset:24576
    ds_read_b64_tr_b16 v[30:31], v17 offset:24576
    ds_read_b64_tr_b16 v[32:33], v16 offset:24576
    ds_read_b64_tr_b16 v[34:35], v18 offset:24576
    ds_read_b128 v[36:39], v13 offset:24576
    ds_read_b128 v[40:43], v13 offset:26624
    ds_read_b64_tr_b16 v[44:45], v15 offset:28672
    ds_read_b64_tr_b16 v[46:47], v17 offset:28672
    ds_read_b64_tr_b16 v[48:49], v16 offset:28672
    ds_read_b64_tr_b16 v[50:51], v18 offset:28672
    ds_read_b128 v[52:55], v14 offset:24576
    ds_read_b128 v[56:59], v14 offset:26624
    s_waitcnt lgkmcnt(6)
    v_mfma_f32_16x16x32_bf16 a[16:19], v[28:31], v[36:39], a[16:19]
    v_mfma_f32_16x16x32_bf16 a[20:23], v[28:31], v[40:43], a[20:23]
    v_mfma_f32_16x16x32_bf16 a[24:27], v[32:35], v[36:39], a[24:27]
    v_mfma_f32_16x16x32_bf16 a[28:31], v[32:35], v[40:43], a[28:31]
    s_waitcnt lgkmcnt(0)
    v_mfma_f32_16x16x32_bf16 a[16:19], v[44:47], v[52:55], a[16:19]
    v_mfma_f32_16x16x32_bf16 a[20:23], v[44:47], v[56:59], a[20:23]
    v_mfma_f32_16x16x32_bf16 a[24:27], v[48:51], v[52:55], a[24:27]
    v_mfma_f32_16x16x32_bf16 a[28:31], v[48:51], v[56:59], a[28:31]
    s_waitcnt vmcnt(3)
    s_barrier
    ds_read_b64_tr_b16 v[28:29], v23 offset:0
    ds_read_b64_tr_b16 v[30:31], v25 offset:0
    ds_read_b64_tr_b16 v[32:33], v24 offset:0
    ds_read_b64_tr_b16 v[34:35], v26 offset:0
    ds_read_b128 v[36:39], v21 offset:0
    ds_read_b128 v[40:43], v21 offset:2048
    ds_read_b64_tr_b16 v[44:45], v23 offset:4096
    ds_read_b64_tr_b16 v[46:47], v25 offset:4096
    ds_read_b64_tr_b16 v[48:49], v24 offset:4096
    ds_read_b64_tr_b16 v[50:51], v26 offset:4096
    ds_read_b128 v[52:55], v22 offset:0
    ds_read_b128 v[56:59], v22 offset:2048
    s_waitcnt lgkmcnt(6)
    v_mfma_f32_16x16x32_bf16 a[16:19], v[28:31], v[36:39], a[16:19]
    v_mfma_f32_16x16x32_bf16 a[20:23], v[28:31], v[40:43], a[20:23]
    v_mfma_f32_16x16x32_bf16 a[24:27], v[32:35], v[36:39], a[24:27]
    v_mfma_f32_16x16x32_bf16 a[28:31], v[32:35], v[40:43], a[28:31]
    s_waitcnt lgkmcnt(0)
    v_mfma_f32_16x16x32_bf16 a[16:19], v[44:47], v[52:55], a[16:19]
    v_mfma_f32_16x16x32_bf16 a[20:23], v[44:47], v[56:59], a[20:23]
    v_mfma_f32_16x16x32_bf16 a[24:27], v[48:51], v[52:55], a[24:27]
    v_mfma_f32_16x16x32_bf16 a[28:31], v[48:51], v[56:59], a[28:31]
    s_waitcnt vmcnt(0)
    s_barrier
    ds_read_b64_tr_b16 v[28:29], v23 offset:24576
    ds_read_b64_tr_b16 v[30:31], v25 offset:24576
    ds_read_b64_tr_b16 v[32:33], v24 offset:24576
    ds_read_b64_tr_b16 v[34:35], v26 offset:24576
    ds_read_b128 v[36:39], v21 offset:24576
    ds_read_b128 v[40:43], v21 offset:26624
    ds_read_b64_tr_b16 v[44:45], v23 offset:28672
    ds_read_b64_tr_b16 v[46:47], v25 offset:28672
    ds_read_b64_tr_b16 v[48:49], v24 offset:28672
    ds_read_b64_tr_b16 v[50:51], v26 offset:28672
    ds_read_b128 v[52:55], v22 offset:24576
    ds_read_b128 v[56:59], v22 offset:26624
    s_waitcnt lgkmcnt(6)
    v_mfma_f32_16x16x32_bf16 a[16:19], v[28:31], v[36:39], a[16:19]
    v_mfma_f32_16x16x32_bf16 a[20:23], v[28:31], v[40:43], a[20:23]
    v_mfma_f32_16x16x32_bf16 a[24:27], v[32:35], v[36:39], a[24:27]
    v_mfma_f32_16x16x32_bf16 a[28:31], v[32:35], v[40:43], a[28:31]
    s_waitcnt lgkmcnt(0)
    v_mfma_f32_16x16x32_bf16 a[16:19], v[44:47], v[52:55], a[16:19]
    v_mfma_f32_16x16x32_bf16 a[20:23], v[44:47], v[56:59], a[20:23]
    v_mfma_f32_16x16x32_bf16 a[24:27], v[48:51], v[52:55], a[24:27]
    v_mfma_f32_16x16x32_bf16 a[28:31], v[48:51], v[56:59], a[28:31]
    s_barrier
    s_nop 7
    s_nop 7
    v_and_b32 v2, 15, v1
    s_lshl_b32 s58, s57, 7
    s_lshl_b32 s59, s42, 4
    s_add_u32 s58, s58, s59
    v_add_u32 v2, s58, v2
    v_lshrrev_b32 v3, 4, v1
    v_lshlrev_b32 v3, 2, v3
    s_lshl_b32 s58, s56, 6
    s_lshl_b32 s59, s41, 4
    s_add_u32 s58, s58, s59
    v_add_u32 v3, s58, v3
    v_lshlrev_b32 v5, 11, v2
    v_lshlrev_b32 v6, 1, v3
    v_add_u32 v5, v5, v6
    v_lshlrev_b32 v7, 1, v5
    buffer_load_dwordx2 v[8:9], v5, s[24:27], 0 offen offset:0
    buffer_load_dwordx2 v[10:11], v5, s[28:31], 0 offen offset:0
    buffer_load_dwordx2 v[12:13], v6, s[32:35], 0 offen offset:0
    v_accvgpr_read_b32 v16, a0
    v_accvgpr_read_b32 v20, a16
    v_accvgpr_read_b32 v17, a1
    v_accvgpr_read_b32 v21, a17
    v_accvgpr_read_b32 v18, a2
    v_accvgpr_read_b32 v22, a18
    v_accvgpr_read_b32 v19, a3
    v_accvgpr_read_b32 v23, a19
    s_waitcnt vmcnt(0)
    v_lshlrev_b32 v24, 16, v8
    v_lshlrev_b32 v25, 16, v10
    v_lshlrev_b32 v26, 16, v12
    v_mul_f32 v25, v25, v26
    v_cvt_pk_bf16_f32 v25, v25, v25
    v_lshlrev_b32 v25, 16, v25
    v_fma_f32 v25, v16, 2.0, v25
    v_cvt_pk_bf16_f32 v26, v20, v20
    v_lshlrev_b32 v26, 16, v26
    v_mul_f32 v27, 0xbfb8aa3b, v26
    v_exp_f32 v27, v27
    s_nop 0
    v_add_f32 v27, 1.0, v27
    v_rcp_f32 v27, v27
    s_nop 0
    v_mul_f32 v26, v26, v27
    v_cvt_pk_bf16_f32 v26, v26, v26
    v_lshlrev_b32 v26, 16, v26
    v_fma_f32 v28, v25, v26, v24
    v_and_b32 v24, 0xffff0000, v8
    v_and_b32 v25, 0xffff0000, v10
    v_and_b32 v26, 0xffff0000, v12
    v_mul_f32 v25, v25, v26
    v_cvt_pk_bf16_f32 v25, v25, v25
    v_lshlrev_b32 v25, 16, v25
    v_fma_f32 v25, v17, 2.0, v25
    v_cvt_pk_bf16_f32 v26, v21, v21
    v_lshlrev_b32 v26, 16, v26
    v_mul_f32 v27, 0xbfb8aa3b, v26
    v_exp_f32 v27, v27
    s_nop 0
    v_add_f32 v27, 1.0, v27
    v_rcp_f32 v27, v27
    s_nop 0
    v_mul_f32 v26, v26, v27
    v_cvt_pk_bf16_f32 v26, v26, v26
    v_lshlrev_b32 v26, 16, v26
    v_fma_f32 v29, v25, v26, v24
    v_lshlrev_b32 v24, 16, v9
    v_lshlrev_b32 v25, 16, v11
    v_lshlrev_b32 v26, 16, v13
    v_mul_f32 v25, v25, v26
    v_cvt_pk_bf16_f32 v25, v25, v25
    v_lshlrev_b32 v25, 16, v25
    v_fma_f32 v25, v18, 2.0, v25
    v_cvt_pk_bf16_f32 v26, v22, v22
    v_lshlrev_b32 v26, 16, v26
    v_mul_f32 v27, 0xbfb8aa3b, v26
    v_exp_f32 v27, v27
    s_nop 0
    v_add_f32 v27, 1.0, v27
    v_rcp_f32 v27, v27
    s_nop 0
    v_mul_f32 v26, v26, v27
    v_cvt_pk_bf16_f32 v26, v26, v26
    v_lshlrev_b32 v26, 16, v26
    v_fma_f32 v30, v25, v26, v24
    v_and_b32 v24, 0xffff0000, v9
    v_and_b32 v25, 0xffff0000, v11
    v_and_b32 v26, 0xffff0000, v13
    v_mul_f32 v25, v25, v26
    v_cvt_pk_bf16_f32 v25, v25, v25
    v_lshlrev_b32 v25, 16, v25
    v_fma_f32 v25, v19, 2.0, v25
    v_cvt_pk_bf16_f32 v26, v23, v23
    v_lshlrev_b32 v26, 16, v26
    v_mul_f32 v27, 0xbfb8aa3b, v26
    v_exp_f32 v27, v27
    s_nop 0
    v_add_f32 v27, 1.0, v27
    v_rcp_f32 v27, v27
    s_nop 0
    v_mul_f32 v26, v26, v27
    v_cvt_pk_bf16_f32 v26, v26, v26
    v_lshlrev_b32 v26, 16, v26
    v_fma_f32 v31, v25, v26, v24
    buffer_store_dwordx4 v[28:31], v7, s[36:39], 0 offen offset:0
    s_nop 1
    v_add_u32 v4, 32768, v5
    buffer_load_dwordx2 v[8:9], v4, s[24:27], 0 offen offset:0
    buffer_load_dwordx2 v[10:11], v4, s[28:31], 0 offen offset:0
    buffer_load_dwordx2 v[12:13], v6, s[32:35], 0 offen offset:0
    v_accvgpr_read_b32 v16, a4
    v_accvgpr_read_b32 v20, a20
    v_accvgpr_read_b32 v17, a5
    v_accvgpr_read_b32 v21, a21
    v_accvgpr_read_b32 v18, a6
    v_accvgpr_read_b32 v22, a22
    v_accvgpr_read_b32 v19, a7
    v_accvgpr_read_b32 v23, a23
    s_waitcnt vmcnt(0)
    v_lshlrev_b32 v24, 16, v8
    v_lshlrev_b32 v25, 16, v10
    v_lshlrev_b32 v26, 16, v12
    v_mul_f32 v25, v25, v26
    v_cvt_pk_bf16_f32 v25, v25, v25
    v_lshlrev_b32 v25, 16, v25
    v_fma_f32 v25, v16, 2.0, v25
    v_cvt_pk_bf16_f32 v26, v20, v20
    v_lshlrev_b32 v26, 16, v26
    v_mul_f32 v27, 0xbfb8aa3b, v26
    v_exp_f32 v27, v27
    s_nop 0
    v_add_f32 v27, 1.0, v27
    v_rcp_f32 v27, v27
    s_nop 0
    v_mul_f32 v26, v26, v27
    v_cvt_pk_bf16_f32 v26, v26, v26
    v_lshlrev_b32 v26, 16, v26
    v_fma_f32 v28, v25, v26, v24
    v_and_b32 v24, 0xffff0000, v8
    v_and_b32 v25, 0xffff0000, v10
    v_and_b32 v26, 0xffff0000, v12
    v_mul_f32 v25, v25, v26
    v_cvt_pk_bf16_f32 v25, v25, v25
    v_lshlrev_b32 v25, 16, v25
    v_fma_f32 v25, v17, 2.0, v25
    v_cvt_pk_bf16_f32 v26, v21, v21
    v_lshlrev_b32 v26, 16, v26
    v_mul_f32 v27, 0xbfb8aa3b, v26
    v_exp_f32 v27, v27
    s_nop 0
    v_add_f32 v27, 1.0, v27
    v_rcp_f32 v27, v27
    s_nop 0
    v_mul_f32 v26, v26, v27
    v_cvt_pk_bf16_f32 v26, v26, v26
    v_lshlrev_b32 v26, 16, v26
    v_fma_f32 v29, v25, v26, v24
    v_lshlrev_b32 v24, 16, v9
    v_lshlrev_b32 v25, 16, v11
    v_lshlrev_b32 v26, 16, v13
    v_mul_f32 v25, v25, v26
    v_cvt_pk_bf16_f32 v25, v25, v25
    v_lshlrev_b32 v25, 16, v25
    v_fma_f32 v25, v18, 2.0, v25
    v_cvt_pk_bf16_f32 v26, v22, v22
    v_lshlrev_b32 v26, 16, v26
    v_mul_f32 v27, 0xbfb8aa3b, v26
    v_exp_f32 v27, v27
    s_nop 0
    v_add_f32 v27, 1.0, v27
    v_rcp_f32 v27, v27
    s_nop 0
    v_mul_f32 v26, v26, v27
    v_cvt_pk_bf16_f32 v26, v26, v26
    v_lshlrev_b32 v26, 16, v26
    v_fma_f32 v30, v25, v26, v24
    v_and_b32 v24, 0xffff0000, v9
    v_and_b32 v25, 0xffff0000, v11
    v_and_b32 v26, 0xffff0000, v13
    v_mul_f32 v25, v25, v26
    v_cvt_pk_bf16_f32 v25, v25, v25
    v_lshlrev_b32 v25, 16, v25
    v_fma_f32 v25, v19, 2.0, v25
    v_cvt_pk_bf16_f32 v26, v23, v23
    v_lshlrev_b32 v26, 16, v26
    v_mul_f32 v27, 0xbfb8aa3b, v26
    v_exp_f32 v27, v27
    s_nop 0
    v_add_f32 v27, 1.0, v27
    v_rcp_f32 v27, v27
    s_nop 0
    v_mul_f32 v26, v26, v27
    v_cvt_pk_bf16_f32 v26, v26, v26
    v_lshlrev_b32 v26, 16, v26
    v_fma_f32 v31, v25, v26, v24
    v_add_u32 v4, 65536, v7
    buffer_store_dwordx4 v[28:31], v4, s[36:39], 0 offen offset:0
    s_nop 1
    buffer_load_dwordx2 v[8:9], v5, s[24:27], 0 offen offset:32
    buffer_load_dwordx2 v[10:11], v5, s[28:31], 0 offen offset:32
    buffer_load_dwordx2 v[12:13], v6, s[32:35], 0 offen offset:32
    v_accvgpr_read_b32 v16, a8
    v_accvgpr_read_b32 v20, a24
    v_accvgpr_read_b32 v17, a9
    v_accvgpr_read_b32 v21, a25
    v_accvgpr_read_b32 v18, a10
    v_accvgpr_read_b32 v22, a26
    v_accvgpr_read_b32 v19, a11
    v_accvgpr_read_b32 v23, a27
    s_waitcnt vmcnt(0)
    v_lshlrev_b32 v24, 16, v8
    v_lshlrev_b32 v25, 16, v10
    v_lshlrev_b32 v26, 16, v12
    v_mul_f32 v25, v25, v26
    v_cvt_pk_bf16_f32 v25, v25, v25
    v_lshlrev_b32 v25, 16, v25
    v_fma_f32 v25, v16, 2.0, v25
    v_cvt_pk_bf16_f32 v26, v20, v20
    v_lshlrev_b32 v26, 16, v26
    v_mul_f32 v27, 0xbfb8aa3b, v26
    v_exp_f32 v27, v27
    s_nop 0
    v_add_f32 v27, 1.0, v27
    v_rcp_f32 v27, v27
    s_nop 0
    v_mul_f32 v26, v26, v27
    v_cvt_pk_bf16_f32 v26, v26, v26
    v_lshlrev_b32 v26, 16, v26
    v_fma_f32 v28, v25, v26, v24
    v_and_b32 v24, 0xffff0000, v8
    v_and_b32 v25, 0xffff0000, v10
    v_and_b32 v26, 0xffff0000, v12
    v_mul_f32 v25, v25, v26
    v_cvt_pk_bf16_f32 v25, v25, v25
    v_lshlrev_b32 v25, 16, v25
    v_fma_f32 v25, v17, 2.0, v25
    v_cvt_pk_bf16_f32 v26, v21, v21
    v_lshlrev_b32 v26, 16, v26
    v_mul_f32 v27, 0xbfb8aa3b, v26
    v_exp_f32 v27, v27
    s_nop 0
    v_add_f32 v27, 1.0, v27
    v_rcp_f32 v27, v27
    s_nop 0
    v_mul_f32 v26, v26, v27
    v_cvt_pk_bf16_f32 v26, v26, v26
    v_lshlrev_b32 v26, 16, v26
    v_fma_f32 v29, v25, v26, v24
    v_lshlrev_b32 v24, 16, v9
    v_lshlrev_b32 v25, 16, v11
    v_lshlrev_b32 v26, 16, v13
    v_mul_f32 v25, v25, v26
    v_cvt_pk_bf16_f32 v25, v25, v25
    v_lshlrev_b32 v25, 16, v25
    v_fma_f32 v25, v18, 2.0, v25
    v_cvt_pk_bf16_f32 v26, v22, v22
    v_lshlrev_b32 v26, 16, v26
    v_mul_f32 v27, 0xbfb8aa3b, v26
    v_exp_f32 v27, v27
    s_nop 0
    v_add_f32 v27, 1.0, v27
    v_rcp_f32 v27, v27
    s_nop 0
    v_mul_f32 v26, v26, v27
    v_cvt_pk_bf16_f32 v26, v26, v26
    v_lshlrev_b32 v26, 16, v26
    v_fma_f32 v30, v25, v26, v24
    v_and_b32 v24, 0xffff0000, v9
    v_and_b32 v25, 0xffff0000, v11
    v_and_b32 v26, 0xffff0000, v13
    v_mul_f32 v25, v25, v26
    v_cvt_pk_bf16_f32 v25, v25, v25
    v_lshlrev_b32 v25, 16, v25
    v_fma_f32 v25, v19, 2.0, v25
    v_cvt_pk_bf16_f32 v26, v23, v23
    v_lshlrev_b32 v26, 16, v26
    v_mul_f32 v27, 0xbfb8aa3b, v26
    v_exp_f32 v27, v27
    s_nop 0
    v_add_f32 v27, 1.0, v27
    v_rcp_f32 v27, v27
    s_nop 0
    v_mul_f32 v26, v26, v27
    v_cvt_pk_bf16_f32 v26, v26, v26
    v_lshlrev_b32 v26, 16, v26
    v_fma_f32 v31, v25, v26, v24
    buffer_store_dwordx4 v[28:31], v7, s[36:39], 0 offen offset:64
    s_nop 1
    v_add_u32 v4, 32768, v5
    buffer_load_dwordx2 v[8:9], v4, s[24:27], 0 offen offset:32
    buffer_load_dwordx2 v[10:11], v4, s[28:31], 0 offen offset:32
    buffer_load_dwordx2 v[12:13], v6, s[32:35], 0 offen offset:32
    v_accvgpr_read_b32 v16, a12
    v_accvgpr_read_b32 v20, a28
    v_accvgpr_read_b32 v17, a13
    v_accvgpr_read_b32 v21, a29
    v_accvgpr_read_b32 v18, a14
    v_accvgpr_read_b32 v22, a30
    v_accvgpr_read_b32 v19, a15
    v_accvgpr_read_b32 v23, a31
    s_waitcnt vmcnt(0)
    v_lshlrev_b32 v24, 16, v8
    v_lshlrev_b32 v25, 16, v10
    v_lshlrev_b32 v26, 16, v12
    v_mul_f32 v25, v25, v26
    v_cvt_pk_bf16_f32 v25, v25, v25
    v_lshlrev_b32 v25, 16, v25
    v_fma_f32 v25, v16, 2.0, v25
    v_cvt_pk_bf16_f32 v26, v20, v20
    v_lshlrev_b32 v26, 16, v26
    v_mul_f32 v27, 0xbfb8aa3b, v26
    v_exp_f32 v27, v27
    s_nop 0
    v_add_f32 v27, 1.0, v27
    v_rcp_f32 v27, v27
    s_nop 0
    v_mul_f32 v26, v26, v27
    v_cvt_pk_bf16_f32 v26, v26, v26
    v_lshlrev_b32 v26, 16, v26
    v_fma_f32 v28, v25, v26, v24
    v_and_b32 v24, 0xffff0000, v8
    v_and_b32 v25, 0xffff0000, v10
    v_and_b32 v26, 0xffff0000, v12
    v_mul_f32 v25, v25, v26
    v_cvt_pk_bf16_f32 v25, v25, v25
    v_lshlrev_b32 v25, 16, v25
    v_fma_f32 v25, v17, 2.0, v25
    v_cvt_pk_bf16_f32 v26, v21, v21
    v_lshlrev_b32 v26, 16, v26
    v_mul_f32 v27, 0xbfb8aa3b, v26
    v_exp_f32 v27, v27
    s_nop 0
    v_add_f32 v27, 1.0, v27
    v_rcp_f32 v27, v27
    s_nop 0
    v_mul_f32 v26, v26, v27
    v_cvt_pk_bf16_f32 v26, v26, v26
    v_lshlrev_b32 v26, 16, v26
    v_fma_f32 v29, v25, v26, v24
    v_lshlrev_b32 v24, 16, v9
    v_lshlrev_b32 v25, 16, v11
    v_lshlrev_b32 v26, 16, v13
    v_mul_f32 v25, v25, v26
    v_cvt_pk_bf16_f32 v25, v25, v25
    v_lshlrev_b32 v25, 16, v25
    v_fma_f32 v25, v18, 2.0, v25
    v_cvt_pk_bf16_f32 v26, v22, v22
    v_lshlrev_b32 v26, 16, v26
    v_mul_f32 v27, 0xbfb8aa3b, v26
    v_exp_f32 v27, v27
    s_nop 0
    v_add_f32 v27, 1.0, v27
    v_rcp_f32 v27, v27
    s_nop 0
    v_mul_f32 v26, v26, v27
    v_cvt_pk_bf16_f32 v26, v26, v26
    v_lshlrev_b32 v26, 16, v26
    v_fma_f32 v30, v25, v26, v24
    v_and_b32 v24, 0xffff0000, v9
    v_and_b32 v25, 0xffff0000, v11
    v_and_b32 v26, 0xffff0000, v13
    v_mul_f32 v25, v25, v26
    v_cvt_pk_bf16_f32 v25, v25, v25
    v_lshlrev_b32 v25, 16, v25
    v_fma_f32 v25, v19, 2.0, v25
    v_cvt_pk_bf16_f32 v26, v23, v23
    v_lshlrev_b32 v26, 16, v26
    v_mul_f32 v27, 0xbfb8aa3b, v26
    v_exp_f32 v27, v27
    s_nop 0
    v_add_f32 v27, 1.0, v27
    v_rcp_f32 v27, v27
    s_nop 0
    v_mul_f32 v26, v26, v27
    v_cvt_pk_bf16_f32 v26, v26, v26
    v_lshlrev_b32 v26, 16, v26
    v_fma_f32 v31, v25, v26, v24
    v_add_u32 v4, 65536, v7
    buffer_store_dwordx4 v[28:31], v4, s[36:39], 0 offen offset:64
    s_nop 1
gemm2_kernel_end:
    s_endpgm
.section .rodata,"a"
.p2align 6
.amdhsa_kernel gemm2_kernel
  .amdhsa_next_free_vgpr 92
  .amdhsa_next_free_sgpr 102
  .amdhsa_accum_offset 60
  .amdhsa_group_segment_fixed_size 0
  .amdhsa_kernarg_size 128
  .amdhsa_user_sgpr_count 2
  .amdhsa_user_sgpr_kernarg_segment_ptr 1
  .amdhsa_system_sgpr_workgroup_id_x 1
.end_amdhsa_kernel
```
